```python
import torch

def _softmax(x, axis=-1):
    return torch.softmax(x, dim=axis)
def _gelu(x):
    return torch.nn.functional.gelu(x, approximate="tanh")
def _silu(x):
    return torch.nn.functional.silu(x)
def _sigmoid(x):
    return torch.sigmoid(x)
def _layernorm(x, axis=-1, eps=1e-5):
    m = x.mean(dim=axis, keepdim=True)
    v = x.var(dim=axis, keepdim=True, unbiased=False)
    return (x - m) / torch.sqrt(v + eps)
def _scatter_add(tgt, idx, src, axis=0):
    return tgt.clone().index_add_(axis, idx, src)
def _segment_sum(src, seg, n):
    out = torch.zeros((n,) + src.shape[1:], dtype=src.dtype)
    return out.index_add_(0, seg, src)
def _pad(x, pw):
    flat = tuple(v for pair in reversed(pw) for v in pair)
    return torch.nn.functional.pad(x, flat)

kernel_name = 'standalone__paged_block_table_kv_pagedattention__prompt'

def setup_inputs():

    _w = (lambda a: (lambda t: t.to(torch.bfloat16) if t.is_floating_point() else t)(torch.as_tensor(a)))
    B, Hq, Hkv, Sq, Skv, D = 1, 32, 16, 2048, 2048, 128
    bs = 16
    nbps = max(1, Skv // bs)
    num_phys = B * nbps + 4
    bt = torch.randperm(num_phys)[: B * nbps].reshape(B, nbps).to(torch.int64)
    cl = (nbps * bs - (torch.arange(1, B + 1, dtype=torch.int64) * 2654435761) % max(1, nbps * bs // 2)).to(torch.int64)
    return {
        "q": _w((lambda *s: torch.randn(*s, dtype=torch.bfloat16) * 0.8)(B, Hq, Sq, D)),
        "k_cache": _w((lambda *s: torch.randn(*s, dtype=torch.bfloat16) * 0.8)(num_phys, bs, Hkv, D)),
        "v_cache": _w((lambda *s: torch.randn(*s, dtype=torch.bfloat16) * 0.05)(num_phys, bs, Hkv, D)),
        "block_table": _w(bt),
        "context_lens": _w(cl),
    }

def reference(q, k_cache, v_cache, block_table, context_lens):
    B, Hq, Sq, D = q.shape
    bs = k_cache.shape[1]
    Hkv = k_cache.shape[2]
    nbps = block_table.shape[1]
    Skv = nbps * bs
    bt = block_table.reshape(-1)
    k = (lambda x, *d: x.permute(*d))(k_cache[bt].reshape(B, Skv, Hkv, D), 0, 2, 1, 3)
    v = (lambda x, *d: x.permute(*d))(v_cache[bt].reshape(B, Skv, Hkv, D), 0, 2, 1, 3)
    g = Hq // Hkv
    qg = q.reshape(B, Hkv, g, Sq, D)
    scores = torch.einsum("bhgqd,bhkd->bhgqk", qg, k) * (D ** -0.5)
    pos = torch.arange(Skv)
    msk = pos[None, :] < context_lens[:, None]
    scores = torch.where(msk[:, None, None, None, :], scores, -1e9)
    p = _softmax(scores, axis=-1)
    out = torch.einsum("bhgqk,bhkd->bhgqd", p, v)
    return out.reshape(B, Hq, Sq, D)
```

```asm
; @launch grid=(256,1,1) block=(256,1,1) lds=163840
.amdgcn_target "amdgcn-amd-amdhsa--gfx950"
.text
.globl standalone__paged_block_table_kv_pagedattention__prompt_kernel
.p2align 8
.type standalone__paged_block_table_kv_pagedattention__prompt_kernel,@function
standalone__paged_block_table_kv_pagedattention__prompt_kernel:
    s_cmp_ge_u32 s2, 256
    s_cbranch_scc1 L_end
    s_load_dwordx8 s[24:31], s[0:1], 0
    s_load_dwordx4 s[32:35], s[0:1], 32
    s_lshr_b32 s79, s2, 3
    s_getpc_b64 s[8:9]
L_pc:
    s_lshl_b32 s10, s79, 10
    v_lshl_add_u32 v2, v0, 2, s10
    v_mov_b32 v3, 0
    v_lshl_add_u64 v[2:3], v[2:3], 0, s[8:9]
    global_load_dword v127, v[2:3], off
    v_lshrrev_b32 v120, 6, v0
    v_and_b32 v122, 15, v0
    v_readfirstlane_b32 s3, v120
    v_bfe_u32 v123, v0, 4, 2
    s_and_b32 s78, s2, 7
    s_lshl_b32 s78, s78, 5
    s_add_u32 s78, s78, s79
    s_lshl_b32 s79, s78, 16
    v_lshl_add_u32 v124, v120, 4, v123
    v_xor_b32 v125, v122, v123
    v_lshl_add_u32 v88, v124, 4, v125
    v_lshlrev_b32 v88, 4, v88
    s_lshl_b32 s64, s3, 12
    s_add_u32 s77, s78, s3
    s_and_b32 s77, s77, 3
    s_lshl_b32 s77, s77, 14
    v_xor_b32 v89, 64, v88
    v_xor_b32 v90, 0x80, v88
    v_xor_b32 v91, 64, v90
    s_mov_b32 s6, 0x10000
    s_mov_b32 s7, 0x20000
    s_add_u32 m0, s64, 131072
    s_waitcnt lgkmcnt(0)
    s_add_u32 s4, s24, s79
    s_addc_u32 s5, s25, 0
    s_load_dword s36, s[32:33], 0
    s_load_dwordx16 s[40:55], s[30:31], 0
    buffer_load_dwordx4 v88, s[4:7], s77 offen offset:0 lds
    buffer_load_dwordx4 v89, s[4:7], s77 offen offset:1024 lds
    buffer_load_dwordx4 v90, s[4:7], s77 offen offset:2048 lds
    buffer_load_dwordx4 v91, s[4:7], s77 offen offset:3072 lds
    v_and_b32 v121, 63, v0
    v_lshlrev_b32 v126, 4, v121
    s_mov_b32 s20, s30
    s_mov_b32 s21, s31
    s_movk_i32 s22, 0x200
    s_mov_b32 s23, 0x20000
    buffer_load_dwordx4 v[108:111], v126, s[20:23], 0 offen
    s_lshr_b32 s78, s78, 4
    s_lshl_b32 s78, s78, 8
    s_add_u32 s8, s26, s78
    s_addc_u32 s9, s27, 0
    s_sub_u32 s8, s8, 3072
    s_subb_u32 s9, s9, 0
    s_sub_u32 s10, 8653824, s78
    s_mov_b32 s11, 0x20000
    v_lshl_add_u32 v124, v120, 2, v123
    v_xor_b32 v126, v122, v124
    v_lshlrev_b32 v126, 4, v126
    v_lshl_add_u32 v112, v124, 12, v126
    v_and_b32 v126, 7, v124
    v_lshlrev_b32 v126, 1, v126
    v_xor_b32 v126, v122, v126
    v_lshlrev_b32 v126, 4, v126
    v_lshl_add_u32 v113, v124, 12, v126
    s_add_u32 s72, s77, 16384
    s_and_b32 s72, s72, 49152
    s_add_u32 s73, s77, 32768
    s_and_b32 s73, s73, 49152
    s_add_u32 s74, s77, 49152
    s_and_b32 s74, s74, 49152
    s_add_u32 s12, s28, s78
    s_addc_u32 s13, s29, 0
    s_sub_u32 s12, s12, 3072
    s_subb_u32 s13, s13, 0
    s_mov_b32 s14, s10
    s_mov_b32 s15, 0x20000
    s_add_u32 s16, s34, s79
    s_addc_u32 s17, s35, 0
    s_mov_b32 s18, 0x10000
    s_mov_b32 s19, 0x20000
    s_add_u32 s65, s64, 0x10000
    s_mov_b32 s66, 0x3e0293ee
    s_waitcnt lgkmcnt(0)
    s_cmp_lt_i32 s36, 1
    s_cselect_b32 s66, 0, s66
    s_cselect_b32 s36, 0x800, s36
    s_min_u32 s71, s36, 0x800
    s_max_u32 s36, s71, 193
    s_add_u32 s37, s36, 63
    s_lshr_b32 s37, s37, 6
    s_mov_b32 s75, s37
    s_sub_u32 s75, s36, 1
    s_and_b32 s75, s75, 63
    s_cmp_lt_u32 s75, 16
    s_addc_u32 s75, s37, 0
    s_sub_u32 s69, 0, s75
    s_and_b32 s69, s69, 3
    s_lshl_b32 s96, s69, 14
    s_min_u32 s40, s40, 131
    s_lshl_b32 s40, s40, 16
    s_or_b32 s40, s40, 3072
    s_min_u32 s41, s41, 131
    s_lshl_b32 s41, s41, 16
    s_or_b32 s41, s41, 2048
    s_min_u32 s42, s42, 131
    s_lshl_b32 s42, s42, 16
    s_or_b32 s42, s42, 1024
    s_min_u32 s43, s43, 131
    s_lshl_b32 s43, s43, 16
    s_add_u32 m0, s64, s96
    s_nop 0
    buffer_load_dwordx4 v112, s[8:11], s40 offen offset:0 sc1 lds
    buffer_load_dwordx4 v112, s[8:11], s41 offen offset:1024 sc1 lds
    buffer_load_dwordx4 v112, s[8:11], s42 offen offset:2048 sc1 lds
    buffer_load_dwordx4 v112, s[8:11], s43 offen offset:3072 sc1 lds
    s_add_u32 m0, s64, 147456
    s_nop 0
    buffer_load_dwordx4 v88, s[4:7], s72 offen offset:0 lds
    buffer_load_dwordx4 v89, s[4:7], s72 offen offset:1024 lds
    buffer_load_dwordx4 v90, s[4:7], s72 offen offset:2048 lds
    buffer_load_dwordx4 v91, s[4:7], s72 offen offset:3072 lds
    s_mov_b32 s67, s66
    s_cmp_lt_u32 s71, 193
    s_cselect_b32 s70, 1, 0
    s_add_u32 s38, s75, s69
    s_lshr_b32 s38, s38, 2
    s_sub_u32 s38, s38, 2
    s_add_u32 s97, s96, 16384
    s_and_b32 s97, s97, 0xc000
    s_add_u32 s98, s96, 32768
    s_and_b32 s98, s98, 0xc000
    s_add_u32 s99, s96, 49152
    s_and_b32 s99, s99, 0xc000
    s_sub_u32 s78, s37, 1
    s_lshl_b32 s78, s78, 6
    s_sub_u32 s78, s36, s78
    s_add_u32 s68, s78, 15
    s_lshr_b32 s68, s68, 4
    s_sub_u32 s78, s78, 1
    s_and_b32 s78, s78, 15
    s_and_b32 s79, s69, 1
    s_sub_u32 s79, 4, s79
    s_sub_u32 s80, 7, s79
    s_mov_b32 s39, 4
    s_sub_u32 s33, s37, s75
    s_not_b32 s33, s33
    s_mov_b64 s[24:25], s[12:13]
    s_mov_b32 s26, s14
    s_mov_b32 s27, 0x20000
    s_lshl_b32 s81, s3, 13
    s_add_u32 s81, s81, 0x20000
    s_lshl_b32 s82, s3, 12
    v_lshrrev_b32 v124, 2, v122
    v_lshlrev_b32 v124, 4, v124
    v_and_b32 v126, 3, v122
    v_add_u32 v124, v124, v126
    v_lshlrev_b32 v124, 8, v124
    v_lshlrev_b32 v126, 12, v120
    v_lshl_add_u32 v126, v122, 8, v126
    v_add_u32 v126, 0x20000, v126
    v_xor_b32 v116, 0, v125
    v_lshl_add_u32 v96, v116, 4, v124
    v_lshl_add_u32 v92, v116, 4, v126
    v_add_u32 v128, s96, v96
    v_xor_b32 v116, 4, v125
    v_lshl_add_u32 v97, v116, 4, v124
    v_lshl_add_u32 v93, v116, 4, v126
    v_add_u32 v129, s96, v97
    v_xor_b32 v116, 8, v125
    v_lshl_add_u32 v98, v116, 4, v124
    v_lshl_add_u32 v94, v116, 4, v126
    v_add_u32 v130, s96, v98
    v_xor_b32 v116, 12, v125
    v_lshl_add_u32 v99, v116, 4, v124
    v_lshl_add_u32 v95, v116, 4, v126
    v_add_u32 v131, s96, v99
    s_min_u32 s44, s44, 131
    s_lshl_b32 s44, s44, 16
    s_or_b32 s44, s44, 3072
    s_min_u32 s45, s45, 131
    s_lshl_b32 s45, s45, 16
    s_or_b32 s45, s45, 2048
    s_min_u32 s46, s46, 131
    s_lshl_b32 s46, s46, 16
    s_or_b32 s46, s46, 1024
    s_min_u32 s47, s47, 131
    s_lshl_b32 s47, s47, 16
    v_bfe_u32 v125, v121, 2, 2
    v_lshl_add_u32 v124, v123, 4, v125
    v_lshlrev_b32 v124, 8, v124
    v_and_b32 v116, 3, v121
    v_lshl_add_u32 v124, v116, 3, v124
    v_add_u32 v124, 0x10000, v124
    v_lshl_add_u32 v125, v123, 2, v125
    v_and_b32 v125, 7, v125
    v_xor_b32 v100, 0, v125
    v_lshl_add_u32 v100, v100, 5, v124
    v_add_u32 v52, s96, v100
    v_xor_b32 v101, 1, v125
    v_lshl_add_u32 v101, v101, 5, v124
    v_add_u32 v53, s96, v101
    v_xor_b32 v102, 2, v125
    v_lshl_add_u32 v102, v102, 5, v124
    v_add_u32 v54, s96, v102
    v_xor_b32 v103, 3, v125
    v_lshl_add_u32 v103, v103, 5, v124
    v_add_u32 v55, s96, v103
    v_xor_b32 v104, 4, v125
    v_lshl_add_u32 v104, v104, 5, v124
    v_add_u32 v56, s96, v104
    v_xor_b32 v105, 5, v125
    v_lshl_add_u32 v105, v105, 5, v124
    v_add_u32 v57, s96, v105
    v_xor_b32 v106, 6, v125
    v_lshl_add_u32 v106, v106, 5, v124
    v_add_u32 v58, s96, v106
    v_xor_b32 v107, 7, v125
    v_lshl_add_u32 v107, v107, 5, v124
    v_add_u32 v59, s96, v107
    v_lshlrev_b32 v124, 12, v120
    v_lshl_add_u32 v124, v122, 8, v124
    v_and_b32 v125, 1, v123
    v_lshl_add_u32 v124, v125, 5, v124
    v_lshrrev_b32 v125, 1, v123
    v_lshl_add_u32 v115, v125, 4, v124
    v_and_b32 v124, 1, v121
    v_mov_b32 v125, 0xaaaaaaaa
    v_mul_lo_u32 v124, v124, v125
    v_or_b32 v114, 0x44444444, v124
    v_mov_b32 v125, 0x3f803f80
    v_accvgpr_write_b32 a208, v125
    v_accvgpr_write_b32 a209, v125
    v_accvgpr_write_b32 a210, v125
    v_accvgpr_write_b32 a211, v125
    v_lshlrev_b32 v124, 2, v123
    v_mov_b32 v125, 0xf149f2ca
    v_add_u32 v126, 0, v124
    v_cmp_lt_u32 vcc, s78, v126
    s_nop 1
    v_cndmask_b32 v116, 0, v125, vcc
    v_add_u32 v126, 1, v124
    v_cmp_lt_u32 vcc, s78, v126
    s_nop 1
    v_cndmask_b32 v117, 0, v125, vcc
    v_add_u32 v126, 2, v124
    v_cmp_lt_u32 vcc, s78, v126
    s_nop 1
    v_cndmask_b32 v118, 0, v125, vcc
    v_add_u32 v126, 3, v124
    v_cmp_lt_u32 vcc, s78, v126
    s_nop 1
    v_cndmask_b32 v119, 0, v125, vcc
    v_mov_b32 v192, 0
    v_mov_b32 v193, 0
    v_mov_b32 v194, 0
    v_mov_b32 v195, 0
    v_mov_b32 v196, 0
    v_mov_b32 v197, 0
    v_mov_b32 v198, 0
    v_mov_b32 v199, 0
    v_mov_b32 v200, 0
    v_mov_b32 v201, 0
    v_mov_b32 v202, 0
    v_mov_b32 v203, 0
    v_mov_b32 v204, 0
    v_mov_b32 v205, 0
    v_mov_b32 v206, 0
    v_mov_b32 v207, 0
    v_mov_b32 v208, 0
    v_mov_b32 v209, 0
    v_mov_b32 v210, 0
    v_mov_b32 v211, 0
    v_mov_b32 v212, 0
    v_mov_b32 v213, 0
    v_mov_b32 v214, 0
    v_mov_b32 v215, 0
    v_mov_b32 v216, 0
    v_mov_b32 v217, 0
    v_mov_b32 v218, 0
    v_mov_b32 v219, 0
    v_mov_b32 v220, 0
    v_mov_b32 v221, 0
    v_mov_b32 v222, 0
    v_mov_b32 v223, 0
    v_mov_b32 v224, 0
    v_mov_b32 v225, 0
    v_mov_b32 v226, 0
    v_mov_b32 v227, 0
    v_mov_b32 v228, 0
    v_mov_b32 v229, 0
    v_mov_b32 v230, 0
    v_mov_b32 v231, 0
    v_mov_b32 v232, 0
    v_mov_b32 v233, 0
    v_mov_b32 v234, 0
    v_mov_b32 v235, 0
    v_mov_b32 v236, 0
    v_mov_b32 v237, 0
    v_mov_b32 v238, 0
    v_mov_b32 v239, 0
    v_mov_b32 v240, 0
    v_mov_b32 v241, 0
    v_mov_b32 v242, 0
    v_mov_b32 v243, 0
    v_mov_b32 v244, 0
    v_mov_b32 v245, 0
    v_mov_b32 v246, 0
    v_mov_b32 v247, 0
    v_mov_b32 v248, 0
    v_mov_b32 v249, 0
    v_mov_b32 v250, 0
    v_mov_b32 v251, 0
    v_mov_b32 v252, 0
    v_mov_b32 v253, 0
    v_mov_b32 v254, 0
    v_mov_b32 v255, 0
    v_accvgpr_write_b32 a192, 0
    v_accvgpr_write_b32 a193, 0
    v_accvgpr_write_b32 a194, 0
    v_accvgpr_write_b32 a195, 0
    v_accvgpr_write_b32 a196, 0
    v_accvgpr_write_b32 a197, 0
    v_accvgpr_write_b32 a198, 0
    v_accvgpr_write_b32 a199, 0
    v_accvgpr_write_b32 a200, 0
    v_accvgpr_write_b32 a201, 0
    v_accvgpr_write_b32 a202, 0
    v_accvgpr_write_b32 a203, 0
    v_accvgpr_write_b32 a204, 0
    v_accvgpr_write_b32 a205, 0
    v_accvgpr_write_b32 a206, 0
    v_accvgpr_write_b32 a207, 0
    s_min_u32 s48, s48, 131
    s_lshl_b32 s48, s48, 16
    s_or_b32 s48, s48, 3072
    s_min_u32 s49, s49, 131
    s_lshl_b32 s49, s49, 16
    s_or_b32 s49, s49, 2048
    s_min_u32 s50, s50, 131
    s_lshl_b32 s50, s50, 16
    s_or_b32 s50, s50, 1024
    s_min_u32 s51, s51, 131
    s_lshl_b32 s51, s51, 16
    s_min_u32 s52, s52, 131
    s_lshl_b32 s52, s52, 16
    s_or_b32 s52, s52, 3072
    s_min_u32 s53, s53, 131
    s_lshl_b32 s53, s53, 16
    s_or_b32 s53, s53, 2048
    s_min_u32 s54, s54, 131
    s_lshl_b32 s54, s54, 16
    s_or_b32 s54, s54, 1024
    s_min_u32 s55, s55, 131
    s_lshl_b32 s55, s55, 16
    s_waitcnt vmcnt(9)
    ds_read_b128 v[0:3], v92 offset:0
    ds_read_b128 v[4:7], v93 offset:0
    ds_read_b128 v[8:11], v94 offset:0
    ds_read_b128 v[12:15], v95 offset:0
    s_waitcnt lgkmcnt(0)
    s_add_u32 m0, s65, s96
    s_nop 0
    buffer_load_dwordx4 v113, s[12:15], s40 offen offset:0 sc1 lds
    buffer_load_dwordx4 v113, s[12:15], s41 offen offset:1024 sc1 lds
    buffer_load_dwordx4 v113, s[12:15], s42 offen offset:2048 sc1 lds
    buffer_load_dwordx4 v113, s[12:15], s43 offen offset:3072 sc1 lds
    v_lshlrev_b32 v120, 16, v0
    v_and_b32 v121, 0xffff0000, v0
    v_lshlrev_b32 v122, 16, v1
    v_and_b32 v123, 0xffff0000, v1
    v_lshlrev_b32 v124, 16, v2
    v_and_b32 v125, 0xffff0000, v2
    v_lshlrev_b32 v126, 16, v3
    v_and_b32 v127, 0xffff0000, v3
    v_pk_mul_f32 v[120:121], v[120:121], s[66:67]
    v_pk_mul_f32 v[122:123], v[122:123], s[66:67]
    v_pk_mul_f32 v[124:125], v[124:125], s[66:67]
    v_pk_mul_f32 v[126:127], v[126:127], s[66:67]
    v_cvt_pk_bf16_f32 v0, v120, v121
    v_cvt_pk_bf16_f32 v1, v122, v123
    v_cvt_pk_bf16_f32 v2, v124, v125
    v_cvt_pk_bf16_f32 v3, v126, v127
    v_accvgpr_write_b32 a0, v0
    v_accvgpr_write_b32 a1, v1
    v_accvgpr_write_b32 a2, v2
    v_accvgpr_write_b32 a3, v3
    v_lshlrev_b32 v120, 16, v4
    v_and_b32 v121, 0xffff0000, v4
    v_lshlrev_b32 v122, 16, v5
    v_and_b32 v123, 0xffff0000, v5
    v_lshlrev_b32 v124, 16, v6
    v_and_b32 v125, 0xffff0000, v6
    v_lshlrev_b32 v126, 16, v7
    v_and_b32 v127, 0xffff0000, v7
    v_pk_mul_f32 v[120:121], v[120:121], s[66:67]
    v_pk_mul_f32 v[122:123], v[122:123], s[66:67]
    v_pk_mul_f32 v[124:125], v[124:125], s[66:67]
    v_pk_mul_f32 v[126:127], v[126:127], s[66:67]
    v_cvt_pk_bf16_f32 v4, v120, v121
    v_cvt_pk_bf16_f32 v5, v122, v123
    v_cvt_pk_bf16_f32 v6, v124, v125
    v_cvt_pk_bf16_f32 v7, v126, v127
    v_accvgpr_write_b32 a4, v4
    v_accvgpr_write_b32 a5, v5
    v_accvgpr_write_b32 a6, v6
    v_accvgpr_write_b32 a7, v7
    v_lshlrev_b32 v120, 16, v8
    v_and_b32 v121, 0xffff0000, v8
    v_lshlrev_b32 v122, 16, v9
    v_and_b32 v123, 0xffff0000, v9
    v_lshlrev_b32 v124, 16, v10
    v_and_b32 v125, 0xffff0000, v10
    v_lshlrev_b32 v126, 16, v11
    v_and_b32 v127, 0xffff0000, v11
    v_pk_mul_f32 v[120:121], v[120:121], s[66:67]
    v_pk_mul_f32 v[122:123], v[122:123], s[66:67]
    v_pk_mul_f32 v[124:125], v[124:125], s[66:67]
    v_pk_mul_f32 v[126:127], v[126:127], s[66:67]
    v_cvt_pk_bf16_f32 v8, v120, v121
    v_cvt_pk_bf16_f32 v9, v122, v123
    v_cvt_pk_bf16_f32 v10, v124, v125
    v_cvt_pk_bf16_f32 v11, v126, v127
    v_accvgpr_write_b32 a8, v8
    v_accvgpr_write_b32 a9, v9
    v_accvgpr_write_b32 a10, v10
    v_accvgpr_write_b32 a11, v11
    v_lshlrev_b32 v120, 16, v12
    v_and_b32 v121, 0xffff0000, v12
    v_lshlrev_b32 v122, 16, v13
    v_and_b32 v123, 0xffff0000, v13
    v_lshlrev_b32 v124, 16, v14
    v_and_b32 v125, 0xffff0000, v14
    v_lshlrev_b32 v126, 16, v15
    v_and_b32 v127, 0xffff0000, v15
    v_pk_mul_f32 v[120:121], v[120:121], s[66:67]
    v_pk_mul_f32 v[122:123], v[122:123], s[66:67]
    v_pk_mul_f32 v[124:125], v[124:125], s[66:67]
    v_pk_mul_f32 v[126:127], v[126:127], s[66:67]
    v_cvt_pk_bf16_f32 v12, v120, v121
    v_cvt_pk_bf16_f32 v13, v122, v123
    v_cvt_pk_bf16_f32 v14, v124, v125
    v_cvt_pk_bf16_f32 v15, v126, v127
    v_accvgpr_write_b32 a12, v12
    v_accvgpr_write_b32 a13, v13
    v_accvgpr_write_b32 a14, v14
    v_accvgpr_write_b32 a15, v15
    s_waitcnt vmcnt(12)
    s_mov_b64 s[20:21], s[8:9]
    s_mov_b32 s22, s10
    v_min_u32 v108, 131, v108
    v_lshlrev_b32 v108, 16, v108
    v_or_b32 v108, 3072, v108
    v_min_u32 v109, 131, v109
    v_lshlrev_b32 v109, 16, v109
    v_or_b32 v109, 2048, v109
    v_min_u32 v110, 131, v110
    v_lshlrev_b32 v110, 16, v110
    v_or_b32 v110, 1024, v110
    v_min_u32 v111, 131, v111
    v_lshlrev_b32 v111, 16, v111
    s_nop 0
    v_readlane_b32 s56, v108, s79
    v_readlane_b32 s57, v109, s79
    v_readlane_b32 s58, v110, s79
    v_readlane_b32 s59, v111, s79
    v_readlane_b32 s60, v108, s80
    v_readlane_b32 s61, v109, s80
    v_readlane_b32 s62, v110, s80
    v_readlane_b32 s63, v111, s80
    s_waitcnt vmcnt(8)
    s_barrier
    ds_read_b128 a[64:67], v128 offset:0
    ds_read_b128 a[68:71], v129 offset:0
    ds_read_b128 a[72:75], v130 offset:0
    ds_read_b128 a[76:79], v131 offset:0
    ds_read_b128 a[92:95], v131 offset:1024
    ds_read_b128 a[88:91], v130 offset:1024
    ds_read_b128 a[84:87], v129 offset:1024
    ds_read_b128 a[80:83], v128 offset:1024
    ds_read_b128 a[96:99], v128 offset:2048
    ds_read_b128 a[100:103], v129 offset:2048
    ds_read_b128 a[104:107], v130 offset:2048
    ds_read_b128 a[108:111], v131 offset:2048
    ds_read_b128 a[124:127], v131 offset:3072
    ds_read_b128 a[120:123], v130 offset:3072
    ds_read_b128 a[116:119], v129 offset:3072
    ds_read_b128 a[112:115], v128 offset:3072
    s_add_u32 m0, s64, 131072
    s_nop 0
    buffer_load_dwordx4 v88, s[4:7], s73 offen offset:0 lds
    buffer_load_dwordx4 v89, s[4:7], s73 offen offset:1024 lds
    buffer_load_dwordx4 v90, s[4:7], s73 offen offset:2048 lds
    buffer_load_dwordx4 v91, s[4:7], s73 offen offset:3072 lds
    s_waitcnt lgkmcnt(15)
    v_mfma_f32_16x16x32_bf16 v[0:3], a[64:67], a[0:3], 0
    s_waitcnt lgkmcnt(14)
    v_mfma_f32_16x16x32_bf16 v[0:3], a[68:71], a[4:7], v[0:3]
    s_waitcnt lgkmcnt(13)
    v_mfma_f32_16x16x32_bf16 v[0:3], a[72:75], a[8:11], v[0:3]
    s_waitcnt lgkmcnt(12)
    v_mfma_f32_16x16x32_bf16 v[0:3], a[76:79], a[12:15], v[0:3]
    s_waitcnt lgkmcnt(11)
    v_mfma_f32_16x16x32_bf16 v[4:7], a[92:95], a[12:15], 0
    s_waitcnt lgkmcnt(10)
    v_mfma_f32_16x16x32_bf16 v[4:7], a[88:91], a[8:11], v[4:7]
    s_waitcnt lgkmcnt(9)
    v_mfma_f32_16x16x32_bf16 v[4:7], a[84:87], a[4:7], v[4:7]
    s_waitcnt lgkmcnt(8)
    v_mfma_f32_16x16x32_bf16 v[4:7], a[80:83], a[0:3], v[4:7]
    s_waitcnt lgkmcnt(0)
    v_mfma_f32_16x16x32_bf16 v[8:11], a[96:99], a[0:3], 0
    v_exp_f32 v0, v0
    v_mfma_f32_16x16x32_bf16 v[8:11], a[100:103], a[4:7], v[8:11]
    v_exp_f32 v1, v1
    v_mfma_f32_16x16x32_bf16 v[8:11], a[104:107], a[8:11], v[8:11]
    v_exp_f32 v2, v2
    v_mfma_f32_16x16x32_bf16 v[8:11], a[108:111], a[12:15], v[8:11]
    v_exp_f32 v3, v3
    v_mfma_f32_16x16x32_bf16 v[12:15], a[124:127], a[12:15], 0
    v_exp_f32 v4, v4
    v_mfma_f32_16x16x32_bf16 v[12:15], a[120:123], a[8:11], v[12:15]
    v_exp_f32 v5, v5
    v_cvt_pk_bf16_f32 v64, v0, v1
    v_mfma_f32_16x16x32_bf16 v[12:15], a[116:119], a[4:7], v[12:15]
    v_exp_f32 v6, v6
    v_cvt_pk_bf16_f32 v65, v2, v3
    v_mfma_f32_16x16x32_bf16 v[12:15], a[112:115], a[0:3], v[12:15]
    v_exp_f32 v7, v7
    v_cvt_pk_bf16_f32 v66, v4, v5
    s_waitcnt vmcnt(8)
    ds_read_b128 v[16:19], v92 offset:16384
    ds_read_b128 v[20:23], v93 offset:16384
    ds_read_b128 v[24:27], v94 offset:16384
    ds_read_b128 v[28:31], v95 offset:16384
    s_waitcnt lgkmcnt(0)
    s_add_u32 m0, s64, s97
    s_nop 0
    buffer_load_dwordx4 v112, s[8:11], s44 offen offset:0 sc1 lds
    buffer_load_dwordx4 v112, s[8:11], s45 offen offset:1024 sc1 lds
    buffer_load_dwordx4 v112, s[8:11], s46 offen offset:2048 sc1 lds
    buffer_load_dwordx4 v112, s[8:11], s47 offen offset:3072 sc1 lds
    v_lshlrev_b32 v120, 16, v16
    v_and_b32 v121, 0xffff0000, v16
    v_lshlrev_b32 v122, 16, v17
    v_and_b32 v123, 0xffff0000, v17
    v_lshlrev_b32 v124, 16, v18
    v_and_b32 v125, 0xffff0000, v18
    v_lshlrev_b32 v126, 16, v19
    v_and_b32 v127, 0xffff0000, v19
    v_pk_mul_f32 v[120:121], v[120:121], s[66:67]
    v_pk_mul_f32 v[122:123], v[122:123], s[66:67]
    v_pk_mul_f32 v[124:125], v[124:125], s[66:67]
    v_pk_mul_f32 v[126:127], v[126:127], s[66:67]
    v_cvt_pk_bf16_f32 v16, v120, v121
    v_cvt_pk_bf16_f32 v17, v122, v123
    v_cvt_pk_bf16_f32 v18, v124, v125
    v_cvt_pk_bf16_f32 v19, v126, v127
    v_accvgpr_write_b32 a16, v16
    v_accvgpr_write_b32 a17, v17
    v_accvgpr_write_b32 a18, v18
    v_accvgpr_write_b32 a19, v19
    v_lshlrev_b32 v120, 16, v20
    v_and_b32 v121, 0xffff0000, v20
    v_lshlrev_b32 v122, 16, v21
    v_and_b32 v123, 0xffff0000, v21
    v_lshlrev_b32 v124, 16, v22
    v_and_b32 v125, 0xffff0000, v22
    v_lshlrev_b32 v126, 16, v23
    v_and_b32 v127, 0xffff0000, v23
    v_pk_mul_f32 v[120:121], v[120:121], s[66:67]
    v_pk_mul_f32 v[122:123], v[122:123], s[66:67]
    v_pk_mul_f32 v[124:125], v[124:125], s[66:67]
    v_pk_mul_f32 v[126:127], v[126:127], s[66:67]
    v_cvt_pk_bf16_f32 v20, v120, v121
    v_cvt_pk_bf16_f32 v21, v122, v123
    v_cvt_pk_bf16_f32 v22, v124, v125
    v_cvt_pk_bf16_f32 v23, v126, v127
    v_accvgpr_write_b32 a20, v20
    v_accvgpr_write_b32 a21, v21
    v_accvgpr_write_b32 a22, v22
    v_accvgpr_write_b32 a23, v23
    v_lshlrev_b32 v120, 16, v24
    v_and_b32 v121, 0xffff0000, v24
    v_lshlrev_b32 v122, 16, v25
    v_and_b32 v123, 0xffff0000, v25
    v_lshlrev_b32 v124, 16, v26
    v_and_b32 v125, 0xffff0000, v26
    v_lshlrev_b32 v126, 16, v27
    v_and_b32 v127, 0xffff0000, v27
    v_pk_mul_f32 v[120:121], v[120:121], s[66:67]
    v_pk_mul_f32 v[122:123], v[122:123], s[66:67]
    v_pk_mul_f32 v[124:125], v[124:125], s[66:67]
    v_pk_mul_f32 v[126:127], v[126:127], s[66:67]
    v_cvt_pk_bf16_f32 v24, v120, v121
    v_cvt_pk_bf16_f32 v25, v122, v123
    v_cvt_pk_bf16_f32 v26, v124, v125
    v_cvt_pk_bf16_f32 v27, v126, v127
    v_accvgpr_write_b32 a24, v24
    v_accvgpr_write_b32 a25, v25
    v_accvgpr_write_b32 a26, v26
    v_accvgpr_write_b32 a27, v27
    v_lshlrev_b32 v120, 16, v28
    v_and_b32 v121, 0xffff0000, v28
    v_lshlrev_b32 v122, 16, v29
    v_and_b32 v123, 0xffff0000, v29
    v_lshlrev_b32 v124, 16, v30
    v_and_b32 v125, 0xffff0000, v30
    v_lshlrev_b32 v126, 16, v31
    v_and_b32 v127, 0xffff0000, v31
    v_pk_mul_f32 v[120:121], v[120:121], s[66:67]
    v_pk_mul_f32 v[122:123], v[122:123], s[66:67]
    v_pk_mul_f32 v[124:125], v[124:125], s[66:67]
    v_pk_mul_f32 v[126:127], v[126:127], s[66:67]
    v_cvt_pk_bf16_f32 v28, v120, v121
    v_cvt_pk_bf16_f32 v29, v122, v123
    v_cvt_pk_bf16_f32 v30, v124, v125
    v_cvt_pk_bf16_f32 v31, v126, v127
    v_accvgpr_write_b32 a28, v28
    v_accvgpr_write_b32 a29, v29
    v_accvgpr_write_b32 a30, v30
    v_accvgpr_write_b32 a31, v31
    s_nop 0
    v_mfma_f32_16x16x32_bf16 v[16:19], a[64:67], a[16:19], 0
    v_exp_f32 v8, v8
    v_cvt_pk_bf16_f32 v67, v6, v7
    v_mfma_f32_16x16x32_bf16 v[16:19], a[68:71], a[20:23], v[16:19]
    v_exp_f32 v9, v9
    v_mfma_f32_16x16x32_bf16 v[16:19], a[72:75], a[24:27], v[16:19]
    v_exp_f32 v10, v10
    v_cvt_pk_bf16_f32 v68, v8, v9
    v_mfma_f32_16x16x32_bf16 v[16:19], a[76:79], a[28:31], v[16:19]
    v_exp_f32 v11, v11
    v_mfma_f32_16x16x32_bf16 v[20:23], a[92:95], a[28:31], 0
    v_exp_f32 v12, v12
    v_exp_f32 v13, v13
    v_exp_f32 v14, v14
    v_exp_f32 v15, v15
    v_cvt_pk_bf16_f32 v69, v10, v11
    v_mfma_f32_16x16x32_bf16 v[20:23], a[88:91], a[24:27], v[20:23]
    v_cvt_pk_bf16_f32 v70, v12, v13
    v_cvt_pk_bf16_f32 v71, v14, v15
    v_mfma_f32_16x16x32_bf16 v[20:23], a[84:87], a[20:23], v[20:23]
    v_mfma_f32_16x16x32_bf16 v[20:23], a[80:83], a[16:19], v[20:23]
    v_mfma_f32_16x16x32_bf16 v[24:27], a[96:99], a[16:19], 0
    v_exp_f32 v16, v16
    v_mfma_f32_16x16x32_bf16 v[24:27], a[100:103], a[20:23], v[24:27]
    v_exp_f32 v17, v17
    v_mfma_f32_16x16x32_bf16 v[24:27], a[104:107], a[24:27], v[24:27]
    v_exp_f32 v18, v18
    v_mfma_f32_16x16x32_bf16 v[24:27], a[108:111], a[28:31], v[24:27]
    v_exp_f32 v19, v19
    v_mfma_f32_16x16x32_bf16 v[28:31], a[124:127], a[28:31], 0
    v_exp_f32 v20, v20
    v_mfma_f32_16x16x32_bf16 v[28:31], a[120:123], a[24:27], v[28:31]
    v_exp_f32 v21, v21
    v_cvt_pk_bf16_f32 v72, v16, v17
    v_mfma_f32_16x16x32_bf16 v[28:31], a[116:119], a[20:23], v[28:31]
    v_exp_f32 v22, v22
    v_cvt_pk_bf16_f32 v73, v18, v19
    v_mfma_f32_16x16x32_bf16 v[28:31], a[112:115], a[16:19], v[28:31]
    v_exp_f32 v23, v23
    v_cvt_pk_bf16_f32 v74, v20, v21
    s_add_u32 m0, s64, 147456
    s_nop 0
    buffer_load_dwordx4 v88, s[4:7], s74 offen offset:0 lds
    buffer_load_dwordx4 v89, s[4:7], s74 offen offset:1024 lds
    buffer_load_dwordx4 v90, s[4:7], s74 offen offset:2048 lds
    buffer_load_dwordx4 v91, s[4:7], s74 offen offset:3072 lds
    s_waitcnt vmcnt(8)
    ds_read_b128 v[32:35], v92 offset:0
    ds_read_b128 v[36:39], v93 offset:0
    ds_read_b128 v[40:43], v94 offset:0
    ds_read_b128 v[44:47], v95 offset:0
    s_waitcnt lgkmcnt(0)
    v_lshlrev_b32 v120, 16, v32
    v_and_b32 v121, 0xffff0000, v32
    v_lshlrev_b32 v122, 16, v33
    v_and_b32 v123, 0xffff0000, v33
    v_lshlrev_b32 v124, 16, v34
    v_and_b32 v125, 0xffff0000, v34
    v_lshlrev_b32 v126, 16, v35
    v_and_b32 v127, 0xffff0000, v35
    v_pk_mul_f32 v[120:121], v[120:121], s[66:67]
    v_pk_mul_f32 v[122:123], v[122:123], s[66:67]
    v_pk_mul_f32 v[124:125], v[124:125], s[66:67]
    v_pk_mul_f32 v[126:127], v[126:127], s[66:67]
    v_cvt_pk_bf16_f32 v32, v120, v121
    v_cvt_pk_bf16_f32 v33, v122, v123
    v_cvt_pk_bf16_f32 v34, v124, v125
    v_cvt_pk_bf16_f32 v35, v126, v127
    v_accvgpr_write_b32 a32, v32
    v_accvgpr_write_b32 a33, v33
    v_accvgpr_write_b32 a34, v34
    v_accvgpr_write_b32 a35, v35
    v_lshlrev_b32 v120, 16, v36
    v_and_b32 v121, 0xffff0000, v36
    v_lshlrev_b32 v122, 16, v37
    v_and_b32 v123, 0xffff0000, v37
    v_lshlrev_b32 v124, 16, v38
    v_and_b32 v125, 0xffff0000, v38
    v_lshlrev_b32 v126, 16, v39
    v_and_b32 v127, 0xffff0000, v39
    v_pk_mul_f32 v[120:121], v[120:121], s[66:67]
    v_pk_mul_f32 v[122:123], v[122:123], s[66:67]
    v_pk_mul_f32 v[124:125], v[124:125], s[66:67]
    v_pk_mul_f32 v[126:127], v[126:127], s[66:67]
    v_cvt_pk_bf16_f32 v36, v120, v121
    v_cvt_pk_bf16_f32 v37, v122, v123
    v_cvt_pk_bf16_f32 v38, v124, v125
    v_cvt_pk_bf16_f32 v39, v126, v127
    v_accvgpr_write_b32 a36, v36
    v_accvgpr_write_b32 a37, v37
    v_accvgpr_write_b32 a38, v38
    v_accvgpr_write_b32 a39, v39
    v_lshlrev_b32 v120, 16, v40
    v_and_b32 v121, 0xffff0000, v40
    v_lshlrev_b32 v122, 16, v41
    v_and_b32 v123, 0xffff0000, v41
    v_lshlrev_b32 v124, 16, v42
    v_and_b32 v125, 0xffff0000, v42
    v_lshlrev_b32 v126, 16, v43
    v_and_b32 v127, 0xffff0000, v43
    v_pk_mul_f32 v[120:121], v[120:121], s[66:67]
    v_pk_mul_f32 v[122:123], v[122:123], s[66:67]
    v_pk_mul_f32 v[124:125], v[124:125], s[66:67]
    v_pk_mul_f32 v[126:127], v[126:127], s[66:67]
    v_cvt_pk_bf16_f32 v40, v120, v121
    v_cvt_pk_bf16_f32 v41, v122, v123
    v_cvt_pk_bf16_f32 v42, v124, v125
    v_cvt_pk_bf16_f32 v43, v126, v127
    v_accvgpr_write_b32 a40, v40
    v_accvgpr_write_b32 a41, v41
    v_accvgpr_write_b32 a42, v42
    v_accvgpr_write_b32 a43, v43
    v_lshlrev_b32 v120, 16, v44
    v_and_b32 v121, 0xffff0000, v44
    v_lshlrev_b32 v122, 16, v45
    v_and_b32 v123, 0xffff0000, v45
    v_lshlrev_b32 v124, 16, v46
    v_and_b32 v125, 0xffff0000, v46
    v_lshlrev_b32 v126, 16, v47
    v_and_b32 v127, 0xffff0000, v47
    v_pk_mul_f32 v[120:121], v[120:121], s[66:67]
    v_pk_mul_f32 v[122:123], v[122:123], s[66:67]
    v_pk_mul_f32 v[124:125], v[124:125], s[66:67]
    v_pk_mul_f32 v[126:127], v[126:127], s[66:67]
    v_cvt_pk_bf16_f32 v44, v120, v121
    v_cvt_pk_bf16_f32 v45, v122, v123
    v_cvt_pk_bf16_f32 v46, v124, v125
    v_cvt_pk_bf16_f32 v47, v126, v127
    v_accvgpr_write_b32 a44, v44
    v_accvgpr_write_b32 a45, v45
    v_accvgpr_write_b32 a46, v46
    v_accvgpr_write_b32 a47, v47
    s_waitcnt vmcnt(4)
    s_barrier
    v_mfma_f32_16x16x32_bf16 v[32:35], a[64:67], a[32:35], 0
    v_exp_f32 v24, v24
    v_cvt_pk_bf16_f32 v75, v22, v23
    v_mfma_f32_16x16x32_bf16 v[32:35], a[68:71], a[36:39], v[32:35]
    v_exp_f32 v25, v25
    v_mfma_f32_16x16x32_bf16 v[32:35], a[72:75], a[40:43], v[32:35]
    v_exp_f32 v26, v26
    v_cvt_pk_bf16_f32 v76, v24, v25
    v_mfma_f32_16x16x32_bf16 v[32:35], a[76:79], a[44:47], v[32:35]
    v_exp_f32 v27, v27
    v_mfma_f32_16x16x32_bf16 v[36:39], a[92:95], a[44:47], 0
    v_exp_f32 v28, v28
    v_exp_f32 v29, v29
    v_exp_f32 v30, v30
    v_exp_f32 v31, v31
    v_cvt_pk_bf16_f32 v77, v26, v27
    v_mfma_f32_16x16x32_bf16 v[36:39], a[88:91], a[40:43], v[36:39]
    v_cvt_pk_bf16_f32 v78, v28, v29
    v_cvt_pk_bf16_f32 v79, v30, v31
    v_mfma_f32_16x16x32_bf16 v[36:39], a[84:87], a[36:39], v[36:39]
    ds_read_b64_tr_b16 a[128:129], v52 offset:0
    ds_read_b64_tr_b16 a[130:131], v52 offset:1024
    v_mfma_f32_16x16x32_bf16 v[36:39], a[80:83], a[32:35], v[36:39]
    ds_read_b64_tr_b16 a[132:133], v52 offset:2048
    ds_read_b64_tr_b16 a[134:135], v52 offset:3072
    v_mfma_f32_16x16x32_bf16 v[40:43], a[96:99], a[32:35], 0
    ds_read_b64_tr_b16 a[136:137], v53 offset:0
    ds_read_b64_tr_b16 a[138:139], v53 offset:1024
    v_mfma_f32_16x16x32_bf16 v[40:43], a[100:103], a[36:39], v[40:43]
    ds_read_b64_tr_b16 a[140:141], v53 offset:2048
    ds_read_b64_tr_b16 a[142:143], v53 offset:3072
    v_mfma_f32_16x16x32_bf16 v[40:43], a[104:107], a[40:43], v[40:43]
    ds_read_b64_tr_b16 a[144:145], v54 offset:0
    ds_read_b64_tr_b16 a[146:147], v54 offset:1024
    v_mfma_f32_16x16x32_bf16 v[40:43], a[108:111], a[44:47], v[40:43]
    ds_read_b64_tr_b16 a[148:149], v54 offset:2048
    ds_read_b64_tr_b16 a[150:151], v54 offset:3072
    v_mfma_f32_16x16x32_bf16 v[44:47], a[124:127], a[44:47], 0
    ds_read_b64_tr_b16 a[152:153], v55 offset:0
    ds_read_b64_tr_b16 a[154:155], v55 offset:1024
    v_mfma_f32_16x16x32_bf16 v[44:47], a[120:123], a[40:43], v[44:47]
    ds_read_b64_tr_b16 a[156:157], v55 offset:2048
    ds_read_b64_tr_b16 a[158:159], v55 offset:3072
    v_mfma_f32_16x16x32_bf16 v[44:47], a[116:119], a[36:39], v[44:47]
    ds_read_b64_tr_b16 a[160:161], v56 offset:0
    ds_read_b64_tr_b16 a[162:163], v56 offset:1024
    v_mfma_f32_16x16x32_bf16 v[44:47], a[112:115], a[32:35], v[44:47]
    s_waitcnt lgkmcnt(14)
    ds_read_b64_tr_b16 a[164:165], v56 offset:2048
    ds_read_b64_tr_b16 a[166:167], v56 offset:3072
    v_mfma_f32_16x16x32_bf16 v[128:131], a[128:131], v[64:67], 0
    s_add_u32 m0, s65, s97
    ds_read_b64_tr_b16 a[168:169], v57 offset:0
    ds_read_b64_tr_b16 a[170:171], v57 offset:1024
    v_mfma_f32_16x16x32_bf16 v[128:131], a[132:135], v[68:71], v[128:131]
    s_waitcnt lgkmcnt(14)
    buffer_load_dwordx4 v113, s[12:15], s44 offen offset:0 sc1 lds
    v_mfma_f32_16x16x32_bf16 v[132:135], a[136:139], v[64:67], 0
    ds_read_b64_tr_b16 a[172:173], v57 offset:2048
    ds_read_b64_tr_b16 a[174:175], v57 offset:3072
    v_mfma_f32_16x16x32_bf16 v[132:135], a[140:143], v[68:71], v[132:135]
    s_waitcnt lgkmcnt(12)
    ds_read_b64_tr_b16 a[176:177], v58 offset:0
    ds_read_b64_tr_b16 a[178:179], v58 offset:1024
    v_mfma_f32_16x16x32_bf16 v[136:139], a[144:147], v[64:67], 0
    ds_read_b64_tr_b16 a[180:181], v58 offset:2048
    ds_read_b64_tr_b16 a[182:183], v58 offset:3072
    v_mfma_f32_16x16x32_bf16 v[136:139], a[148:151], v[68:71], v[136:139]
    s_waitcnt lgkmcnt(12)
    ds_read_b64_tr_b16 a[184:185], v59 offset:0
    ds_read_b64_tr_b16 a[186:187], v59 offset:1024
    buffer_load_dwordx4 v113, s[12:15], s45 offen offset:1024 sc1 lds
    v_mfma_f32_16x16x32_bf16 v[140:143], a[152:155], v[64:67], 0
    ds_read_b64_tr_b16 a[188:189], v59 offset:2048
    ds_read_b64_tr_b16 a[190:191], v59 offset:3072
    v_mfma_f32_16x16x32_bf16 v[140:143], a[156:159], v[68:71], v[140:143]
    s_waitcnt lgkmcnt(12)
    v_exp_f32 v32, v32
    v_mfma_f32_16x16x32_bf16 v[144:147], a[160:163], v[64:67], 0
    v_exp_f32 v33, v33
    v_mfma_f32_16x16x32_bf16 v[144:147], a[164:167], v[68:71], v[144:147]
    s_waitcnt lgkmcnt(10)
    buffer_load_dwordx4 v113, s[12:15], s46 offen offset:2048 sc1 lds
    v_mfma_f32_16x16x32_bf16 v[148:151], a[168:171], v[64:67], 0
    s_waitcnt lgkmcnt(8)
    v_exp_f32 v34, v34
    v_mfma_f32_16x16x32_bf16 v[148:151], a[172:175], v[68:71], v[148:151]
    s_waitcnt lgkmcnt(6)
    v_exp_f32 v35, v35
    v_mfma_f32_16x16x32_bf16 v[152:155], a[176:179], v[64:67], 0
    s_waitcnt lgkmcnt(4)
    v_exp_f32 v36, v36
    v_mfma_f32_16x16x32_bf16 v[152:155], a[180:183], v[68:71], v[152:155]
    s_waitcnt lgkmcnt(2)
    buffer_load_dwordx4 v113, s[12:15], s47 offen offset:3072 sc1 lds
    v_mfma_f32_16x16x32_bf16 v[156:159], a[184:187], v[64:67], 0
    s_waitcnt lgkmcnt(0)
    v_exp_f32 v37, v37
    v_mfma_f32_16x16x32_bf16 v[156:159], a[188:191], v[68:71], v[156:159]
    v_exp_f32 v38, v38
    v_smfmac_f32_16x16x64_bf16 a[192:195], a[208:211], v[64:71], v114
    v_exp_f32 v39, v39
    s_waitcnt vmcnt(4)
    ds_read_b128 v[48:51], v92 offset:16384
    ds_read_b128 v[52:55], v93 offset:16384
    ds_read_b128 v[56:59], v94 offset:16384
    ds_read_b128 v[60:63], v95 offset:16384
    s_waitcnt lgkmcnt(0)
    v_lshlrev_b32 v120, 16, v48
    v_and_b32 v121, 0xffff0000, v48
    v_lshlrev_b32 v122, 16, v49
    v_and_b32 v123, 0xffff0000, v49
    v_lshlrev_b32 v124, 16, v50
    s_add_u32 m0, s64, s98
    s_nop 0
    buffer_load_dwordx4 v112, s[8:11], s48 offen offset:0 sc1 lds
    v_and_b32 v125, 0xffff0000, v50
    v_lshlrev_b32 v126, 16, v51
    v_and_b32 v127, 0xffff0000, v51
    v_pk_mul_f32 v[120:121], v[120:121], s[66:67]
    v_pk_mul_f32 v[122:123], v[122:123], s[66:67]
    v_pk_mul_f32 v[124:125], v[124:125], s[66:67]
    v_pk_mul_f32 v[126:127], v[126:127], s[66:67]
    v_cvt_pk_bf16_f32 v48, v120, v121
    v_cvt_pk_bf16_f32 v49, v122, v123
    v_cvt_pk_bf16_f32 v50, v124, v125
    buffer_load_dwordx4 v112, s[8:11], s49 offen offset:1024 sc1 lds
    v_cvt_pk_bf16_f32 v51, v126, v127
    v_accvgpr_write_b32 a48, v48
    v_accvgpr_write_b32 a49, v49
    v_accvgpr_write_b32 a50, v50
    v_accvgpr_write_b32 a51, v51
    v_lshlrev_b32 v120, 16, v52
    v_and_b32 v121, 0xffff0000, v52
    v_lshlrev_b32 v122, 16, v53
    v_and_b32 v123, 0xffff0000, v53
    v_lshlrev_b32 v124, 16, v54
    buffer_load_dwordx4 v112, s[8:11], s50 offen offset:2048 sc1 lds
    v_and_b32 v125, 0xffff0000, v54
    v_lshlrev_b32 v126, 16, v55
    v_and_b32 v127, 0xffff0000, v55
    v_pk_mul_f32 v[120:121], v[120:121], s[66:67]
    v_pk_mul_f32 v[122:123], v[122:123], s[66:67]
    v_pk_mul_f32 v[124:125], v[124:125], s[66:67]
    v_pk_mul_f32 v[126:127], v[126:127], s[66:67]
    v_cvt_pk_bf16_f32 v52, v120, v121
    v_cvt_pk_bf16_f32 v53, v122, v123
    v_cvt_pk_bf16_f32 v54, v124, v125
    buffer_load_dwordx4 v112, s[8:11], s51 offen offset:3072 sc1 lds
    v_cvt_pk_bf16_f32 v55, v126, v127
    v_accvgpr_write_b32 a52, v52
    v_accvgpr_write_b32 a53, v53
    v_accvgpr_write_b32 a54, v54
    v_accvgpr_write_b32 a55, v55
    v_lshlrev_b32 v120, 16, v56
    v_and_b32 v121, 0xffff0000, v56
    v_lshlrev_b32 v122, 16, v57
    v_and_b32 v123, 0xffff0000, v57
    v_lshlrev_b32 v124, 16, v58
    v_and_b32 v125, 0xffff0000, v58
    v_lshlrev_b32 v126, 16, v59
    v_and_b32 v127, 0xffff0000, v59
    v_pk_mul_f32 v[120:121], v[120:121], s[66:67]
    v_pk_mul_f32 v[122:123], v[122:123], s[66:67]
    v_pk_mul_f32 v[124:125], v[124:125], s[66:67]
    v_pk_mul_f32 v[126:127], v[126:127], s[66:67]
    v_cvt_pk_bf16_f32 v56, v120, v121
    v_cvt_pk_bf16_f32 v57, v122, v123
    v_cvt_pk_bf16_f32 v58, v124, v125
    v_cvt_pk_bf16_f32 v59, v126, v127
    v_accvgpr_write_b32 a56, v56
    v_accvgpr_write_b32 a57, v57
    v_accvgpr_write_b32 a58, v58
    v_accvgpr_write_b32 a59, v59
    v_lshlrev_b32 v120, 16, v60
    v_and_b32 v121, 0xffff0000, v60
    v_lshlrev_b32 v122, 16, v61
    v_and_b32 v123, 0xffff0000, v61
    v_lshlrev_b32 v124, 16, v62
    v_and_b32 v125, 0xffff0000, v62
    v_lshlrev_b32 v126, 16, v63
    v_and_b32 v127, 0xffff0000, v63
    v_pk_mul_f32 v[120:121], v[120:121], s[66:67]
    v_pk_mul_f32 v[122:123], v[122:123], s[66:67]
    v_pk_mul_f32 v[124:125], v[124:125], s[66:67]
    v_pk_mul_f32 v[126:127], v[126:127], s[66:67]
    v_cvt_pk_bf16_f32 v60, v120, v121
    v_cvt_pk_bf16_f32 v61, v122, v123
    v_cvt_pk_bf16_f32 v62, v124, v125
    v_cvt_pk_bf16_f32 v63, v126, v127
    v_accvgpr_write_b32 a60, v60
    v_accvgpr_write_b32 a61, v61
    v_accvgpr_write_b32 a62, v62
    v_accvgpr_write_b32 a63, v63
    v_add_u32 v120, s97, v96
    v_add_u32 v121, s97, v97
    v_add_u32 v122, s97, v98
    v_add_u32 v123, s97, v99
    v_mfma_f32_16x16x32_bf16 v[48:51], a[64:67], a[48:51], 0
    s_add_u32 m0, s65, s98
    v_exp_f32 v40, v40
    v_mfma_f32_16x16x32_bf16 v[48:51], a[68:71], a[52:55], v[48:51]
    s_nop 0
    buffer_load_dwordx4 v113, s[12:15], s48 offen offset:0 sc1 lds
    v_mfma_f32_16x16x32_bf16 v[48:51], a[72:75], a[56:59], v[48:51]
    ds_read_b128 a[64:67], v120 offset:0
    v_cvt_pk_bf16_f32 v80, v32, v33
    v_mfma_f32_16x16x32_bf16 v[48:51], a[76:79], a[60:63], v[48:51]
    ds_read_b128 a[68:71], v121 offset:0
    v_cvt_pk_bf16_f32 v81, v34, v35
    v_mfma_f32_16x16x32_bf16 v[52:55], a[92:95], a[60:63], 0
    v_exp_f32 v41, v41
    v_mfma_f32_16x16x32_bf16 v[52:55], a[88:91], a[56:59], v[52:55]
    s_nop 0
    buffer_load_dwordx4 v113, s[12:15], s49 offen offset:1024 sc1 lds
    v_mfma_f32_16x16x32_bf16 v[52:55], a[84:87], a[52:55], v[52:55]
    ds_read_b128 a[72:75], v122 offset:0
    v_cvt_pk_bf16_f32 v82, v36, v37
    v_mfma_f32_16x16x32_bf16 v[52:55], a[80:83], a[48:51], v[52:55]
    ds_read_b128 a[76:79], v123 offset:0
    v_cvt_pk_bf16_f32 v83, v38, v39
    v_mfma_f32_16x16x32_bf16 v[56:59], a[96:99], a[48:51], 0
    v_exp_f32 v48, v48
    v_mfma_f32_16x16x32_bf16 v[56:59], a[100:103], a[52:55], v[56:59]
    v_exp_f32 v49, v49
    buffer_load_dwordx4 v113, s[12:15], s50 offen offset:2048 sc1 lds
    v_mfma_f32_16x16x32_bf16 v[56:59], a[104:107], a[56:59], v[56:59]
    v_exp_f32 v50, v50
    v_mfma_f32_16x16x32_bf16 v[56:59], a[108:111], a[60:63], v[56:59]
    v_exp_f32 v51, v51
    v_mfma_f32_16x16x32_bf16 v[60:63], a[124:127], a[60:63], 0
    v_exp_f32 v52, v52
    v_mfma_f32_16x16x32_bf16 v[60:63], a[120:123], a[56:59], v[60:63]
    v_exp_f32 v53, v53
    buffer_load_dwordx4 v113, s[12:15], s51 offen offset:3072 sc1 lds
    v_mfma_f32_16x16x32_bf16 v[60:63], a[116:119], a[52:55], v[60:63]
    v_exp_f32 v54, v54
    v_mfma_f32_16x16x32_bf16 v[60:63], a[112:115], a[48:51], v[60:63]
    v_exp_f32 v55, v55
    v_mfma_f32_16x16x32_bf16 v[160:163], a[128:131], v[72:75], 0
    s_add_u32 m0, s64, s99
    v_exp_f32 v56, v56
    v_mfma_f32_16x16x32_bf16 v[160:163], a[132:135], v[76:79], v[160:163]
    s_nop 0
    buffer_load_dwordx4 v112, s[8:11], s52 offen offset:0 sc1 lds
    v_mfma_f32_16x16x32_bf16 v[164:167], a[136:139], v[72:75], 0
    v_exp_f32 v57, v57
    v_mfma_f32_16x16x32_bf16 v[164:167], a[140:143], v[76:79], v[164:167]
    v_exp_f32 v42, v42
    v_mfma_f32_16x16x32_bf16 v[168:171], a[144:147], v[72:75], 0
    ds_read_b128 a[80:83], v120 offset:1024
    v_cvt_pk_bf16_f32 v88, v48, v49
    v_mfma_f32_16x16x32_bf16 v[168:171], a[148:151], v[76:79], v[168:171]
    s_nop 0
    buffer_load_dwordx4 v112, s[8:11], s53 offen offset:1024 sc1 lds
    v_mfma_f32_16x16x32_bf16 v[172:175], a[152:155], v[72:75], 0
    ds_read_b128 a[84:87], v121 offset:1024
    v_cvt_pk_bf16_f32 v89, v50, v51
    v_mfma_f32_16x16x32_bf16 v[172:175], a[156:159], v[76:79], v[172:175]
    ds_read_b128 a[88:91], v122 offset:1024
    v_exp_f32 v43, v43
    v_mfma_f32_16x16x32_bf16 v[176:179], a[160:163], v[72:75], 0
    ds_read_b128 a[92:95], v123 offset:1024
    v_cvt_pk_bf16_f32 v90, v52, v53
    v_mfma_f32_16x16x32_bf16 v[176:179], a[164:167], v[76:79], v[176:179]
    ds_read_b128 a[96:99], v120 offset:2048
    v_exp_f32 v44, v44
    buffer_load_dwordx4 v112, s[8:11], s54 offen offset:2048 sc1 lds
    v_mfma_f32_16x16x32_bf16 v[180:183], a[168:171], v[72:75], 0
    ds_read_b128 a[100:103], v121 offset:2048
    v_cvt_pk_bf16_f32 v91, v54, v55
    v_mfma_f32_16x16x32_bf16 v[180:183], a[172:175], v[76:79], v[180:183]
    ds_read_b128 a[104:107], v122 offset:2048
    v_exp_f32 v45, v45
    v_mfma_f32_16x16x32_bf16 v[184:187], a[176:179], v[72:75], 0
    ds_read_b128 a[108:111], v123 offset:2048
    v_cvt_pk_bf16_f32 v84, v40, v41
    v_mfma_f32_16x16x32_bf16 v[184:187], a[180:183], v[76:79], v[184:187]
    ds_read_b128 a[112:115], v120 offset:3072
    v_exp_f32 v46, v46
    buffer_load_dwordx4 v112, s[8:11], s55 offen offset:3072 sc1 lds
    v_cvt_pk_bf16_f32 v92, v56, v57
    v_mfma_f32_16x16x32_bf16 v[188:191], a[184:187], v[72:75], 0
    ds_read_b128 a[116:119], v121 offset:3072
    v_cvt_pk_bf16_f32 v85, v42, v43
    v_mfma_f32_16x16x32_bf16 v[188:191], a[188:191], v[76:79], v[188:191]
    ds_read_b128 a[120:123], v122 offset:3072
    v_exp_f32 v47, v47
    v_cvt_pk_bf16_f32 v86, v44, v45
    v_smfmac_f32_16x16x64_bf16 a[196:199], a[208:211], v[72:79], v114
    ds_read_b128 a[124:127], v123 offset:3072
    v_cvt_pk_bf16_f32 v87, v46, v47
    s_waitcnt lgkmcnt(4)
    s_cmp_eq_u32 s69, 1
    s_cbranch_scc1 L_b2
    s_cmp_eq_u32 s69, 2
    s_cbranch_scc1 L_b3
    s_cmp_eq_u32 s69, 3
    s_cbranch_scc1 L_b0
    s_cmp_eq_u32 s75, 4
    s_cbranch_scc1 L_tail
.p2align 6
L_b1:
    v_mfma_f32_16x16x32_bf16 v[0:3], a[64:67], a[0:3], 0
    v_exp_f32 v58, v58
    v_mfma_f32_16x16x32_bf16 v[0:3], a[68:71], a[4:7], v[0:3]
    s_add_u32 m0, s65, 49152
    v_mfma_f32_16x16x32_bf16 v[0:3], a[72:75], a[8:11], v[0:3]
    v_exp_f32 v59, v59
    v_mfma_f32_16x16x32_bf16 v[0:3], a[76:79], a[12:15], v[0:3]
    s_nop 0
    buffer_load_dwordx4 v113, s[12:15], s60 offen offset:0 sc1 lds
    v_mfma_f32_16x16x32_bf16 v[16:19], a[76:79], a[28:31], 0
    v_exp_f32 v60, v60
    v_mfma_f32_16x16x32_bf16 v[16:19], a[72:75], a[24:27], v[16:19]
    v_cvt_pk_bf16_f32 v93, v58, v59
    v_mfma_f32_16x16x32_bf16 v[16:19], a[68:71], a[20:23], v[16:19]
    v_exp_f32 v61, v61
    v_mfma_f32_16x16x32_bf16 v[16:19], a[64:67], a[16:19], v[16:19]
    s_nop 0
    buffer_load_dwordx4 v113, s[12:15], s61 offen offset:1024 sc1 lds
    v_mfma_f32_16x16x32_bf16 v[20:23], a[80:83], a[16:19], 0
    v_exp_f32 v62, v62
    v_mfma_f32_16x16x32_bf16 v[20:23], a[84:87], a[20:23], v[20:23]
    v_cvt_pk_bf16_f32 v94, v60, v61
    v_mfma_f32_16x16x32_bf16 v[20:23], a[88:91], a[24:27], v[20:23]
    v_exp_f32 v63, v63
    v_mfma_f32_16x16x32_bf16 v[20:23], a[92:95], a[28:31], v[20:23]
    v_cvt_pk_bf16_f32 v95, v62, v63
    v_mfma_f32_16x16x32_bf16 v[4:7], a[92:95], a[12:15], 0
    s_nop 0
    buffer_load_dwordx4 v113, s[12:15], s62 offen offset:2048 sc1 lds
    v_mfma_f32_16x16x32_bf16 v[4:7], a[88:91], a[8:11], v[4:7]
    v_exp_f32 v0, v0
    v_mfma_f32_16x16x32_bf16 v[4:7], a[84:87], a[4:7], v[4:7]
    v_mfma_f32_16x16x32_bf16 v[4:7], a[80:83], a[0:3], v[4:7]
    v_exp_f32 v1, v1
    v_mfma_f32_16x16x32_bf16 v[8:11], a[96:99], a[0:3], 0
    s_nop 0
    buffer_load_dwordx4 v113, s[12:15], s63 offen offset:3072 sc1 lds
    v_mfma_f32_16x16x32_bf16 v[8:11], a[100:103], a[4:7], v[8:11]
    v_exp_f32 v2, v2
    v_mfma_f32_16x16x32_bf16 v[8:11], a[104:107], a[8:11], v[8:11]
    s_add_u32 m0, s64, 0
    v_cvt_pk_bf16_f32 v64, v0, v1
    v_mfma_f32_16x16x32_bf16 v[8:11], a[108:111], a[12:15], v[8:11]
    v_exp_f32 v3, v3
    v_mfma_f32_16x16x32_bf16 v[24:27], a[108:111], a[28:31], 0
    s_nop 0
    buffer_load_dwordx4 v112, s[8:11], s56 offen offset:0 sc1 lds
    v_mfma_f32_16x16x32_bf16 v[24:27], a[104:107], a[24:27], v[24:27]
    v_exp_f32 v4, v4
    v_mfma_f32_16x16x32_bf16 v[24:27], a[100:103], a[20:23], v[24:27]
    v_cvt_pk_bf16_f32 v65, v2, v3
    v_mfma_f32_16x16x32_bf16 v[24:27], a[96:99], a[16:19], v[24:27]
    s_waitcnt lgkmcnt(0)
    v_exp_f32 v5, v5
    v_mfma_f32_16x16x32_bf16 v[28:31], a[112:115], a[16:19], 0
    s_nop 0
    buffer_load_dwordx4 v112, s[8:11], s57 offen offset:1024 sc1 lds
    v_mfma_f32_16x16x32_bf16 v[28:31], a[116:119], a[20:23], v[28:31]
    v_exp_f32 v6, v6
    v_mfma_f32_16x16x32_bf16 v[28:31], a[120:123], a[24:27], v[28:31]
    v_cvt_pk_bf16_f32 v66, v4, v5
    v_mfma_f32_16x16x32_bf16 v[28:31], a[124:127], a[28:31], v[28:31]
    v_exp_f32 v7, v7
    v_mfma_f32_16x16x32_bf16 v[12:15], a[124:127], a[12:15], 0
    s_nop 0
    buffer_load_dwordx4 v112, s[8:11], s58 offen offset:2048 sc1 lds
    v_mfma_f32_16x16x32_bf16 v[12:15], a[120:123], a[8:11], v[12:15]
    v_exp_f32 v8, v8
    v_mfma_f32_16x16x32_bf16 v[12:15], a[116:119], a[4:7], v[12:15]
    v_cvt_pk_bf16_f32 v67, v6, v7
    v_mfma_f32_16x16x32_bf16 v[12:15], a[112:115], a[0:3], v[12:15]
    v_exp_f32 v9, v9
    v_mfma_f32_16x16x32_bf16 v[192:195], a[128:131], v[80:83], v[192:195]
    s_nop 0
    buffer_load_dwordx4 v112, s[8:11], s59 offen offset:3072 sc1 lds
    v_mfma_f32_16x16x32_bf16 v[192:195], a[132:135], v[84:87], v[192:195]
    v_exp_f32 v10, v10
    v_mfma_f32_16x16x32_bf16 v[224:227], a[132:135], v[92:95], v[224:227]
    v_cvt_pk_bf16_f32 v68, v8, v9
    v_mfma_f32_16x16x32_bf16 v[224:227], a[128:131], v[88:91], v[224:227]
    v_exp_f32 v11, v11
    v_mfma_f32_16x16x32_bf16 v[228:231], a[136:139], v[88:91], v[228:231]
    v_cvt_pk_bf16_f32 v69, v10, v11
    v_mfma_f32_16x16x32_bf16 v[228:231], a[140:143], v[92:95], v[228:231]
    v_exp_f32 v12, v12
    v_mfma_f32_16x16x32_bf16 v[196:199], a[140:143], v[84:87], v[196:199]
    v_mfma_f32_16x16x32_bf16 v[196:199], a[136:139], v[80:83], v[196:199]
    s_waitcnt vmcnt(16)
    v_exp_f32 v13, v13
    v_mfma_f32_16x16x32_bf16 v[200:203], a[144:147], v[80:83], v[200:203]
    s_barrier
    v_mfma_f32_16x16x32_bf16 v[200:203], a[148:151], v[84:87], v[200:203]
    v_exp_f32 v14, v14
    v_mfma_f32_16x16x32_bf16 v[232:235], a[148:151], v[92:95], v[232:235]
    ds_read_b64_tr_b16 a[128:129], v100 offset:16384
    v_cvt_pk_bf16_f32 v70, v12, v13
    v_mfma_f32_16x16x32_bf16 v[232:235], a[144:147], v[88:91], v[232:235]
    v_exp_f32 v15, v15
    v_mfma_f32_16x16x32_bf16 v[236:239], a[152:155], v[88:91], v[236:239]
    ds_read_b64_tr_b16 a[130:131], v100 offset:17408
    v_cvt_pk_bf16_f32 v71, v14, v15
    v_mfma_f32_16x16x32_bf16 v[236:239], a[156:159], v[92:95], v[236:239]
    ds_read_b64_tr_b16 a[132:133], v100 offset:18432
    v_mfma_f32_16x16x32_bf16 v[204:207], a[156:159], v[84:87], v[204:207]
    v_exp_f32 v16, v16
    v_mfma_f32_16x16x32_bf16 v[204:207], a[152:155], v[80:83], v[204:207]
    ds_read_b64_tr_b16 a[134:135], v100 offset:19456
    v_smfmac_f32_16x16x64_bf16 a[200:203], a[208:211], v[80:87], v114
    v_exp_f32 v17, v17
    v_mfma_f32_16x16x32_bf16 v[208:211], a[160:163], v[80:83], v[208:211]
    ds_read_b64_tr_b16 a[136:137], v101 offset:16384
    v_cvt_pk_bf16_f32 v72, v16, v17
    v_mfma_f32_16x16x32_bf16 v[208:211], a[164:167], v[84:87], v[208:211]
    v_exp_f32 v18, v18
    v_mfma_f32_16x16x32_bf16 v[240:243], a[164:167], v[92:95], v[240:243]
    ds_read_b64_tr_b16 a[140:141], v101 offset:18432
    ds_read_b64_tr_b16 a[138:139], v101 offset:17408
    v_mfma_f32_16x16x32_bf16 v[240:243], a[160:163], v[88:91], v[240:243]
    v_exp_f32 v19, v19
    v_mfma_f32_16x16x32_bf16 v[244:247], a[168:171], v[88:91], v[244:247]
    ds_read_b64_tr_b16 a[142:143], v101 offset:19456
    v_cvt_pk_bf16_f32 v73, v18, v19
    v_mfma_f32_16x16x32_bf16 v[244:247], a[172:175], v[92:95], v[244:247]
    v_exp_f32 v20, v20
    v_mfma_f32_16x16x32_bf16 v[212:215], a[172:175], v[84:87], v[212:215]
    ds_read_b64_tr_b16 a[144:145], v102 offset:16384
    ds_read_b64_tr_b16 a[146:147], v102 offset:17408
    v_mfma_f32_16x16x32_bf16 v[212:215], a[168:171], v[80:83], v[212:215]
    v_exp_f32 v21, v21
    v_mfma_f32_16x16x32_bf16 v[216:219], a[176:179], v[80:83], v[216:219]
    ds_read_b64_tr_b16 a[148:149], v102 offset:18432
    v_cvt_pk_bf16_f32 v74, v20, v21
    v_mfma_f32_16x16x32_bf16 v[216:219], a[180:183], v[84:87], v[216:219]
    v_exp_f32 v22, v22
    v_mfma_f32_16x16x32_bf16 v[248:251], a[180:183], v[92:95], v[248:251]
    ds_read_b64_tr_b16 a[150:151], v102 offset:19456
    v_mfma_f32_16x16x32_bf16 v[248:251], a[176:179], v[88:91], v[248:251]
    s_add_u32 s39, s39, 1
    v_exp_f32 v23, v23
    v_mfma_f32_16x16x32_bf16 v[252:255], a[184:187], v[88:91], v[252:255]
    ds_read_b64_tr_b16 a[152:153], v103 offset:16384
    v_cvt_pk_bf16_f32 v75, v22, v23
    v_mfma_f32_16x16x32_bf16 v[252:255], a[188:191], v[92:95], v[252:255]
    v_exp_f32 v24, v24
    v_mfma_f32_16x16x32_bf16 v[220:223], a[188:191], v[84:87], v[220:223]
    ds_read_b64_tr_b16 a[156:157], v103 offset:18432
    ds_read_b64_tr_b16 a[154:155], v103 offset:17408
    v_mfma_f32_16x16x32_bf16 v[220:223], a[184:187], v[80:83], v[220:223]
    v_exp_f32 v25, v25
    v_smfmac_f32_16x16x64_bf16 a[204:207], a[208:211], v[88:95], v114
    ds_read_b64_tr_b16 a[158:159], v103 offset:19456
    v_cvt_pk_bf16_f32 v76, v24, v25
    v_mfma_f32_16x16x32_bf16 v[32:35], a[64:67], a[32:35], 0
    v_exp_f32 v26, v26
    v_mfma_f32_16x16x32_bf16 v[32:35], a[68:71], a[36:39], v[32:35]
    ds_read_b64_tr_b16 a[160:161], v104 offset:16384
    ds_read_b64_tr_b16 a[162:163], v104 offset:17408
    v_mfma_f32_16x16x32_bf16 v[32:35], a[72:75], a[40:43], v[32:35]
    v_exp_f32 v27, v27
    v_mfma_f32_16x16x32_bf16 v[32:35], a[76:79], a[44:47], v[32:35]
    ds_read_b64_tr_b16 a[164:165], v104 offset:18432
    v_cvt_pk_bf16_f32 v77, v26, v27
    v_mfma_f32_16x16x32_bf16 v[48:51], a[76:79], a[60:63], 0
    v_exp_f32 v28, v28
    v_mfma_f32_16x16x32_bf16 v[48:51], a[72:75], a[56:59], v[48:51]
    ds_read_b64_tr_b16 a[166:167], v104 offset:19456
    v_mfma_f32_16x16x32_bf16 v[48:51], a[68:71], a[52:55], v[48:51]
    v_exp_f32 v29, v29
    v_mfma_f32_16x16x32_bf16 v[48:51], a[64:67], a[48:51], v[48:51]
    ds_read_b64_tr_b16 a[168:169], v105 offset:16384
    v_cvt_pk_bf16_f32 v78, v28, v29
    v_mfma_f32_16x16x32_bf16 v[52:55], a[80:83], a[48:51], 0
    v_exp_f32 v30, v30
    v_mfma_f32_16x16x32_bf16 v[52:55], a[84:87], a[52:55], v[52:55]
    ds_read_b64_tr_b16 a[172:173], v105 offset:18432
    ds_read_b64_tr_b16 a[170:171], v105 offset:17408
    v_mfma_f32_16x16x32_bf16 v[52:55], a[88:91], a[56:59], v[52:55]
    v_exp_f32 v31, v31
    v_mfma_f32_16x16x32_bf16 v[52:55], a[92:95], a[60:63], v[52:55]
    ds_read_b64_tr_b16 a[174:175], v105 offset:19456
    v_cvt_pk_bf16_f32 v79, v30, v31
    v_mfma_f32_16x16x32_bf16 v[36:39], a[92:95], a[44:47], 0
    ds_read_b64_tr_b16 a[176:177], v106 offset:16384
    v_mfma_f32_16x16x32_bf16 v[36:39], a[88:91], a[40:43], v[36:39]
    v_exp_f32 v32, v32
    v_mfma_f32_16x16x32_bf16 v[36:39], a[84:87], a[36:39], v[36:39]
    ds_read_b64_tr_b16 a[178:179], v106 offset:17408
    v_mfma_f32_16x16x32_bf16 v[36:39], a[80:83], a[32:35], v[36:39]
    v_exp_f32 v33, v33
    v_mfma_f32_16x16x32_bf16 v[40:43], a[96:99], a[32:35], 0
    ds_read_b64_tr_b16 a[180:181], v106 offset:18432
    v_cvt_pk_bf16_f32 v80, v32, v33
    v_mfma_f32_16x16x32_bf16 v[40:43], a[100:103], a[36:39], v[40:43]
    v_exp_f32 v34, v34
    v_mfma_f32_16x16x32_bf16 v[40:43], a[104:107], a[40:43], v[40:43]
    ds_read_b64_tr_b16 a[182:183], v106 offset:19456
    ds_read_b64_tr_b16 a[184:185], v107 offset:16384
    v_mfma_f32_16x16x32_bf16 v[40:43], a[108:111], a[44:47], v[40:43]
    v_exp_f32 v35, v35
    v_mfma_f32_16x16x32_bf16 v[56:59], a[108:111], a[60:63], 0
    ds_read_b64_tr_b16 a[186:187], v107 offset:17408
    v_cvt_pk_bf16_f32 v81, v34, v35
    v_mfma_f32_16x16x32_bf16 v[56:59], a[104:107], a[56:59], v[56:59]
    v_exp_f32 v36, v36
    v_mfma_f32_16x16x32_bf16 v[56:59], a[100:103], a[52:55], v[56:59]
    v_readlane_b32 s60, v108, s39
    v_mfma_f32_16x16x32_bf16 v[56:59], a[96:99], a[48:51], v[56:59]
    v_exp_f32 v37, v37
    v_mfma_f32_16x16x32_bf16 v[60:63], a[112:115], a[48:51], 0
    ds_read_b128 a[64:67], v96 offset:32768
    v_cvt_pk_bf16_f32 v82, v36, v37
    v_mfma_f32_16x16x32_bf16 v[60:63], a[116:119], a[52:55], v[60:63]
    v_exp_f32 v38, v38
    v_mfma_f32_16x16x32_bf16 v[60:63], a[120:123], a[56:59], v[60:63]
    ds_read_b128 a[68:71], v97 offset:32768
    ds_read_b64_tr_b16 a[188:189], v107 offset:18432
    v_mfma_f32_16x16x32_bf16 v[60:63], a[124:127], a[60:63], v[60:63]
    v_exp_f32 v39, v39
    v_mfma_f32_16x16x32_bf16 v[44:47], a[124:127], a[44:47], 0
    ds_read_b128 a[72:75], v98 offset:32768
    v_cvt_pk_bf16_f32 v83, v38, v39
    v_mfma_f32_16x16x32_bf16 v[44:47], a[120:123], a[40:43], v[44:47]
    v_exp_f32 v40, v40
    v_mfma_f32_16x16x32_bf16 v[44:47], a[116:119], a[36:39], v[44:47]
    ds_read_b128 a[76:79], v99 offset:32768
    ds_read_b64_tr_b16 a[190:191], v107 offset:19456
    v_mfma_f32_16x16x32_bf16 v[44:47], a[112:115], a[32:35], v[44:47]
    s_waitcnt lgkmcnt(6)
    v_exp_f32 v41, v41
    v_mfma_f32_16x16x32_bf16 v[128:131], a[128:131], v[64:67], v[128:131]
    ds_read_b128 a[80:83], v96 offset:33792
    v_cvt_pk_bf16_f32 v84, v40, v41
    v_mfma_f32_16x16x32_bf16 v[128:131], a[132:135], v[68:71], v[128:131]
    v_exp_f32 v42, v42
    v_mfma_f32_16x16x32_bf16 v[160:163], a[132:135], v[76:79], v[160:163]
    ds_read_b128 a[84:87], v97 offset:33792
    v_mfma_f32_16x16x32_bf16 v[160:163], a[128:131], v[72:75], v[160:163]
    v_exp_f32 v43, v43
    v_mfma_f32_16x16x32_bf16 v[164:167], a[136:139], v[72:75], v[164:167]
    ds_read_b128 a[88:91], v98 offset:33792
    v_cvt_pk_bf16_f32 v85, v42, v43
    v_mfma_f32_16x16x32_bf16 v[164:167], a[140:143], v[76:79], v[164:167]
    v_exp_f32 v44, v44
    v_mfma_f32_16x16x32_bf16 v[132:135], a[140:143], v[68:71], v[132:135]
    ds_read_b128 a[92:95], v99 offset:33792
    v_mfma_f32_16x16x32_bf16 v[132:135], a[136:139], v[64:67], v[132:135]
    v_exp_f32 v45, v45
    v_mfma_f32_16x16x32_bf16 v[136:139], a[144:147], v[64:67], v[136:139]
    ds_read_b128 a[96:99], v96 offset:34816
    v_cvt_pk_bf16_f32 v86, v44, v45
    v_mfma_f32_16x16x32_bf16 v[136:139], a[148:151], v[68:71], v[136:139]
    v_exp_f32 v46, v46
    v_mfma_f32_16x16x32_bf16 v[168:171], a[148:151], v[76:79], v[168:171]
    ds_read_b128 a[100:103], v97 offset:34816
    v_mfma_f32_16x16x32_bf16 v[168:171], a[144:147], v[72:75], v[168:171]
    v_exp_f32 v47, v47
    v_mfma_f32_16x16x32_bf16 v[172:175], a[152:155], v[72:75], v[172:175]
    ds_read_b128 a[104:107], v98 offset:34816
    v_cvt_pk_bf16_f32 v87, v46, v47
    v_mfma_f32_16x16x32_bf16 v[172:175], a[156:159], v[76:79], v[172:175]
    v_readlane_b32 s61, v109, s39
    v_mfma_f32_16x16x32_bf16 v[140:143], a[156:159], v[68:71], v[140:143]
    v_exp_f32 v48, v48
    v_mfma_f32_16x16x32_bf16 v[140:143], a[152:155], v[64:67], v[140:143]
    ds_read_b128 a[108:111], v99 offset:34816
    v_smfmac_f32_16x16x64_bf16 a[192:195], a[208:211], v[64:71], v114
    v_exp_f32 v49, v49
    v_mfma_f32_16x16x32_bf16 v[144:147], a[160:163], v[64:67], v[144:147]
    ds_read_b128 a[112:115], v96 offset:35840
    v_cvt_pk_bf16_f32 v88, v48, v49
    v_mfma_f32_16x16x32_bf16 v[144:147], a[164:167], v[68:71], v[144:147]
    v_exp_f32 v50, v50
    v_mfma_f32_16x16x32_bf16 v[176:179], a[164:167], v[76:79], v[176:179]
    ds_read_b128 a[116:119], v97 offset:35840
    v_mfma_f32_16x16x32_bf16 v[176:179], a[160:163], v[72:75], v[176:179]
    v_exp_f32 v51, v51
    v_mfma_f32_16x16x32_bf16 v[180:183], a[168:171], v[72:75], v[180:183]
    ds_read_b128 a[120:123], v98 offset:35840
    v_cvt_pk_bf16_f32 v89, v50, v51
    v_mfma_f32_16x16x32_bf16 v[180:183], a[172:175], v[76:79], v[180:183]
    v_exp_f32 v52, v52
    v_mfma_f32_16x16x32_bf16 v[148:151], a[172:175], v[68:71], v[148:151]
    ds_read_b128 a[124:127], v99 offset:35840
    v_mfma_f32_16x16x32_bf16 v[148:151], a[168:171], v[64:67], v[148:151]
    v_exp_f32 v53, v53
    v_mfma_f32_16x16x32_bf16 v[152:155], a[176:179], v[64:67], v[152:155]
    v_cvt_pk_bf16_f32 v90, v52, v53
    v_mfma_f32_16x16x32_bf16 v[152:155], a[180:183], v[68:71], v[152:155]
    v_exp_f32 v54, v54
    v_mfma_f32_16x16x32_bf16 v[184:187], a[180:183], v[76:79], v[184:187]
    v_readlane_b32 s62, v110, s39
    v_mfma_f32_16x16x32_bf16 v[184:187], a[176:179], v[72:75], v[184:187]
    v_exp_f32 v55, v55
    v_mfma_f32_16x16x32_bf16 v[188:191], a[184:187], v[72:75], v[188:191]
    s_waitcnt lgkmcnt(1)
    v_cvt_pk_bf16_f32 v91, v54, v55
    v_mfma_f32_16x16x32_bf16 v[188:191], a[188:191], v[76:79], v[188:191]
    v_exp_f32 v56, v56
    v_mfma_f32_16x16x32_bf16 v[156:159], a[188:191], v[68:71], v[156:159]
    v_readlane_b32 s63, v111, s39
    v_mfma_f32_16x16x32_bf16 v[156:159], a[184:187], v[64:67], v[156:159]
    s_waitcnt lgkmcnt(4)
    v_exp_f32 v57, v57
    v_smfmac_f32_16x16x64_bf16 a[196:199], a[208:211], v[72:79], v114
    v_cvt_pk_bf16_f32 v92, v56, v57
L_b2:
    v_mfma_f32_16x16x32_bf16 v[0:3], a[64:67], a[0:3], 0
    v_exp_f32 v58, v58
    v_mfma_f32_16x16x32_bf16 v[0:3], a[68:71], a[4:7], v[0:3]
    s_add_u32 m0, s65, 0
    v_mfma_f32_16x16x32_bf16 v[0:3], a[72:75], a[8:11], v[0:3]
    v_exp_f32 v59, v59
    v_mfma_f32_16x16x32_bf16 v[0:3], a[76:79], a[12:15], v[0:3]
    s_nop 0
    buffer_load_dwordx4 v113, s[12:15], s56 offen offset:0 sc1 lds
    v_mfma_f32_16x16x32_bf16 v[16:19], a[76:79], a[28:31], 0
    v_exp_f32 v60, v60
    v_mfma_f32_16x16x32_bf16 v[16:19], a[72:75], a[24:27], v[16:19]
    v_cvt_pk_bf16_f32 v93, v58, v59
    v_mfma_f32_16x16x32_bf16 v[16:19], a[68:71], a[20:23], v[16:19]
    v_exp_f32 v61, v61
    v_mfma_f32_16x16x32_bf16 v[16:19], a[64:67], a[16:19], v[16:19]
    s_nop 0
    buffer_load_dwordx4 v113, s[12:15], s57 offen offset:1024 sc1 lds
    v_mfma_f32_16x16x32_bf16 v[20:23], a[80:83], a[16:19], 0
    v_exp_f32 v62, v62
    v_mfma_f32_16x16x32_bf16 v[20:23], a[84:87], a[20:23], v[20:23]
    v_cvt_pk_bf16_f32 v94, v60, v61
    v_mfma_f32_16x16x32_bf16 v[20:23], a[88:91], a[24:27], v[20:23]
    v_exp_f32 v63, v63
    v_mfma_f32_16x16x32_bf16 v[20:23], a[92:95], a[28:31], v[20:23]
    v_cvt_pk_bf16_f32 v95, v62, v63
    v_mfma_f32_16x16x32_bf16 v[4:7], a[92:95], a[12:15], 0
    s_nop 0
    buffer_load_dwordx4 v113, s[12:15], s58 offen offset:2048 sc1 lds
    v_mfma_f32_16x16x32_bf16 v[4:7], a[88:91], a[8:11], v[4:7]
    v_exp_f32 v0, v0
    v_mfma_f32_16x16x32_bf16 v[4:7], a[84:87], a[4:7], v[4:7]
    v_mfma_f32_16x16x32_bf16 v[4:7], a[80:83], a[0:3], v[4:7]
    v_exp_f32 v1, v1
    v_mfma_f32_16x16x32_bf16 v[8:11], a[96:99], a[0:3], 0
    s_nop 0
    buffer_load_dwordx4 v113, s[12:15], s59 offen offset:3072 sc1 lds
    v_mfma_f32_16x16x32_bf16 v[8:11], a[100:103], a[4:7], v[8:11]
    v_exp_f32 v2, v2
    v_mfma_f32_16x16x32_bf16 v[8:11], a[104:107], a[8:11], v[8:11]
    s_add_u32 m0, s64, 16384
    v_cvt_pk_bf16_f32 v64, v0, v1
    v_mfma_f32_16x16x32_bf16 v[8:11], a[108:111], a[12:15], v[8:11]
    v_exp_f32 v3, v3
    v_mfma_f32_16x16x32_bf16 v[24:27], a[108:111], a[28:31], 0
    s_nop 0
    buffer_load_dwordx4 v112, s[8:11], s60 offen offset:0 sc1 lds
    v_mfma_f32_16x16x32_bf16 v[24:27], a[104:107], a[24:27], v[24:27]
    v_exp_f32 v4, v4
    v_mfma_f32_16x16x32_bf16 v[24:27], a[100:103], a[20:23], v[24:27]
    v_cvt_pk_bf16_f32 v65, v2, v3
    v_mfma_f32_16x16x32_bf16 v[24:27], a[96:99], a[16:19], v[24:27]
    s_waitcnt lgkmcnt(0)
    v_exp_f32 v5, v5
    v_mfma_f32_16x16x32_bf16 v[28:31], a[112:115], a[16:19], 0
    s_nop 0
    buffer_load_dwordx4 v112, s[8:11], s61 offen offset:1024 sc1 lds
    v_mfma_f32_16x16x32_bf16 v[28:31], a[116:119], a[20:23], v[28:31]
    v_exp_f32 v6, v6
    v_mfma_f32_16x16x32_bf16 v[28:31], a[120:123], a[24:27], v[28:31]
    v_cvt_pk_bf16_f32 v66, v4, v5
    v_mfma_f32_16x16x32_bf16 v[28:31], a[124:127], a[28:31], v[28:31]
    v_exp_f32 v7, v7
    v_mfma_f32_16x16x32_bf16 v[12:15], a[124:127], a[12:15], 0
    s_nop 0
    buffer_load_dwordx4 v112, s[8:11], s62 offen offset:2048 sc1 lds
    v_mfma_f32_16x16x32_bf16 v[12:15], a[120:123], a[8:11], v[12:15]
    v_exp_f32 v8, v8
    v_mfma_f32_16x16x32_bf16 v[12:15], a[116:119], a[4:7], v[12:15]
    v_cvt_pk_bf16_f32 v67, v6, v7
    v_mfma_f32_16x16x32_bf16 v[12:15], a[112:115], a[0:3], v[12:15]
    v_exp_f32 v9, v9
    v_mfma_f32_16x16x32_bf16 v[192:195], a[128:131], v[80:83], v[192:195]
    s_nop 0
    buffer_load_dwordx4 v112, s[8:11], s63 offen offset:3072 sc1 lds
    v_mfma_f32_16x16x32_bf16 v[192:195], a[132:135], v[84:87], v[192:195]
    v_exp_f32 v10, v10
    v_mfma_f32_16x16x32_bf16 v[224:227], a[132:135], v[92:95], v[224:227]
    v_cvt_pk_bf16_f32 v68, v8, v9
    v_mfma_f32_16x16x32_bf16 v[224:227], a[128:131], v[88:91], v[224:227]
    v_exp_f32 v11, v11
    v_mfma_f32_16x16x32_bf16 v[228:231], a[136:139], v[88:91], v[228:231]
    v_cvt_pk_bf16_f32 v69, v10, v11
    v_mfma_f32_16x16x32_bf16 v[228:231], a[140:143], v[92:95], v[228:231]
    v_exp_f32 v12, v12
    v_mfma_f32_16x16x32_bf16 v[196:199], a[140:143], v[84:87], v[196:199]
    v_mfma_f32_16x16x32_bf16 v[196:199], a[136:139], v[80:83], v[196:199]
    s_waitcnt vmcnt(16)
    v_exp_f32 v13, v13
    v_mfma_f32_16x16x32_bf16 v[200:203], a[144:147], v[80:83], v[200:203]
    s_barrier
    v_mfma_f32_16x16x32_bf16 v[200:203], a[148:151], v[84:87], v[200:203]
    v_exp_f32 v14, v14
    v_mfma_f32_16x16x32_bf16 v[232:235], a[148:151], v[92:95], v[232:235]
    ds_read_b64_tr_b16 a[128:129], v100 offset:32768
    v_cvt_pk_bf16_f32 v70, v12, v13
    v_mfma_f32_16x16x32_bf16 v[232:235], a[144:147], v[88:91], v[232:235]
    v_exp_f32 v15, v15
    v_mfma_f32_16x16x32_bf16 v[236:239], a[152:155], v[88:91], v[236:239]
    ds_read_b64_tr_b16 a[130:131], v100 offset:33792
    v_cvt_pk_bf16_f32 v71, v14, v15
    v_mfma_f32_16x16x32_bf16 v[236:239], a[156:159], v[92:95], v[236:239]
    ds_read_b64_tr_b16 a[132:133], v100 offset:34816
    v_mfma_f32_16x16x32_bf16 v[204:207], a[156:159], v[84:87], v[204:207]
    v_exp_f32 v16, v16
    v_mfma_f32_16x16x32_bf16 v[204:207], a[152:155], v[80:83], v[204:207]
    ds_read_b64_tr_b16 a[134:135], v100 offset:35840
    v_smfmac_f32_16x16x64_bf16 a[200:203], a[208:211], v[80:87], v114
    v_exp_f32 v17, v17
    v_mfma_f32_16x16x32_bf16 v[208:211], a[160:163], v[80:83], v[208:211]
    ds_read_b64_tr_b16 a[136:137], v101 offset:32768
    v_cvt_pk_bf16_f32 v72, v16, v17
    v_mfma_f32_16x16x32_bf16 v[208:211], a[164:167], v[84:87], v[208:211]
    v_exp_f32 v18, v18
    v_mfma_f32_16x16x32_bf16 v[240:243], a[164:167], v[92:95], v[240:243]
    ds_read_b64_tr_b16 a[140:141], v101 offset:34816
    ds_read_b64_tr_b16 a[138:139], v101 offset:33792
    v_mfma_f32_16x16x32_bf16 v[240:243], a[160:163], v[88:91], v[240:243]
    v_exp_f32 v19, v19
    v_mfma_f32_16x16x32_bf16 v[244:247], a[168:171], v[88:91], v[244:247]
    ds_read_b64_tr_b16 a[142:143], v101 offset:35840
    v_cvt_pk_bf16_f32 v73, v18, v19
    v_mfma_f32_16x16x32_bf16 v[244:247], a[172:175], v[92:95], v[244:247]
    v_exp_f32 v20, v20
    v_mfma_f32_16x16x32_bf16 v[212:215], a[172:175], v[84:87], v[212:215]
    ds_read_b64_tr_b16 a[144:145], v102 offset:32768
    ds_read_b64_tr_b16 a[146:147], v102 offset:33792
    v_mfma_f32_16x16x32_bf16 v[212:215], a[168:171], v[80:83], v[212:215]
    v_exp_f32 v21, v21
    v_mfma_f32_16x16x32_bf16 v[216:219], a[176:179], v[80:83], v[216:219]
    ds_read_b64_tr_b16 a[148:149], v102 offset:34816
    v_cvt_pk_bf16_f32 v74, v20, v21
    v_mfma_f32_16x16x32_bf16 v[216:219], a[180:183], v[84:87], v[216:219]
    v_exp_f32 v22, v22
    v_mfma_f32_16x16x32_bf16 v[248:251], a[180:183], v[92:95], v[248:251]
    ds_read_b64_tr_b16 a[150:151], v102 offset:35840
    v_mfma_f32_16x16x32_bf16 v[248:251], a[176:179], v[88:91], v[248:251]
    s_add_u32 s39, s39, 1
    v_exp_f32 v23, v23
    v_mfma_f32_16x16x32_bf16 v[252:255], a[184:187], v[88:91], v[252:255]
    ds_read_b64_tr_b16 a[152:153], v103 offset:32768
    v_cvt_pk_bf16_f32 v75, v22, v23
    v_mfma_f32_16x16x32_bf16 v[252:255], a[188:191], v[92:95], v[252:255]
    v_exp_f32 v24, v24
    v_mfma_f32_16x16x32_bf16 v[220:223], a[188:191], v[84:87], v[220:223]
    ds_read_b64_tr_b16 a[156:157], v103 offset:34816
    ds_read_b64_tr_b16 a[154:155], v103 offset:33792
    v_mfma_f32_16x16x32_bf16 v[220:223], a[184:187], v[80:83], v[220:223]
    v_exp_f32 v25, v25
    v_smfmac_f32_16x16x64_bf16 a[204:207], a[208:211], v[88:95], v114
    ds_read_b64_tr_b16 a[158:159], v103 offset:35840
    v_cvt_pk_bf16_f32 v76, v24, v25
    v_mfma_f32_16x16x32_bf16 v[32:35], a[64:67], a[32:35], 0
    v_exp_f32 v26, v26
    v_mfma_f32_16x16x32_bf16 v[32:35], a[68:71], a[36:39], v[32:35]
    ds_read_b64_tr_b16 a[160:161], v104 offset:32768
    ds_read_b64_tr_b16 a[162:163], v104 offset:33792
    v_mfma_f32_16x16x32_bf16 v[32:35], a[72:75], a[40:43], v[32:35]
    v_exp_f32 v27, v27
    v_mfma_f32_16x16x32_bf16 v[32:35], a[76:79], a[44:47], v[32:35]
    ds_read_b64_tr_b16 a[164:165], v104 offset:34816
    v_cvt_pk_bf16_f32 v77, v26, v27
    v_mfma_f32_16x16x32_bf16 v[48:51], a[76:79], a[60:63], 0
    v_exp_f32 v28, v28
    v_mfma_f32_16x16x32_bf16 v[48:51], a[72:75], a[56:59], v[48:51]
    ds_read_b64_tr_b16 a[166:167], v104 offset:35840
    v_mfma_f32_16x16x32_bf16 v[48:51], a[68:71], a[52:55], v[48:51]
    v_exp_f32 v29, v29
    v_mfma_f32_16x16x32_bf16 v[48:51], a[64:67], a[48:51], v[48:51]
    ds_read_b64_tr_b16 a[168:169], v105 offset:32768
    v_cvt_pk_bf16_f32 v78, v28, v29
    v_mfma_f32_16x16x32_bf16 v[52:55], a[80:83], a[48:51], 0
    v_exp_f32 v30, v30
    v_mfma_f32_16x16x32_bf16 v[52:55], a[84:87], a[52:55], v[52:55]
    ds_read_b64_tr_b16 a[172:173], v105 offset:34816
    ds_read_b64_tr_b16 a[170:171], v105 offset:33792
    v_mfma_f32_16x16x32_bf16 v[52:55], a[88:91], a[56:59], v[52:55]
    v_exp_f32 v31, v31
    v_mfma_f32_16x16x32_bf16 v[52:55], a[92:95], a[60:63], v[52:55]
    ds_read_b64_tr_b16 a[174:175], v105 offset:35840
    v_cvt_pk_bf16_f32 v79, v30, v31
    v_mfma_f32_16x16x32_bf16 v[36:39], a[92:95], a[44:47], 0
    ds_read_b64_tr_b16 a[176:177], v106 offset:32768
    v_mfma_f32_16x16x32_bf16 v[36:39], a[88:91], a[40:43], v[36:39]
    v_exp_f32 v32, v32
    v_mfma_f32_16x16x32_bf16 v[36:39], a[84:87], a[36:39], v[36:39]
    ds_read_b64_tr_b16 a[178:179], v106 offset:33792
    v_mfma_f32_16x16x32_bf16 v[36:39], a[80:83], a[32:35], v[36:39]
    v_exp_f32 v33, v33
    v_mfma_f32_16x16x32_bf16 v[40:43], a[96:99], a[32:35], 0
    ds_read_b64_tr_b16 a[180:181], v106 offset:34816
    v_cvt_pk_bf16_f32 v80, v32, v33
    v_mfma_f32_16x16x32_bf16 v[40:43], a[100:103], a[36:39], v[40:43]
    v_exp_f32 v34, v34
    v_mfma_f32_16x16x32_bf16 v[40:43], a[104:107], a[40:43], v[40:43]
    ds_read_b64_tr_b16 a[182:183], v106 offset:35840
    ds_read_b64_tr_b16 a[184:185], v107 offset:32768
    v_mfma_f32_16x16x32_bf16 v[40:43], a[108:111], a[44:47], v[40:43]
    v_exp_f32 v35, v35
    v_mfma_f32_16x16x32_bf16 v[56:59], a[108:111], a[60:63], 0
    ds_read_b64_tr_b16 a[186:187], v107 offset:33792
    v_cvt_pk_bf16_f32 v81, v34, v35
    v_mfma_f32_16x16x32_bf16 v[56:59], a[104:107], a[56:59], v[56:59]
    v_exp_f32 v36, v36
    v_mfma_f32_16x16x32_bf16 v[56:59], a[100:103], a[52:55], v[56:59]
    v_readlane_b32 s56, v108, s39
    v_mfma_f32_16x16x32_bf16 v[56:59], a[96:99], a[48:51], v[56:59]
    v_exp_f32 v37, v37
    v_mfma_f32_16x16x32_bf16 v[60:63], a[112:115], a[48:51], 0
    ds_read_b128 a[64:67], v96 offset:49152
    v_cvt_pk_bf16_f32 v82, v36, v37
    v_mfma_f32_16x16x32_bf16 v[60:63], a[116:119], a[52:55], v[60:63]
    v_exp_f32 v38, v38
    v_mfma_f32_16x16x32_bf16 v[60:63], a[120:123], a[56:59], v[60:63]
    ds_read_b128 a[68:71], v97 offset:49152
    ds_read_b64_tr_b16 a[188:189], v107 offset:34816
    v_mfma_f32_16x16x32_bf16 v[60:63], a[124:127], a[60:63], v[60:63]
    v_exp_f32 v39, v39
    v_mfma_f32_16x16x32_bf16 v[44:47], a[124:127], a[44:47], 0
    ds_read_b128 a[72:75], v98 offset:49152
    v_cvt_pk_bf16_f32 v83, v38, v39
    v_mfma_f32_16x16x32_bf16 v[44:47], a[120:123], a[40:43], v[44:47]
    v_exp_f32 v40, v40
    v_mfma_f32_16x16x32_bf16 v[44:47], a[116:119], a[36:39], v[44:47]
    ds_read_b128 a[76:79], v99 offset:49152
    ds_read_b64_tr_b16 a[190:191], v107 offset:35840
    v_mfma_f32_16x16x32_bf16 v[44:47], a[112:115], a[32:35], v[44:47]
    s_waitcnt lgkmcnt(6)
    v_exp_f32 v41, v41
    v_mfma_f32_16x16x32_bf16 v[128:131], a[128:131], v[64:67], v[128:131]
    ds_read_b128 a[80:83], v96 offset:50176
    v_cvt_pk_bf16_f32 v84, v40, v41
    v_mfma_f32_16x16x32_bf16 v[128:131], a[132:135], v[68:71], v[128:131]
    v_exp_f32 v42, v42
    v_mfma_f32_16x16x32_bf16 v[160:163], a[132:135], v[76:79], v[160:163]
    s_cmp_eq_u32 s38, s33
    ds_read_b128 a[84:87], v97 offset:50176
    v_mfma_f32_16x16x32_bf16 v[160:163], a[128:131], v[72:75], v[160:163]
    s_cselect_b32 s22, 0, s22
    v_exp_f32 v43, v43
    v_mfma_f32_16x16x32_bf16 v[164:167], a[136:139], v[72:75], v[164:167]
    s_cselect_b32 s26, 0, s26
    ds_read_b128 a[88:91], v98 offset:50176
    v_cvt_pk_bf16_f32 v85, v42, v43
    v_mfma_f32_16x16x32_bf16 v[164:167], a[140:143], v[76:79], v[164:167]
    v_exp_f32 v44, v44
    v_mfma_f32_16x16x32_bf16 v[132:135], a[140:143], v[68:71], v[132:135]
    ds_read_b128 a[92:95], v99 offset:50176
    v_mfma_f32_16x16x32_bf16 v[132:135], a[136:139], v[64:67], v[132:135]
    v_exp_f32 v45, v45
    v_mfma_f32_16x16x32_bf16 v[136:139], a[144:147], v[64:67], v[136:139]
    ds_read_b128 a[96:99], v96 offset:51200
    v_cvt_pk_bf16_f32 v86, v44, v45
    v_mfma_f32_16x16x32_bf16 v[136:139], a[148:151], v[68:71], v[136:139]
    v_exp_f32 v46, v46
    v_mfma_f32_16x16x32_bf16 v[168:171], a[148:151], v[76:79], v[168:171]
    ds_read_b128 a[100:103], v97 offset:51200
    v_mfma_f32_16x16x32_bf16 v[168:171], a[144:147], v[72:75], v[168:171]
    v_exp_f32 v47, v47
    v_mfma_f32_16x16x32_bf16 v[172:175], a[152:155], v[72:75], v[172:175]
    ds_read_b128 a[104:107], v98 offset:51200
    v_cvt_pk_bf16_f32 v87, v46, v47
    v_mfma_f32_16x16x32_bf16 v[172:175], a[156:159], v[76:79], v[172:175]
    v_readlane_b32 s57, v109, s39
    v_mfma_f32_16x16x32_bf16 v[140:143], a[156:159], v[68:71], v[140:143]
    v_exp_f32 v48, v48
    v_mfma_f32_16x16x32_bf16 v[140:143], a[152:155], v[64:67], v[140:143]
    ds_read_b128 a[108:111], v99 offset:51200
    v_smfmac_f32_16x16x64_bf16 a[192:195], a[208:211], v[64:71], v114
    v_exp_f32 v49, v49
    v_mfma_f32_16x16x32_bf16 v[144:147], a[160:163], v[64:67], v[144:147]
    ds_read_b128 a[112:115], v96 offset:52224
    v_cvt_pk_bf16_f32 v88, v48, v49
    v_mfma_f32_16x16x32_bf16 v[144:147], a[164:167], v[68:71], v[144:147]
    v_exp_f32 v50, v50
    v_mfma_f32_16x16x32_bf16 v[176:179], a[164:167], v[76:79], v[176:179]
    ds_read_b128 a[116:119], v97 offset:52224
    v_mfma_f32_16x16x32_bf16 v[176:179], a[160:163], v[72:75], v[176:179]
    v_exp_f32 v51, v51
    v_mfma_f32_16x16x32_bf16 v[180:183], a[168:171], v[72:75], v[180:183]
    ds_read_b128 a[120:123], v98 offset:52224
    v_cvt_pk_bf16_f32 v89, v50, v51
    v_mfma_f32_16x16x32_bf16 v[180:183], a[172:175], v[76:79], v[180:183]
    v_exp_f32 v52, v52
    v_mfma_f32_16x16x32_bf16 v[148:151], a[172:175], v[68:71], v[148:151]
    ds_read_b128 a[124:127], v99 offset:52224
    v_mfma_f32_16x16x32_bf16 v[148:151], a[168:171], v[64:67], v[148:151]
    v_exp_f32 v53, v53
    v_mfma_f32_16x16x32_bf16 v[152:155], a[176:179], v[64:67], v[152:155]
    v_cvt_pk_bf16_f32 v90, v52, v53
    v_mfma_f32_16x16x32_bf16 v[152:155], a[180:183], v[68:71], v[152:155]
    v_exp_f32 v54, v54
    v_mfma_f32_16x16x32_bf16 v[184:187], a[180:183], v[76:79], v[184:187]
    v_readlane_b32 s58, v110, s39
    v_mfma_f32_16x16x32_bf16 v[184:187], a[176:179], v[72:75], v[184:187]
    v_exp_f32 v55, v55
    v_mfma_f32_16x16x32_bf16 v[188:191], a[184:187], v[72:75], v[188:191]
    s_waitcnt lgkmcnt(1)
    v_cvt_pk_bf16_f32 v91, v54, v55
    v_mfma_f32_16x16x32_bf16 v[188:191], a[188:191], v[76:79], v[188:191]
    v_exp_f32 v56, v56
    v_mfma_f32_16x16x32_bf16 v[156:159], a[188:191], v[68:71], v[156:159]
    v_readlane_b32 s59, v111, s39
    v_mfma_f32_16x16x32_bf16 v[156:159], a[184:187], v[64:67], v[156:159]
    s_waitcnt lgkmcnt(4)
    v_exp_f32 v57, v57
    v_smfmac_f32_16x16x64_bf16 a[196:199], a[208:211], v[72:79], v114
    v_cvt_pk_bf16_f32 v92, v56, v57
L_b3:
    v_mfma_f32_16x16x32_bf16 v[0:3], a[64:67], a[0:3], 0
    v_exp_f32 v58, v58
    v_mfma_f32_16x16x32_bf16 v[0:3], a[68:71], a[4:7], v[0:3]
    s_add_u32 m0, s65, 16384
    v_mfma_f32_16x16x32_bf16 v[0:3], a[72:75], a[8:11], v[0:3]
    v_exp_f32 v59, v59
    v_mfma_f32_16x16x32_bf16 v[0:3], a[76:79], a[12:15], v[0:3]
    s_nop 0
    buffer_load_dwordx4 v113, s[12:15], s60 offen offset:0 sc1 lds
    v_mfma_f32_16x16x32_bf16 v[16:19], a[76:79], a[28:31], 0
    v_exp_f32 v60, v60
    v_mfma_f32_16x16x32_bf16 v[16:19], a[72:75], a[24:27], v[16:19]
    v_cvt_pk_bf16_f32 v93, v58, v59
    v_mfma_f32_16x16x32_bf16 v[16:19], a[68:71], a[20:23], v[16:19]
    v_exp_f32 v61, v61
    v_mfma_f32_16x16x32_bf16 v[16:19], a[64:67], a[16:19], v[16:19]
    s_nop 0
    buffer_load_dwordx4 v113, s[12:15], s61 offen offset:1024 sc1 lds
    v_mfma_f32_16x16x32_bf16 v[20:23], a[80:83], a[16:19], 0
    v_exp_f32 v62, v62
    v_mfma_f32_16x16x32_bf16 v[20:23], a[84:87], a[20:23], v[20:23]
    v_cvt_pk_bf16_f32 v94, v60, v61
    v_mfma_f32_16x16x32_bf16 v[20:23], a[88:91], a[24:27], v[20:23]
    v_exp_f32 v63, v63
    v_mfma_f32_16x16x32_bf16 v[20:23], a[92:95], a[28:31], v[20:23]
    v_cvt_pk_bf16_f32 v95, v62, v63
    v_mfma_f32_16x16x32_bf16 v[4:7], a[92:95], a[12:15], 0
    s_nop 0
    buffer_load_dwordx4 v113, s[12:15], s62 offen offset:2048 sc1 lds
    v_mfma_f32_16x16x32_bf16 v[4:7], a[88:91], a[8:11], v[4:7]
    v_exp_f32 v0, v0
    v_mfma_f32_16x16x32_bf16 v[4:7], a[84:87], a[4:7], v[4:7]
    v_mfma_f32_16x16x32_bf16 v[4:7], a[80:83], a[0:3], v[4:7]
    v_exp_f32 v1, v1
    v_mfma_f32_16x16x32_bf16 v[8:11], a[96:99], a[0:3], 0
    s_nop 0
    buffer_load_dwordx4 v113, s[12:15], s63 offen offset:3072 sc1 lds
    v_mfma_f32_16x16x32_bf16 v[8:11], a[100:103], a[4:7], v[8:11]
    v_exp_f32 v2, v2
    v_mfma_f32_16x16x32_bf16 v[8:11], a[104:107], a[8:11], v[8:11]
    s_add_u32 m0, s64, 32768
    v_cvt_pk_bf16_f32 v64, v0, v1
    v_mfma_f32_16x16x32_bf16 v[8:11], a[108:111], a[12:15], v[8:11]
    v_exp_f32 v3, v3
    v_mfma_f32_16x16x32_bf16 v[24:27], a[108:111], a[28:31], 0
    s_nop 0
    buffer_load_dwordx4 v112, s[8:11], s56 offen offset:0 sc1 lds
    v_mfma_f32_16x16x32_bf16 v[24:27], a[104:107], a[24:27], v[24:27]
    v_exp_f32 v4, v4
    v_mfma_f32_16x16x32_bf16 v[24:27], a[100:103], a[20:23], v[24:27]
    v_cvt_pk_bf16_f32 v65, v2, v3
    v_mfma_f32_16x16x32_bf16 v[24:27], a[96:99], a[16:19], v[24:27]
    s_waitcnt lgkmcnt(0)
    v_exp_f32 v5, v5
    v_mfma_f32_16x16x32_bf16 v[28:31], a[112:115], a[16:19], 0
    s_nop 0
    buffer_load_dwordx4 v112, s[20:23], s57 offen offset:1024 sc1 lds
    v_mfma_f32_16x16x32_bf16 v[28:31], a[116:119], a[20:23], v[28:31]
    v_exp_f32 v6, v6
    v_mfma_f32_16x16x32_bf16 v[28:31], a[120:123], a[24:27], v[28:31]
    v_cvt_pk_bf16_f32 v66, v4, v5
    v_mfma_f32_16x16x32_bf16 v[28:31], a[124:127], a[28:31], v[28:31]
    v_exp_f32 v7, v7
    v_mfma_f32_16x16x32_bf16 v[12:15], a[124:127], a[12:15], 0
    s_nop 0
    buffer_load_dwordx4 v112, s[20:23], s58 offen offset:2048 sc1 lds
    v_mfma_f32_16x16x32_bf16 v[12:15], a[120:123], a[8:11], v[12:15]
    v_exp_f32 v8, v8
    v_mfma_f32_16x16x32_bf16 v[12:15], a[116:119], a[4:7], v[12:15]
    v_cvt_pk_bf16_f32 v67, v6, v7
    v_mfma_f32_16x16x32_bf16 v[12:15], a[112:115], a[0:3], v[12:15]
    v_exp_f32 v9, v9
    v_mfma_f32_16x16x32_bf16 v[192:195], a[128:131], v[80:83], v[192:195]
    s_nop 0
    buffer_load_dwordx4 v112, s[20:23], s59 offen offset:3072 sc1 lds
    v_mfma_f32_16x16x32_bf16 v[192:195], a[132:135], v[84:87], v[192:195]
    v_exp_f32 v10, v10
    v_mfma_f32_16x16x32_bf16 v[224:227], a[132:135], v[92:95], v[224:227]
    v_cvt_pk_bf16_f32 v68, v8, v9
    v_mfma_f32_16x16x32_bf16 v[224:227], a[128:131], v[88:91], v[224:227]
    v_exp_f32 v11, v11
    v_mfma_f32_16x16x32_bf16 v[228:231], a[136:139], v[88:91], v[228:231]
    v_cvt_pk_bf16_f32 v69, v10, v11
    v_mfma_f32_16x16x32_bf16 v[228:231], a[140:143], v[92:95], v[228:231]
    v_exp_f32 v12, v12
    v_mfma_f32_16x16x32_bf16 v[196:199], a[140:143], v[84:87], v[196:199]
    v_mfma_f32_16x16x32_bf16 v[196:199], a[136:139], v[80:83], v[196:199]
    s_waitcnt vmcnt(16)
    v_exp_f32 v13, v13
    v_mfma_f32_16x16x32_bf16 v[200:203], a[144:147], v[80:83], v[200:203]
    s_barrier
    v_mfma_f32_16x16x32_bf16 v[200:203], a[148:151], v[84:87], v[200:203]
    v_exp_f32 v14, v14
    v_mfma_f32_16x16x32_bf16 v[232:235], a[148:151], v[92:95], v[232:235]
    ds_read_b64_tr_b16 a[128:129], v100 offset:49152
    v_cvt_pk_bf16_f32 v70, v12, v13
    v_mfma_f32_16x16x32_bf16 v[232:235], a[144:147], v[88:91], v[232:235]
    v_exp_f32 v15, v15
    v_mfma_f32_16x16x32_bf16 v[236:239], a[152:155], v[88:91], v[236:239]
    ds_read_b64_tr_b16 a[130:131], v100 offset:50176
    v_cvt_pk_bf16_f32 v71, v14, v15
    v_mfma_f32_16x16x32_bf16 v[236:239], a[156:159], v[92:95], v[236:239]
    ds_read_b64_tr_b16 a[132:133], v100 offset:51200
    v_mfma_f32_16x16x32_bf16 v[204:207], a[156:159], v[84:87], v[204:207]
    v_exp_f32 v16, v16
    v_mfma_f32_16x16x32_bf16 v[204:207], a[152:155], v[80:83], v[204:207]
    ds_read_b64_tr_b16 a[134:135], v100 offset:52224
    v_smfmac_f32_16x16x64_bf16 a[200:203], a[208:211], v[80:87], v114
    v_exp_f32 v17, v17
    v_mfma_f32_16x16x32_bf16 v[208:211], a[160:163], v[80:83], v[208:211]
    ds_read_b64_tr_b16 a[136:137], v101 offset:49152
    v_cvt_pk_bf16_f32 v72, v16, v17
    v_mfma_f32_16x16x32_bf16 v[208:211], a[164:167], v[84:87], v[208:211]
    v_exp_f32 v18, v18
    v_mfma_f32_16x16x32_bf16 v[240:243], a[164:167], v[92:95], v[240:243]
    ds_read_b64_tr_b16 a[140:141], v101 offset:51200
    ds_read_b64_tr_b16 a[138:139], v101 offset:50176
    v_mfma_f32_16x16x32_bf16 v[240:243], a[160:163], v[88:91], v[240:243]
    v_exp_f32 v19, v19
    v_mfma_f32_16x16x32_bf16 v[244:247], a[168:171], v[88:91], v[244:247]
    ds_read_b64_tr_b16 a[142:143], v101 offset:52224
    v_cvt_pk_bf16_f32 v73, v18, v19
    v_mfma_f32_16x16x32_bf16 v[244:247], a[172:175], v[92:95], v[244:247]
    v_exp_f32 v20, v20
    v_mfma_f32_16x16x32_bf16 v[212:215], a[172:175], v[84:87], v[212:215]
    ds_read_b64_tr_b16 a[144:145], v102 offset:49152
    ds_read_b64_tr_b16 a[146:147], v102 offset:50176
    v_mfma_f32_16x16x32_bf16 v[212:215], a[168:171], v[80:83], v[212:215]
    v_exp_f32 v21, v21
    v_mfma_f32_16x16x32_bf16 v[216:219], a[176:179], v[80:83], v[216:219]
    ds_read_b64_tr_b16 a[148:149], v102 offset:51200
    v_cvt_pk_bf16_f32 v74, v20, v21
    v_mfma_f32_16x16x32_bf16 v[216:219], a[180:183], v[84:87], v[216:219]
    v_exp_f32 v22, v22
    v_mfma_f32_16x16x32_bf16 v[248:251], a[180:183], v[92:95], v[248:251]
    ds_read_b64_tr_b16 a[150:151], v102 offset:52224
    v_mfma_f32_16x16x32_bf16 v[248:251], a[176:179], v[88:91], v[248:251]
    s_add_u32 s39, s39, 1
    v_exp_f32 v23, v23
    v_mfma_f32_16x16x32_bf16 v[252:255], a[184:187], v[88:91], v[252:255]
    ds_read_b64_tr_b16 a[152:153], v103 offset:49152
    v_cvt_pk_bf16_f32 v75, v22, v23
    v_mfma_f32_16x16x32_bf16 v[252:255], a[188:191], v[92:95], v[252:255]
    v_exp_f32 v24, v24
    v_mfma_f32_16x16x32_bf16 v[220:223], a[188:191], v[84:87], v[220:223]
    ds_read_b64_tr_b16 a[156:157], v103 offset:51200
    ds_read_b64_tr_b16 a[154:155], v103 offset:50176
    v_mfma_f32_16x16x32_bf16 v[220:223], a[184:187], v[80:83], v[220:223]
    v_exp_f32 v25, v25
    v_smfmac_f32_16x16x64_bf16 a[204:207], a[208:211], v[88:95], v114
    ds_read_b64_tr_b16 a[158:159], v103 offset:52224
    v_cvt_pk_bf16_f32 v76, v24, v25
    v_mfma_f32_16x16x32_bf16 v[32:35], a[64:67], a[32:35], 0
    v_exp_f32 v26, v26
    v_mfma_f32_16x16x32_bf16 v[32:35], a[68:71], a[36:39], v[32:35]
    ds_read_b64_tr_b16 a[160:161], v104 offset:49152
    ds_read_b64_tr_b16 a[162:163], v104 offset:50176
    v_mfma_f32_16x16x32_bf16 v[32:35], a[72:75], a[40:43], v[32:35]
    v_exp_f32 v27, v27
    v_mfma_f32_16x16x32_bf16 v[32:35], a[76:79], a[44:47], v[32:35]
    ds_read_b64_tr_b16 a[164:165], v104 offset:51200
    v_cvt_pk_bf16_f32 v77, v26, v27
    v_mfma_f32_16x16x32_bf16 v[48:51], a[76:79], a[60:63], 0
    v_exp_f32 v28, v28
    v_mfma_f32_16x16x32_bf16 v[48:51], a[72:75], a[56:59], v[48:51]
    ds_read_b64_tr_b16 a[166:167], v104 offset:52224
    v_mfma_f32_16x16x32_bf16 v[48:51], a[68:71], a[52:55], v[48:51]
    v_exp_f32 v29, v29
    v_mfma_f32_16x16x32_bf16 v[48:51], a[64:67], a[48:51], v[48:51]
    ds_read_b64_tr_b16 a[168:169], v105 offset:49152
    v_cvt_pk_bf16_f32 v78, v28, v29
    v_mfma_f32_16x16x32_bf16 v[52:55], a[80:83], a[48:51], 0
    v_exp_f32 v30, v30
    v_mfma_f32_16x16x32_bf16 v[52:55], a[84:87], a[52:55], v[52:55]
    ds_read_b64_tr_b16 a[172:173], v105 offset:51200
    ds_read_b64_tr_b16 a[170:171], v105 offset:50176
    v_mfma_f32_16x16x32_bf16 v[52:55], a[88:91], a[56:59], v[52:55]
    v_exp_f32 v31, v31
    v_mfma_f32_16x16x32_bf16 v[52:55], a[92:95], a[60:63], v[52:55]
    ds_read_b64_tr_b16 a[174:175], v105 offset:52224
    v_cvt_pk_bf16_f32 v79, v30, v31
    v_mfma_f32_16x16x32_bf16 v[36:39], a[92:95], a[44:47], 0
    ds_read_b64_tr_b16 a[176:177], v106 offset:49152
    v_mfma_f32_16x16x32_bf16 v[36:39], a[88:91], a[40:43], v[36:39]
    v_exp_f32 v32, v32
    v_mfma_f32_16x16x32_bf16 v[36:39], a[84:87], a[36:39], v[36:39]
    ds_read_b64_tr_b16 a[178:179], v106 offset:50176
    v_mfma_f32_16x16x32_bf16 v[36:39], a[80:83], a[32:35], v[36:39]
    v_exp_f32 v33, v33
    v_mfma_f32_16x16x32_bf16 v[40:43], a[96:99], a[32:35], 0
    ds_read_b64_tr_b16 a[180:181], v106 offset:51200
    v_cvt_pk_bf16_f32 v80, v32, v33
    v_mfma_f32_16x16x32_bf16 v[40:43], a[100:103], a[36:39], v[40:43]
    v_exp_f32 v34, v34
    v_mfma_f32_16x16x32_bf16 v[40:43], a[104:107], a[40:43], v[40:43]
    ds_read_b64_tr_b16 a[182:183], v106 offset:52224
    ds_read_b64_tr_b16 a[184:185], v107 offset:49152
    v_mfma_f32_16x16x32_bf16 v[40:43], a[108:111], a[44:47], v[40:43]
    v_exp_f32 v35, v35
    v_mfma_f32_16x16x32_bf16 v[56:59], a[108:111], a[60:63], 0
    ds_read_b64_tr_b16 a[186:187], v107 offset:50176
    v_cvt_pk_bf16_f32 v81, v34, v35
    v_mfma_f32_16x16x32_bf16 v[56:59], a[104:107], a[56:59], v[56:59]
    v_exp_f32 v36, v36
    v_mfma_f32_16x16x32_bf16 v[56:59], a[100:103], a[52:55], v[56:59]
    v_readlane_b32 s60, v108, s39
    v_mfma_f32_16x16x32_bf16 v[56:59], a[96:99], a[48:51], v[56:59]
    v_exp_f32 v37, v37
    v_mfma_f32_16x16x32_bf16 v[60:63], a[112:115], a[48:51], 0
    ds_read_b128 a[64:67], v96 offset:0
    v_cvt_pk_bf16_f32 v82, v36, v37
    v_mfma_f32_16x16x32_bf16 v[60:63], a[116:119], a[52:55], v[60:63]
    v_exp_f32 v38, v38
    v_mfma_f32_16x16x32_bf16 v[60:63], a[120:123], a[56:59], v[60:63]
    ds_read_b128 a[68:71], v97 offset:0
    ds_read_b64_tr_b16 a[188:189], v107 offset:51200
    v_mfma_f32_16x16x32_bf16 v[60:63], a[124:127], a[60:63], v[60:63]
    v_exp_f32 v39, v39
    v_mfma_f32_16x16x32_bf16 v[44:47], a[124:127], a[44:47], 0
    ds_read_b128 a[72:75], v98 offset:0
    v_cvt_pk_bf16_f32 v83, v38, v39
    v_mfma_f32_16x16x32_bf16 v[44:47], a[120:123], a[40:43], v[44:47]
    v_exp_f32 v40, v40
    v_mfma_f32_16x16x32_bf16 v[44:47], a[116:119], a[36:39], v[44:47]
    ds_read_b128 a[76:79], v99 offset:0
    ds_read_b64_tr_b16 a[190:191], v107 offset:52224
    v_mfma_f32_16x16x32_bf16 v[44:47], a[112:115], a[32:35], v[44:47]
    s_waitcnt lgkmcnt(6)
    v_exp_f32 v41, v41
    v_mfma_f32_16x16x32_bf16 v[128:131], a[128:131], v[64:67], v[128:131]
    ds_read_b128 a[80:83], v96 offset:1024
    v_cvt_pk_bf16_f32 v84, v40, v41
    v_mfma_f32_16x16x32_bf16 v[128:131], a[132:135], v[68:71], v[128:131]
    v_exp_f32 v42, v42
    v_mfma_f32_16x16x32_bf16 v[160:163], a[132:135], v[76:79], v[160:163]
    ds_read_b128 a[84:87], v97 offset:1024
    v_mfma_f32_16x16x32_bf16 v[160:163], a[128:131], v[72:75], v[160:163]
    v_exp_f32 v43, v43
    v_mfma_f32_16x16x32_bf16 v[164:167], a[136:139], v[72:75], v[164:167]
    ds_read_b128 a[88:91], v98 offset:1024
    v_cvt_pk_bf16_f32 v85, v42, v43
    v_mfma_f32_16x16x32_bf16 v[164:167], a[140:143], v[76:79], v[164:167]
    v_exp_f32 v44, v44
    v_mfma_f32_16x16x32_bf16 v[132:135], a[140:143], v[68:71], v[132:135]
    ds_read_b128 a[92:95], v99 offset:1024
    v_mfma_f32_16x16x32_bf16 v[132:135], a[136:139], v[64:67], v[132:135]
    v_exp_f32 v45, v45
    v_mfma_f32_16x16x32_bf16 v[136:139], a[144:147], v[64:67], v[136:139]
    ds_read_b128 a[96:99], v96 offset:2048
    v_cvt_pk_bf16_f32 v86, v44, v45
    v_mfma_f32_16x16x32_bf16 v[136:139], a[148:151], v[68:71], v[136:139]
    v_exp_f32 v46, v46
    v_mfma_f32_16x16x32_bf16 v[168:171], a[148:151], v[76:79], v[168:171]
    ds_read_b128 a[100:103], v97 offset:2048
    v_mfma_f32_16x16x32_bf16 v[168:171], a[144:147], v[72:75], v[168:171]
    v_exp_f32 v47, v47
    v_mfma_f32_16x16x32_bf16 v[172:175], a[152:155], v[72:75], v[172:175]
    ds_read_b128 a[104:107], v98 offset:2048
    v_cvt_pk_bf16_f32 v87, v46, v47
    v_mfma_f32_16x16x32_bf16 v[172:175], a[156:159], v[76:79], v[172:175]
    v_readlane_b32 s61, v109, s39
    v_mfma_f32_16x16x32_bf16 v[140:143], a[156:159], v[68:71], v[140:143]
    v_exp_f32 v48, v48
    v_mfma_f32_16x16x32_bf16 v[140:143], a[152:155], v[64:67], v[140:143]
    ds_read_b128 a[108:111], v99 offset:2048
    v_smfmac_f32_16x16x64_bf16 a[192:195], a[208:211], v[64:71], v114
    v_exp_f32 v49, v49
    v_mfma_f32_16x16x32_bf16 v[144:147], a[160:163], v[64:67], v[144:147]
    ds_read_b128 a[112:115], v96 offset:3072
    v_cvt_pk_bf16_f32 v88, v48, v49
    v_mfma_f32_16x16x32_bf16 v[144:147], a[164:167], v[68:71], v[144:147]
    v_exp_f32 v50, v50
    v_mfma_f32_16x16x32_bf16 v[176:179], a[164:167], v[76:79], v[176:179]
    ds_read_b128 a[116:119], v97 offset:3072
    v_mfma_f32_16x16x32_bf16 v[176:179], a[160:163], v[72:75], v[176:179]
    v_exp_f32 v51, v51
    v_mfma_f32_16x16x32_bf16 v[180:183], a[168:171], v[72:75], v[180:183]
    ds_read_b128 a[120:123], v98 offset:3072
    v_cvt_pk_bf16_f32 v89, v50, v51
    v_mfma_f32_16x16x32_bf16 v[180:183], a[172:175], v[76:79], v[180:183]
    v_exp_f32 v52, v52
    v_mfma_f32_16x16x32_bf16 v[148:151], a[172:175], v[68:71], v[148:151]
    ds_read_b128 a[124:127], v99 offset:3072
    v_mfma_f32_16x16x32_bf16 v[148:151], a[168:171], v[64:67], v[148:151]
    v_exp_f32 v53, v53
    v_mfma_f32_16x16x32_bf16 v[152:155], a[176:179], v[64:67], v[152:155]
    v_cvt_pk_bf16_f32 v90, v52, v53
    v_mfma_f32_16x16x32_bf16 v[152:155], a[180:183], v[68:71], v[152:155]
    v_exp_f32 v54, v54
    v_mfma_f32_16x16x32_bf16 v[184:187], a[180:183], v[76:79], v[184:187]
    v_readlane_b32 s62, v110, s39
    v_mfma_f32_16x16x32_bf16 v[184:187], a[176:179], v[72:75], v[184:187]
    v_exp_f32 v55, v55
    v_mfma_f32_16x16x32_bf16 v[188:191], a[184:187], v[72:75], v[188:191]
    s_waitcnt lgkmcnt(1)
    v_cvt_pk_bf16_f32 v91, v54, v55
    v_mfma_f32_16x16x32_bf16 v[188:191], a[188:191], v[76:79], v[188:191]
    v_exp_f32 v56, v56
    v_mfma_f32_16x16x32_bf16 v[156:159], a[188:191], v[68:71], v[156:159]
    v_readlane_b32 s63, v111, s39
    v_mfma_f32_16x16x32_bf16 v[156:159], a[184:187], v[64:67], v[156:159]
    s_waitcnt lgkmcnt(4)
    v_exp_f32 v57, v57
    v_smfmac_f32_16x16x64_bf16 a[196:199], a[208:211], v[72:79], v114
    v_cvt_pk_bf16_f32 v92, v56, v57
L_b0:
    v_mfma_f32_16x16x32_bf16 v[0:3], a[64:67], a[0:3], 0
    v_exp_f32 v58, v58
    v_mfma_f32_16x16x32_bf16 v[0:3], a[68:71], a[4:7], v[0:3]
    s_add_u32 m0, s65, 32768
    v_mfma_f32_16x16x32_bf16 v[0:3], a[72:75], a[8:11], v[0:3]
    v_exp_f32 v59, v59
    v_mfma_f32_16x16x32_bf16 v[0:3], a[76:79], a[12:15], v[0:3]
    s_nop 0
    buffer_load_dwordx4 v113, s[12:15], s56 offen offset:0 sc1 lds
    v_mfma_f32_16x16x32_bf16 v[16:19], a[76:79], a[28:31], 0
    v_exp_f32 v60, v60
    v_mfma_f32_16x16x32_bf16 v[16:19], a[72:75], a[24:27], v[16:19]
    v_cvt_pk_bf16_f32 v93, v58, v59
    v_mfma_f32_16x16x32_bf16 v[16:19], a[68:71], a[20:23], v[16:19]
    v_exp_f32 v61, v61
    v_mfma_f32_16x16x32_bf16 v[16:19], a[64:67], a[16:19], v[16:19]
    s_nop 0
    buffer_load_dwordx4 v113, s[24:27], s57 offen offset:1024 sc1 lds
    v_mfma_f32_16x16x32_bf16 v[20:23], a[80:83], a[16:19], 0
    v_exp_f32 v62, v62
    v_mfma_f32_16x16x32_bf16 v[20:23], a[84:87], a[20:23], v[20:23]
    v_cvt_pk_bf16_f32 v94, v60, v61
    v_mfma_f32_16x16x32_bf16 v[20:23], a[88:91], a[24:27], v[20:23]
    v_exp_f32 v63, v63
    v_mfma_f32_16x16x32_bf16 v[20:23], a[92:95], a[28:31], v[20:23]
    v_cvt_pk_bf16_f32 v95, v62, v63
    v_mfma_f32_16x16x32_bf16 v[4:7], a[92:95], a[12:15], 0
    s_nop 0
    buffer_load_dwordx4 v113, s[24:27], s58 offen offset:2048 sc1 lds
    v_mfma_f32_16x16x32_bf16 v[4:7], a[88:91], a[8:11], v[4:7]
    v_exp_f32 v0, v0
    v_mfma_f32_16x16x32_bf16 v[4:7], a[84:87], a[4:7], v[4:7]
    v_mfma_f32_16x16x32_bf16 v[4:7], a[80:83], a[0:3], v[4:7]
    v_exp_f32 v1, v1
    v_mfma_f32_16x16x32_bf16 v[8:11], a[96:99], a[0:3], 0
    s_nop 0
    buffer_load_dwordx4 v113, s[24:27], s59 offen offset:3072 sc1 lds
    v_mfma_f32_16x16x32_bf16 v[8:11], a[100:103], a[4:7], v[8:11]
    v_exp_f32 v2, v2
    v_mfma_f32_16x16x32_bf16 v[8:11], a[104:107], a[8:11], v[8:11]
    s_add_u32 m0, s64, 49152
    v_cvt_pk_bf16_f32 v64, v0, v1
    v_mfma_f32_16x16x32_bf16 v[8:11], a[108:111], a[12:15], v[8:11]
    v_exp_f32 v3, v3
    v_mfma_f32_16x16x32_bf16 v[24:27], a[108:111], a[28:31], 0
    s_nop 0
    buffer_load_dwordx4 v112, s[20:23], s60 offen offset:0 sc1 lds
    v_mfma_f32_16x16x32_bf16 v[24:27], a[104:107], a[24:27], v[24:27]
    v_exp_f32 v4, v4
    v_mfma_f32_16x16x32_bf16 v[24:27], a[100:103], a[20:23], v[24:27]
    v_cvt_pk_bf16_f32 v65, v2, v3
    v_mfma_f32_16x16x32_bf16 v[24:27], a[96:99], a[16:19], v[24:27]
    s_waitcnt lgkmcnt(0)
    v_exp_f32 v5, v5
    v_mfma_f32_16x16x32_bf16 v[28:31], a[112:115], a[16:19], 0
    s_nop 0
    buffer_load_dwordx4 v112, s[20:23], s61 offen offset:1024 sc1 lds
    v_mfma_f32_16x16x32_bf16 v[28:31], a[116:119], a[20:23], v[28:31]
    v_exp_f32 v6, v6
    v_mfma_f32_16x16x32_bf16 v[28:31], a[120:123], a[24:27], v[28:31]
    v_cvt_pk_bf16_f32 v66, v4, v5
    v_mfma_f32_16x16x32_bf16 v[28:31], a[124:127], a[28:31], v[28:31]
    v_exp_f32 v7, v7
    v_mfma_f32_16x16x32_bf16 v[12:15], a[124:127], a[12:15], 0
    s_nop 0
    buffer_load_dwordx4 v112, s[20:23], s62 offen offset:2048 sc1 lds
    v_mfma_f32_16x16x32_bf16 v[12:15], a[120:123], a[8:11], v[12:15]
    v_exp_f32 v8, v8
    v_mfma_f32_16x16x32_bf16 v[12:15], a[116:119], a[4:7], v[12:15]
    v_cvt_pk_bf16_f32 v67, v6, v7
    v_mfma_f32_16x16x32_bf16 v[12:15], a[112:115], a[0:3], v[12:15]
    v_exp_f32 v9, v9
    v_mfma_f32_16x16x32_bf16 v[192:195], a[128:131], v[80:83], v[192:195]
    s_nop 0
    buffer_load_dwordx4 v112, s[20:23], s63 offen offset:3072 sc1 lds
    v_mfma_f32_16x16x32_bf16 v[192:195], a[132:135], v[84:87], v[192:195]
    v_exp_f32 v10, v10
    v_mfma_f32_16x16x32_bf16 v[224:227], a[132:135], v[92:95], v[224:227]
    v_cvt_pk_bf16_f32 v68, v8, v9
    v_mfma_f32_16x16x32_bf16 v[224:227], a[128:131], v[88:91], v[224:227]
    v_exp_f32 v11, v11
    v_mfma_f32_16x16x32_bf16 v[228:231], a[136:139], v[88:91], v[228:231]
    v_cvt_pk_bf16_f32 v69, v10, v11
    v_mfma_f32_16x16x32_bf16 v[228:231], a[140:143], v[92:95], v[228:231]
    v_exp_f32 v12, v12
    v_mfma_f32_16x16x32_bf16 v[196:199], a[140:143], v[84:87], v[196:199]
    v_mfma_f32_16x16x32_bf16 v[196:199], a[136:139], v[80:83], v[196:199]
    s_waitcnt vmcnt(16)
    v_exp_f32 v13, v13
    v_mfma_f32_16x16x32_bf16 v[200:203], a[144:147], v[80:83], v[200:203]
    s_barrier
    v_mfma_f32_16x16x32_bf16 v[200:203], a[148:151], v[84:87], v[200:203]
    v_exp_f32 v14, v14
    v_mfma_f32_16x16x32_bf16 v[232:235], a[148:151], v[92:95], v[232:235]
    ds_read_b64_tr_b16 a[128:129], v100 offset:0
    v_cvt_pk_bf16_f32 v70, v12, v13
    v_mfma_f32_16x16x32_bf16 v[232:235], a[144:147], v[88:91], v[232:235]
    v_exp_f32 v15, v15
    v_mfma_f32_16x16x32_bf16 v[236:239], a[152:155], v[88:91], v[236:239]
    ds_read_b64_tr_b16 a[130:131], v100 offset:1024
    v_cvt_pk_bf16_f32 v71, v14, v15
    v_mfma_f32_16x16x32_bf16 v[236:239], a[156:159], v[92:95], v[236:239]
    ds_read_b64_tr_b16 a[132:133], v100 offset:2048
    v_mfma_f32_16x16x32_bf16 v[204:207], a[156:159], v[84:87], v[204:207]
    v_exp_f32 v16, v16
    v_mfma_f32_16x16x32_bf16 v[204:207], a[152:155], v[80:83], v[204:207]
    ds_read_b64_tr_b16 a[134:135], v100 offset:3072
    v_smfmac_f32_16x16x64_bf16 a[200:203], a[208:211], v[80:87], v114
    v_exp_f32 v17, v17
    v_mfma_f32_16x16x32_bf16 v[208:211], a[160:163], v[80:83], v[208:211]
    ds_read_b64_tr_b16 a[136:137], v101 offset:0
    v_cvt_pk_bf16_f32 v72, v16, v17
    v_mfma_f32_16x16x32_bf16 v[208:211], a[164:167], v[84:87], v[208:211]
    v_exp_f32 v18, v18
    v_mfma_f32_16x16x32_bf16 v[240:243], a[164:167], v[92:95], v[240:243]
    ds_read_b64_tr_b16 a[140:141], v101 offset:2048
    ds_read_b64_tr_b16 a[138:139], v101 offset:1024
    v_mfma_f32_16x16x32_bf16 v[240:243], a[160:163], v[88:91], v[240:243]
    v_exp_f32 v19, v19
    v_mfma_f32_16x16x32_bf16 v[244:247], a[168:171], v[88:91], v[244:247]
    ds_read_b64_tr_b16 a[142:143], v101 offset:3072
    v_cvt_pk_bf16_f32 v73, v18, v19
    v_mfma_f32_16x16x32_bf16 v[244:247], a[172:175], v[92:95], v[244:247]
    v_exp_f32 v20, v20
    v_mfma_f32_16x16x32_bf16 v[212:215], a[172:175], v[84:87], v[212:215]
    ds_read_b64_tr_b16 a[144:145], v102 offset:0
    ds_read_b64_tr_b16 a[146:147], v102 offset:1024
    v_mfma_f32_16x16x32_bf16 v[212:215], a[168:171], v[80:83], v[212:215]
    v_exp_f32 v21, v21
    v_mfma_f32_16x16x32_bf16 v[216:219], a[176:179], v[80:83], v[216:219]
    ds_read_b64_tr_b16 a[148:149], v102 offset:2048
    v_cvt_pk_bf16_f32 v74, v20, v21
    v_mfma_f32_16x16x32_bf16 v[216:219], a[180:183], v[84:87], v[216:219]
    v_exp_f32 v22, v22
    v_mfma_f32_16x16x32_bf16 v[248:251], a[180:183], v[92:95], v[248:251]
    ds_read_b64_tr_b16 a[150:151], v102 offset:3072
    v_mfma_f32_16x16x32_bf16 v[248:251], a[176:179], v[88:91], v[248:251]
    s_add_u32 s39, s39, 1
    v_exp_f32 v23, v23
    v_mfma_f32_16x16x32_bf16 v[252:255], a[184:187], v[88:91], v[252:255]
    ds_read_b64_tr_b16 a[152:153], v103 offset:0
    v_cvt_pk_bf16_f32 v75, v22, v23
    v_mfma_f32_16x16x32_bf16 v[252:255], a[188:191], v[92:95], v[252:255]
    v_exp_f32 v24, v24
    v_mfma_f32_16x16x32_bf16 v[220:223], a[188:191], v[84:87], v[220:223]
    ds_read_b64_tr_b16 a[156:157], v103 offset:2048
    ds_read_b64_tr_b16 a[154:155], v103 offset:1024
    v_mfma_f32_16x16x32_bf16 v[220:223], a[184:187], v[80:83], v[220:223]
    v_exp_f32 v25, v25
    v_smfmac_f32_16x16x64_bf16 a[204:207], a[208:211], v[88:95], v114
    ds_read_b64_tr_b16 a[158:159], v103 offset:3072
    v_cvt_pk_bf16_f32 v76, v24, v25
    v_mfma_f32_16x16x32_bf16 v[32:35], a[64:67], a[32:35], 0
    v_exp_f32 v26, v26
    v_mfma_f32_16x16x32_bf16 v[32:35], a[68:71], a[36:39], v[32:35]
    ds_read_b64_tr_b16 a[160:161], v104 offset:0
    ds_read_b64_tr_b16 a[162:163], v104 offset:1024
    v_mfma_f32_16x16x32_bf16 v[32:35], a[72:75], a[40:43], v[32:35]
    v_exp_f32 v27, v27
    v_mfma_f32_16x16x32_bf16 v[32:35], a[76:79], a[44:47], v[32:35]
    ds_read_b64_tr_b16 a[164:165], v104 offset:2048
    v_cvt_pk_bf16_f32 v77, v26, v27
    v_mfma_f32_16x16x32_bf16 v[48:51], a[76:79], a[60:63], 0
    v_exp_f32 v28, v28
    v_mfma_f32_16x16x32_bf16 v[48:51], a[72:75], a[56:59], v[48:51]
    ds_read_b64_tr_b16 a[166:167], v104 offset:3072
    v_mfma_f32_16x16x32_bf16 v[48:51], a[68:71], a[52:55], v[48:51]
    v_exp_f32 v29, v29
    v_mfma_f32_16x16x32_bf16 v[48:51], a[64:67], a[48:51], v[48:51]
    ds_read_b64_tr_b16 a[168:169], v105 offset:0
    v_cvt_pk_bf16_f32 v78, v28, v29
    v_mfma_f32_16x16x32_bf16 v[52:55], a[80:83], a[48:51], 0
    v_exp_f32 v30, v30
    v_mfma_f32_16x16x32_bf16 v[52:55], a[84:87], a[52:55], v[52:55]
    ds_read_b64_tr_b16 a[172:173], v105 offset:2048
    ds_read_b64_tr_b16 a[170:171], v105 offset:1024
    v_mfma_f32_16x16x32_bf16 v[52:55], a[88:91], a[56:59], v[52:55]
    v_exp_f32 v31, v31
    v_mfma_f32_16x16x32_bf16 v[52:55], a[92:95], a[60:63], v[52:55]
    ds_read_b64_tr_b16 a[174:175], v105 offset:3072
    v_cvt_pk_bf16_f32 v79, v30, v31
    v_mfma_f32_16x16x32_bf16 v[36:39], a[92:95], a[44:47], 0
    ds_read_b64_tr_b16 a[176:177], v106 offset:0
    v_mfma_f32_16x16x32_bf16 v[36:39], a[88:91], a[40:43], v[36:39]
    v_exp_f32 v32, v32
    v_mfma_f32_16x16x32_bf16 v[36:39], a[84:87], a[36:39], v[36:39]
    ds_read_b64_tr_b16 a[178:179], v106 offset:1024
    v_mfma_f32_16x16x32_bf16 v[36:39], a[80:83], a[32:35], v[36:39]
    v_exp_f32 v33, v33
    v_mfma_f32_16x16x32_bf16 v[40:43], a[96:99], a[32:35], 0
    ds_read_b64_tr_b16 a[180:181], v106 offset:2048
    v_cvt_pk_bf16_f32 v80, v32, v33
    v_mfma_f32_16x16x32_bf16 v[40:43], a[100:103], a[36:39], v[40:43]
    v_exp_f32 v34, v34
    v_mfma_f32_16x16x32_bf16 v[40:43], a[104:107], a[40:43], v[40:43]
    ds_read_b64_tr_b16 a[182:183], v106 offset:3072
    ds_read_b64_tr_b16 a[184:185], v107 offset:0
    v_mfma_f32_16x16x32_bf16 v[40:43], a[108:111], a[44:47], v[40:43]
    v_exp_f32 v35, v35
    v_mfma_f32_16x16x32_bf16 v[56:59], a[108:111], a[60:63], 0
    ds_read_b64_tr_b16 a[186:187], v107 offset:1024
    v_cvt_pk_bf16_f32 v81, v34, v35
    v_mfma_f32_16x16x32_bf16 v[56:59], a[104:107], a[56:59], v[56:59]
    v_exp_f32 v36, v36
    v_mfma_f32_16x16x32_bf16 v[56:59], a[100:103], a[52:55], v[56:59]
    v_readlane_b32 s56, v108, s39
    v_mfma_f32_16x16x32_bf16 v[56:59], a[96:99], a[48:51], v[56:59]
    v_exp_f32 v37, v37
    v_mfma_f32_16x16x32_bf16 v[60:63], a[112:115], a[48:51], 0
    ds_read_b128 a[64:67], v96 offset:16384
    v_cvt_pk_bf16_f32 v82, v36, v37
    v_mfma_f32_16x16x32_bf16 v[60:63], a[116:119], a[52:55], v[60:63]
    v_exp_f32 v38, v38
    v_mfma_f32_16x16x32_bf16 v[60:63], a[120:123], a[56:59], v[60:63]
    ds_read_b128 a[68:71], v97 offset:16384
    ds_read_b64_tr_b16 a[188:189], v107 offset:2048
    v_mfma_f32_16x16x32_bf16 v[60:63], a[124:127], a[60:63], v[60:63]
    v_exp_f32 v39, v39
    v_mfma_f32_16x16x32_bf16 v[44:47], a[124:127], a[44:47], 0
    ds_read_b128 a[72:75], v98 offset:16384
    v_cvt_pk_bf16_f32 v83, v38, v39
    v_mfma_f32_16x16x32_bf16 v[44:47], a[120:123], a[40:43], v[44:47]
    v_exp_f32 v40, v40
    v_mfma_f32_16x16x32_bf16 v[44:47], a[116:119], a[36:39], v[44:47]
    ds_read_b128 a[76:79], v99 offset:16384
    ds_read_b64_tr_b16 a[190:191], v107 offset:3072
    v_mfma_f32_16x16x32_bf16 v[44:47], a[112:115], a[32:35], v[44:47]
    s_waitcnt lgkmcnt(6)
    v_exp_f32 v41, v41
    v_mfma_f32_16x16x32_bf16 v[128:131], a[128:131], v[64:67], v[128:131]
    ds_read_b128 a[80:83], v96 offset:17408
    v_cvt_pk_bf16_f32 v84, v40, v41
    v_mfma_f32_16x16x32_bf16 v[128:131], a[132:135], v[68:71], v[128:131]
    v_exp_f32 v42, v42
    v_mfma_f32_16x16x32_bf16 v[160:163], a[132:135], v[76:79], v[160:163]
    ds_read_b128 a[84:87], v97 offset:17408
    v_mfma_f32_16x16x32_bf16 v[160:163], a[128:131], v[72:75], v[160:163]
    v_exp_f32 v43, v43
    v_mfma_f32_16x16x32_bf16 v[164:167], a[136:139], v[72:75], v[164:167]
    ds_read_b128 a[88:91], v98 offset:17408
    v_cvt_pk_bf16_f32 v85, v42, v43
    v_mfma_f32_16x16x32_bf16 v[164:167], a[140:143], v[76:79], v[164:167]
    v_exp_f32 v44, v44
    v_mfma_f32_16x16x32_bf16 v[132:135], a[140:143], v[68:71], v[132:135]
    ds_read_b128 a[92:95], v99 offset:17408
    v_mfma_f32_16x16x32_bf16 v[132:135], a[136:139], v[64:67], v[132:135]
    v_exp_f32 v45, v45
    v_mfma_f32_16x16x32_bf16 v[136:139], a[144:147], v[64:67], v[136:139]
    ds_read_b128 a[96:99], v96 offset:18432
    v_cvt_pk_bf16_f32 v86, v44, v45
    v_mfma_f32_16x16x32_bf16 v[136:139], a[148:151], v[68:71], v[136:139]
    v_exp_f32 v46, v46
    v_mfma_f32_16x16x32_bf16 v[168:171], a[148:151], v[76:79], v[168:171]
    ds_read_b128 a[100:103], v97 offset:18432
    v_mfma_f32_16x16x32_bf16 v[168:171], a[144:147], v[72:75], v[168:171]
    v_exp_f32 v47, v47
    v_mfma_f32_16x16x32_bf16 v[172:175], a[152:155], v[72:75], v[172:175]
    ds_read_b128 a[104:107], v98 offset:18432
    v_cvt_pk_bf16_f32 v87, v46, v47
    v_mfma_f32_16x16x32_bf16 v[172:175], a[156:159], v[76:79], v[172:175]
    v_readlane_b32 s57, v109, s39
    v_mfma_f32_16x16x32_bf16 v[140:143], a[156:159], v[68:71], v[140:143]
    v_exp_f32 v48, v48
    v_mfma_f32_16x16x32_bf16 v[140:143], a[152:155], v[64:67], v[140:143]
    ds_read_b128 a[108:111], v99 offset:18432
    v_smfmac_f32_16x16x64_bf16 a[192:195], a[208:211], v[64:71], v114
    v_exp_f32 v49, v49
    v_mfma_f32_16x16x32_bf16 v[144:147], a[160:163], v[64:67], v[144:147]
    ds_read_b128 a[112:115], v96 offset:19456
    v_cvt_pk_bf16_f32 v88, v48, v49
    v_mfma_f32_16x16x32_bf16 v[144:147], a[164:167], v[68:71], v[144:147]
    v_exp_f32 v50, v50
    v_mfma_f32_16x16x32_bf16 v[176:179], a[164:167], v[76:79], v[176:179]
    ds_read_b128 a[116:119], v97 offset:19456
    v_mfma_f32_16x16x32_bf16 v[176:179], a[160:163], v[72:75], v[176:179]
    v_exp_f32 v51, v51
    v_mfma_f32_16x16x32_bf16 v[180:183], a[168:171], v[72:75], v[180:183]
    ds_read_b128 a[120:123], v98 offset:19456
    v_cvt_pk_bf16_f32 v89, v50, v51
    v_mfma_f32_16x16x32_bf16 v[180:183], a[172:175], v[76:79], v[180:183]
    v_exp_f32 v52, v52
    v_mfma_f32_16x16x32_bf16 v[148:151], a[172:175], v[68:71], v[148:151]
    ds_read_b128 a[124:127], v99 offset:19456
    v_mfma_f32_16x16x32_bf16 v[148:151], a[168:171], v[64:67], v[148:151]
    v_exp_f32 v53, v53
    v_mfma_f32_16x16x32_bf16 v[152:155], a[176:179], v[64:67], v[152:155]
    v_cvt_pk_bf16_f32 v90, v52, v53
    v_mfma_f32_16x16x32_bf16 v[152:155], a[180:183], v[68:71], v[152:155]
    v_exp_f32 v54, v54
    v_mfma_f32_16x16x32_bf16 v[184:187], a[180:183], v[76:79], v[184:187]
    v_readlane_b32 s58, v110, s39
    v_mfma_f32_16x16x32_bf16 v[184:187], a[176:179], v[72:75], v[184:187]
    v_exp_f32 v55, v55
    v_mfma_f32_16x16x32_bf16 v[188:191], a[184:187], v[72:75], v[188:191]
    s_waitcnt lgkmcnt(1)
    v_cvt_pk_bf16_f32 v91, v54, v55
    v_mfma_f32_16x16x32_bf16 v[188:191], a[188:191], v[76:79], v[188:191]
    v_exp_f32 v56, v56
    v_mfma_f32_16x16x32_bf16 v[156:159], a[188:191], v[68:71], v[156:159]
    s_sub_u32 s38, s38, 1
    v_readlane_b32 s59, v111, s39
    v_mfma_f32_16x16x32_bf16 v[156:159], a[184:187], v[64:67], v[156:159]
    s_waitcnt lgkmcnt(4)
    v_exp_f32 v57, v57
    v_smfmac_f32_16x16x64_bf16 a[196:199], a[208:211], v[72:79], v114
    v_cvt_pk_bf16_f32 v92, v56, v57
    s_cbranch_scc0 L_b1
L_tail:
    s_cmp_gt_u32 s68, 1
    s_cbranch_scc1 L_tail234
    v_mfma_f32_16x16x32_bf16 v[0:3], a[64:67], a[0:3], 0
    s_waitcnt vmcnt(8)
    v_exp_f32 v58, v58
    v_mfma_f32_16x16x32_bf16 v[0:3], a[68:71], a[4:7], v[0:3]
    s_barrier
    v_mfma_f32_16x16x32_bf16 v[0:3], a[72:75], a[8:11], v[0:3]
    v_exp_f32 v59, v59
    v_mfma_f32_16x16x32_bf16 v[0:3], a[76:79], a[12:15], v[0:3]
    v_exp_f32 v60, v60
    v_mfma_f32_16x16x32_bf16 v[4:7], a[92:95], a[12:15], 0
    v_exp_f32 v61, v61
    v_mfma_f32_16x16x32_bf16 v[4:7], a[88:91], a[8:11], v[4:7]
    v_exp_f32 v62, v62
    v_mfma_f32_16x16x32_bf16 v[4:7], a[84:87], a[4:7], v[4:7]
    v_cvt_pk_bf16_f32 v93, v58, v59
    v_cvt_pk_bf16_f32 v94, v60, v61
    v_mfma_f32_16x16x32_bf16 v[4:7], a[80:83], a[0:3], v[4:7]
    v_exp_f32 v63, v63
    v_mfma_f32_16x16x32_bf16 v[8:11], a[96:99], a[0:3], 0
    ds_read_b128 a[212:215], v96 offset:32768
    v_cvt_pk_bf16_f32 v95, v62, v63
    v_mfma_f32_16x16x32_bf16 v[8:11], a[100:103], a[4:7], v[8:11]
    v_exp_f32 v0, v0
    v_mfma_f32_16x16x32_bf16 v[8:11], a[104:107], a[8:11], v[8:11]
    v_exp_f32 v1, v1
    v_mfma_f32_16x16x32_bf16 v[8:11], a[108:111], a[12:15], v[8:11]
    s_waitcnt lgkmcnt(1)
    ds_read_b128 a[216:219], v97 offset:32768
    v_cvt_pk_bf16_f32 v64, v0, v1
    v_mfma_f32_16x16x32_bf16 v[12:15], a[124:127], a[12:15], 0
    v_exp_f32 v2, v2
    v_mfma_f32_16x16x32_bf16 v[12:15], a[120:123], a[8:11], v[12:15]
    v_exp_f32 v3, v3
    v_mfma_f32_16x16x32_bf16 v[12:15], a[116:119], a[4:7], v[12:15]
    ds_read_b128 a[220:223], v98 offset:32768
    v_cvt_pk_bf16_f32 v65, v2, v3
    v_mfma_f32_16x16x32_bf16 v[12:15], a[112:115], a[0:3], v[12:15]
    v_exp_f32 v4, v4
    v_mfma_f32_16x16x32_bf16 v[192:195], a[128:131], v[80:83], v[192:195]
    v_exp_f32 v5, v5
    v_mfma_f32_16x16x32_bf16 v[192:195], a[132:135], v[84:87], v[192:195]
    ds_read_b128 a[224:227], v99 offset:32768
    v_cvt_pk_bf16_f32 v66, v4, v5
    v_mfma_f32_16x16x32_bf16 v[196:199], a[136:139], v[80:83], v[196:199]
    v_exp_f32 v6, v6
    v_mfma_f32_16x16x32_bf16 v[196:199], a[140:143], v[84:87], v[196:199]
    v_exp_f32 v7, v7
    v_mfma_f32_16x16x32_bf16 v[200:203], a[144:147], v[80:83], v[200:203]
    v_exp_f32 v8, v8
    v_mfma_f32_16x16x32_bf16 v[200:203], a[148:151], v[84:87], v[200:203]
    v_exp_f32 v9, v9
    v_mfma_f32_16x16x32_bf16 v[204:207], a[152:155], v[80:83], v[204:207]
    v_exp_f32 v10, v10
    v_mfma_f32_16x16x32_bf16 v[204:207], a[156:159], v[84:87], v[204:207]
    v_exp_f32 v11, v11
    v_mfma_f32_16x16x32_bf16 v[208:211], a[160:163], v[80:83], v[208:211]
    v_exp_f32 v12, v12
    v_mfma_f32_16x16x32_bf16 v[208:211], a[164:167], v[84:87], v[208:211]
    v_exp_f32 v13, v13
    v_mfma_f32_16x16x32_bf16 v[212:215], a[168:171], v[80:83], v[212:215]
    v_cvt_pk_bf16_f32 v67, v6, v7
    v_cvt_pk_bf16_f32 v68, v8, v9
    v_mfma_f32_16x16x32_bf16 v[212:215], a[172:175], v[84:87], v[212:215]
    v_exp_f32 v14, v14
    v_mfma_f32_16x16x32_bf16 v[216:219], a[176:179], v[80:83], v[216:219]
    v_cvt_pk_bf16_f32 v69, v10, v11
    v_cvt_pk_bf16_f32 v70, v12, v13
    v_mfma_f32_16x16x32_bf16 v[216:219], a[180:183], v[84:87], v[216:219]
    v_exp_f32 v15, v15
    v_mfma_f32_16x16x32_bf16 v[220:223], a[184:187], v[80:83], v[220:223]
    v_cvt_pk_bf16_f32 v71, v14, v15
    v_mbcnt_lo_u32_b32 v120, -1, 0
    v_mfma_f32_16x16x32_bf16 v[220:223], a[188:191], v[84:87], v[220:223]
    v_mbcnt_hi_u32_b32 v120, -1, v120
    v_and_b32 v121, 15, v120
    v_smfmac_f32_16x16x64_bf16 a[200:203], a[208:211], v[80:87], v114
    v_lshrrev_b32 v122, 4, v120
    v_mul_u32_u24 v125, 400, v121
    v_mfma_f32_16x16x32_bf16 v[224:227], a[128:131], v[88:91], v[224:227]
    v_mov_b32 v82, 0
    v_mov_b32 v83, 0
    v_mfma_f32_16x16x32_bf16 v[224:227], a[132:135], v[92:95], v[224:227]
    ds_read_b64_tr_b16 a[128:129], v100 offset:16384
    v_mov_b32 v84, 0
    v_mfma_f32_16x16x32_bf16 v[228:231], a[136:139], v[88:91], v[228:231]
    ds_read_b64_tr_b16 a[130:131], v100 offset:17408
    v_mov_b32 v85, 0
    v_mfma_f32_16x16x32_bf16 v[228:231], a[140:143], v[92:95], v[228:231]
    ds_read_b64_tr_b16 a[132:133], v100 offset:18432
    v_mov_b32 v86, 0
    v_mfma_f32_16x16x32_bf16 v[232:235], a[144:147], v[88:91], v[232:235]
    ds_read_b64_tr_b16 a[134:135], v100 offset:19456
    v_mov_b32 v87, 0
    v_mfma_f32_16x16x32_bf16 v[232:235], a[148:151], v[92:95], v[232:235]
    ds_read_b64_tr_b16 a[136:137], v101 offset:16384
    v_lshl_add_u32 v125, v122, 3, v125
    v_mfma_f32_16x16x32_bf16 v[236:239], a[152:155], v[88:91], v[236:239]
    ds_read_b64_tr_b16 a[138:139], v101 offset:17408
    v_lshrrev_b32 v121, 3, v120
    v_mfma_f32_16x16x32_bf16 v[236:239], a[156:159], v[92:95], v[236:239]
    s_waitcnt vmcnt(4)
    ds_read_b64_tr_b16 a[140:141], v101 offset:18432
    v_and_b32 v122, 7, v120
    v_mfma_f32_16x16x32_bf16 v[240:243], a[160:163], v[88:91], v[240:243]
    s_barrier
    v_mfma_f32_16x16x32_bf16 v[240:243], a[164:167], v[92:95], v[240:243]
    ds_read_b64_tr_b16 a[228:229], v100 offset:32768
    v_mul_u32_u24 v126, 400, v121
    v_mfma_f32_16x16x32_bf16 v[244:247], a[168:171], v[88:91], v[244:247]
    ds_read_b64_tr_b16 a[230:231], v101 offset:32768
    v_lshl_add_u32 v126, v122, 4, v126
    v_mfma_f32_16x16x32_bf16 v[244:247], a[172:175], v[92:95], v[244:247]
    ds_read_b64_tr_b16 a[142:143], v101 offset:19456
    v_add_u32 v125, s81, v125
    v_mfma_f32_16x16x32_bf16 v[248:251], a[176:179], v[88:91], v[248:251]
    ds_read_b64_tr_b16 a[232:233], v102 offset:32768
    v_add_u32 v126, s81, v126
    v_mfma_f32_16x16x32_bf16 v[248:251], a[180:183], v[92:95], v[248:251]
    ds_read_b64_tr_b16 a[144:145], v102 offset:16384
    v_lshlrev_b32 v127, 8, v121
    v_mfma_f32_16x16x32_bf16 v[252:255], a[184:187], v[88:91], v[252:255]
    ds_read_b64_tr_b16 a[146:147], v102 offset:17408
    v_lshl_add_u32 v127, v122, 4, v127
    v_mfma_f32_16x16x32_bf16 v[252:255], a[188:191], v[92:95], v[252:255]
    ds_read_b64_tr_b16 a[148:149], v102 offset:18432
    v_add_u32 v127, s82, v127
    v_smfmac_f32_16x16x64_bf16 a[204:207], a[208:211], v[88:95], v114
    s_waitcnt lgkmcnt(7)
    ds_read_b64_tr_b16 a[150:151], v102 offset:19456
    ds_read_b64_tr_b16 a[234:235], v103 offset:32768
    v_mfma_f32_16x16x32_bf16 v[32:35], a[212:215], a[0:3], v[116:119]
    ds_read_b64_tr_b16 a[152:153], v103 offset:16384
    v_mov_b32 v90, 0
    v_mfma_f32_16x16x32_bf16 v[32:35], a[216:219], a[4:7], v[32:35]
    ds_read_b64_tr_b16 a[154:155], v103 offset:17408
    v_mov_b32 v91, 0
    v_mfma_f32_16x16x32_bf16 v[32:35], a[220:223], a[8:11], v[32:35]
    ds_read_b64_tr_b16 a[156:157], v103 offset:18432
    v_mov_b32 v92, 0
    v_mfma_f32_16x16x32_bf16 v[32:35], a[224:227], a[12:15], v[32:35]
    ds_read_b64_tr_b16 a[158:159], v103 offset:19456
    v_mov_b32 v93, 0
    v_mfma_f32_16x16x32_bf16 v[48:51], a[212:215], a[16:19], v[116:119]
    ds_read_b64_tr_b16 a[236:237], v104 offset:32768
    v_mov_b32 v94, 0
    v_mfma_f32_16x16x32_bf16 v[48:51], a[216:219], a[20:23], v[48:51]
    ds_read_b64_tr_b16 a[160:161], v104 offset:16384
    v_mov_b32 v95, 0
    v_mfma_f32_16x16x32_bf16 v[48:51], a[220:223], a[24:27], v[48:51]
    ds_read_b64_tr_b16 a[162:163], v104 offset:17408
    ds_read_b64_tr_b16 a[164:165], v104 offset:18432
    v_mfma_f32_16x16x32_bf16 v[48:51], a[224:227], a[28:31], v[48:51]
    ds_read_b64_tr_b16 a[166:167], v104 offset:19456
    v_mfma_f32_16x16x32_bf16 v[16:19], a[64:67], a[16:19], 0
    v_exp_f32 v32, v32
    v_mfma_f32_16x16x32_bf16 v[16:19], a[68:71], a[20:23], v[16:19]
    v_exp_f32 v33, v33
    v_mfma_f32_16x16x32_bf16 v[16:19], a[72:75], a[24:27], v[16:19]
    v_exp_f32 v34, v34
    v_mfma_f32_16x16x32_bf16 v[16:19], a[76:79], a[28:31], v[16:19]
    v_exp_f32 v35, v35
    v_mfma_f32_16x16x32_bf16 v[20:23], a[92:95], a[28:31], 0
    v_cvt_pk_bf16_f32 v80, v32, v33
    v_cvt_pk_bf16_f32 v81, v34, v35
    v_mfma_f32_16x16x32_bf16 v[20:23], a[88:91], a[24:27], v[20:23]
    ds_read_b64_tr_b16 a[238:239], v105 offset:32768
    ds_read_b64_tr_b16 a[168:169], v105 offset:16384
    v_mfma_f32_16x16x32_bf16 v[20:23], a[84:87], a[20:23], v[20:23]
    ds_read_b64_tr_b16 a[170:171], v105 offset:17408
    v_mfma_f32_16x16x32_bf16 v[20:23], a[80:83], a[16:19], v[20:23]
    ds_read_b64_tr_b16 a[172:173], v105 offset:18432
    ds_read_b64_tr_b16 a[174:175], v105 offset:19456
    v_mfma_f32_16x16x32_bf16 v[24:27], a[96:99], a[16:19], 0
    ds_read_b64_tr_b16 a[240:241], v106 offset:32768
    v_mfma_f32_16x16x32_bf16 v[24:27], a[100:103], a[20:23], v[24:27]
    ds_read_b64_tr_b16 a[176:177], v106 offset:16384
    ds_read_b64_tr_b16 a[178:179], v106 offset:17408
    v_mfma_f32_16x16x32_bf16 v[24:27], a[104:107], a[24:27], v[24:27]
    v_exp_f32 v16, v16
    v_mfma_f32_16x16x32_bf16 v[24:27], a[108:111], a[28:31], v[24:27]
    ds_read_b64_tr_b16 a[180:181], v106 offset:18432
    ds_read_b64_tr_b16 a[182:183], v106 offset:19456
    v_mfma_f32_16x16x32_bf16 v[28:31], a[124:127], a[28:31], 0
    ds_read_b64_tr_b16 a[242:243], v107 offset:32768
    v_mfma_f32_16x16x32_bf16 v[28:31], a[120:123], a[24:27], v[28:31]
    v_exp_f32 v17, v17
    v_mfma_f32_16x16x32_bf16 v[28:31], a[116:119], a[20:23], v[28:31]
    ds_read_b64_tr_b16 a[184:185], v107 offset:16384
    v_cvt_pk_bf16_f32 v72, v16, v17
    v_mfma_f32_16x16x32_bf16 v[28:31], a[112:115], a[16:19], v[28:31]
    ds_read_b64_tr_b16 a[244:245], v107 offset:33792
    ds_read_b64_tr_b16 a[186:187], v107 offset:17408
    v_smfmac_f32_16x16x64_bf16 a[192:195], a[208:211], v[64:71], v114
    ds_read_b64_tr_b16 a[188:189], v107 offset:18432
    v_smfmac_f32_16x16x64_bf16 a[192:195], a[208:211], v[80:87], v114
    v_exp_f32 v18, v18
    v_mfma_f32_16x16x32_bf16 v[128:131], a[128:131], v[64:67], v[128:131]
    v_exp_f32 v19, v19
    v_mfma_f32_16x16x32_bf16 v[128:131], a[132:135], v[68:71], v[128:131]
    s_waitcnt lgkmcnt(5)
    ds_read_b64_tr_b16 a[190:191], v107 offset:19456
    v_cvt_pk_bf16_f32 v73, v18, v19
    v_mfma_f32_16x16x32_bf16 v[128:131], a[228:231], v[80:83], v[128:131]
    v_exp_f32 v20, v20
    v_mfma_f32_16x16x32_bf16 v[132:135], a[136:139], v[64:67], v[132:135]
    v_exp_f32 v21, v21
    v_mfma_f32_16x16x32_bf16 v[132:135], a[140:143], v[68:71], v[132:135]
    v_accvgpr_read_b32 v120, a192
    v_accvgpr_read_b32 v121, a193
    v_mfma_f32_16x16x32_bf16 v[132:135], a[230:233], v[80:83], v[132:135]
    v_add_f32 v120, v120, v121
    v_cvt_pk_bf16_f32 v74, v20, v21
    v_mfma_f32_16x16x32_bf16 v[136:139], a[144:147], v[64:67], v[136:139]
    v_rcp_f32 v121, v120
    v_mfma_f32_16x16x32_bf16 v[136:139], a[148:151], v[68:71], v[136:139]
    v_subrev_u32 v120, 0x2b800000, v120
    v_mov_b32 v124, v120
    v_mfma_f32_16x16x32_bf16 v[136:139], a[232:235], v[80:83], v[136:139]
    v_exp_f32 v22, v22
    v_mfma_f32_16x16x32_bf16 v[140:143], a[152:155], v[64:67], v[140:143]
    v_exp_f32 v23, v23
    v_mfma_f32_16x16x32_bf16 v[140:143], a[156:159], v[68:71], v[140:143]
    v_mul_f32 v128, v121, v128
    v_mul_f32 v129, v121, v129
    v_mfma_f32_16x16x32_bf16 v[140:143], a[234:237], v[80:83], v[140:143]
    v_exp_f32 v24, v24
    v_mfma_f32_16x16x32_bf16 v[144:147], a[160:163], v[64:67], v[144:147]
    v_mul_f32 v130, v121, v130
    v_mul_f32 v131, v121, v131
    v_mfma_f32_16x16x32_bf16 v[144:147], a[164:167], v[68:71], v[144:147]
    v_mul_f32 v132, v121, v132
    v_mul_f32 v133, v121, v133
    v_mfma_f32_16x16x32_bf16 v[144:147], a[236:239], v[80:83], v[144:147]
    v_exp_f32 v25, v25
    v_mfma_f32_16x16x32_bf16 v[148:151], a[168:171], v[64:67], v[148:151]
    v_mul_f32 v134, v121, v134
    v_mul_f32 v135, v121, v135
    v_mfma_f32_16x16x32_bf16 v[148:151], a[172:175], v[68:71], v[148:151]
    v_cvt_pk_bf16_f32 v128, v128, v129
    v_cvt_pk_bf16_f32 v129, v130, v131
    v_mfma_f32_16x16x32_bf16 v[148:151], a[238:241], v[80:83], v[148:151]
    v_exp_f32 v26, v26
    v_mfma_f32_16x16x32_bf16 v[152:155], a[176:179], v[64:67], v[152:155]
    v_cvt_pk_bf16_f32 v130, v132, v133
    v_cvt_pk_bf16_f32 v131, v134, v135
    v_mfma_f32_16x16x32_bf16 v[152:155], a[180:183], v[68:71], v[152:155]
    s_waitcnt lgkmcnt(0)
    ds_write_b64 v125, v[128:129] offset:0
    v_cvt_pk_bf16_f32 v75, v22, v23
    v_mfma_f32_16x16x32_bf16 v[152:155], a[240:243], v[80:83], v[152:155]
    ds_write_b64 v125, v[130:131] offset:32
    v_cvt_pk_bf16_f32 v76, v24, v25
    v_mfma_f32_16x16x32_bf16 v[156:159], a[184:187], v[64:67], v[156:159]
    v_exp_f32 v27, v27
    v_mfma_f32_16x16x32_bf16 v[156:159], a[188:191], v[68:71], v[156:159]
    v_exp_f32 v28, v28
    v_mfma_f32_16x16x32_bf16 v[156:159], a[242:245], v[80:83], v[156:159]
    v_exp_f32 v48, v48
    v_mfma_f32_16x16x32_bf16 v[0:3], a[212:215], a[32:35], v[116:119]
    v_exp_f32 v29, v29
    v_mfma_f32_16x16x32_bf16 v[0:3], a[216:219], a[36:39], v[0:3]
    v_exp_f32 v49, v49
    v_mfma_f32_16x16x32_bf16 v[0:3], a[220:223], a[40:43], v[0:3]
    v_exp_f32 v30, v30
    v_mfma_f32_16x16x32_bf16 v[0:3], a[224:227], a[44:47], v[0:3]
    v_mul_f32 v136, v121, v136
    v_mul_f32 v137, v121, v137
    v_mfma_f32_16x16x32_bf16 v[32:35], a[64:67], a[32:35], 0
    v_cvt_pk_bf16_f32 v77, v26, v27
    v_mul_f32 v138, v121, v138
    v_mul_f32 v139, v121, v139
    v_pk_mul_f32 v[140:141], v[140:141], v[120:121] op_sel:[0,1] op_sel_hi:[1,1]
    v_pk_mul_f32 v[142:143], v[142:143], v[120:121] op_sel:[0,1] op_sel_hi:[1,1]
    v_cvt_pk_bf16_f32 v136, v136, v137
    v_cvt_pk_bf16_f32 v137, v138, v139
    v_cvt_pk_bf16_f32 v138, v140, v141
    v_cvt_pk_bf16_f32 v139, v142, v143
    ds_write_b64 v125, v[136:137] offset:64
    ds_write_b64 v125, v[138:139] offset:96
    ds_read_b128 v[132:135], v126 offset:0
    ds_read_b128 v[140:143], v126 offset:3200
    v_pk_mul_f32 v[144:145], v[144:145], v[120:121] op_sel:[0,1] op_sel_hi:[1,1]
    v_pk_mul_f32 v[146:147], v[146:147], v[120:121] op_sel:[0,1] op_sel_hi:[1,1]
    v_pk_mul_f32 v[148:149], v[148:149], v[120:121] op_sel:[0,1] op_sel_hi:[1,1]
    v_pk_mul_f32 v[150:151], v[150:151], v[120:121] op_sel:[0,1] op_sel_hi:[1,1]
    v_cvt_pk_bf16_f32 v144, v144, v145
    v_cvt_pk_bf16_f32 v145, v146, v147
    v_cvt_pk_bf16_f32 v146, v148, v149
    v_cvt_pk_bf16_f32 v147, v150, v151
    s_waitcnt lgkmcnt(1)
    buffer_store_dwordx4 v[132:135], v127, s[16:19], s77 offen offset:0 sc1
    ds_write_b64 v125, v[144:145] offset:128
    ds_write_b64 v125, v[146:147] offset:160
    v_pk_mul_f32 v[152:153], v[152:153], v[120:121] op_sel:[0,1] op_sel_hi:[1,1]
    v_pk_mul_f32 v[154:155], v[154:155], v[120:121] op_sel:[0,1] op_sel_hi:[1,1]
    v_pk_mul_f32 v[156:157], v[156:157], v[120:121] op_sel:[0,1] op_sel_hi:[1,1]
    v_pk_mul_f32 v[158:159], v[158:159], v[120:121] op_sel:[0,1] op_sel_hi:[1,1]
    s_waitcnt lgkmcnt(2)
    buffer_store_dwordx4 v[140:143], v127, s[16:19], s77 offen offset:2048 sc1
    v_cvt_pk_bf16_f32 v152, v152, v153
    v_cvt_pk_bf16_f32 v153, v154, v155
    v_cvt_pk_bf16_f32 v154, v156, v157
    v_cvt_pk_bf16_f32 v155, v158, v159
    ds_write_b64 v125, v[152:153] offset:192
    ds_write_b64 v125, v[154:155] offset:224
    ds_read_b128 v[148:151], v126 offset:128
    ds_read_b128 v[156:159], v126 offset:3328
    v_mfma_f32_16x16x32_bf16 v[32:35], a[68:71], a[36:39], v[32:35]
    v_exp_f32 v50, v50
    v_mfma_f32_16x16x32_bf16 v[32:35], a[72:75], a[40:43], v[32:35]
    v_exp_f32 v31, v31
    v_mfma_f32_16x16x32_bf16 v[32:35], a[76:79], a[44:47], v[32:35]
    v_cvt_pk_bf16_f32 v78, v28, v29
    v_cvt_pk_bf16_f32 v79, v30, v31
    v_mfma_f32_16x16x32_bf16 v[36:39], a[92:95], a[44:47], 0
    v_exp_f32 v51, v51
    v_mfma_f32_16x16x32_bf16 v[36:39], a[88:91], a[40:43], v[36:39]
    v_cvt_pk_bf16_f32 v88, v48, v49
    v_cvt_pk_bf16_f32 v89, v50, v51
    v_mfma_f32_16x16x32_bf16 v[36:39], a[84:87], a[36:39], v[36:39]
    v_exp_f32 v0, v0
    v_mfma_f32_16x16x32_bf16 v[36:39], a[80:83], a[32:35], v[36:39]
    v_exp_f32 v1, v1
    v_mfma_f32_16x16x32_bf16 v[40:43], a[96:99], a[32:35], 0
    v_exp_f32 v32, v32
    s_waitcnt lgkmcnt(1)
    buffer_store_dwordx4 v[148:151], v127, s[16:19], s77 offen offset:128 sc1
    s_waitcnt lgkmcnt(0)
    buffer_store_dwordx4 v[156:159], v127, s[16:19], s77 offen offset:2176 sc1
    v_mfma_f32_16x16x32_bf16 v[40:43], a[100:103], a[36:39], v[40:43]
    v_exp_f32 v33, v33
    v_mfma_f32_16x16x32_bf16 v[40:43], a[104:107], a[40:43], v[40:43]
    v_exp_f32 v34, v34
    v_mfma_f32_16x16x32_bf16 v[40:43], a[108:111], a[44:47], v[40:43]
    v_exp_f32 v35, v35
    v_mfma_f32_16x16x32_bf16 v[44:47], a[124:127], a[44:47], 0
    v_exp_f32 v36, v36
    v_mfma_f32_16x16x32_bf16 v[44:47], a[120:123], a[40:43], v[44:47]
    v_exp_f32 v37, v37
    v_mfma_f32_16x16x32_bf16 v[44:47], a[116:119], a[36:39], v[44:47]
    v_exp_f32 v38, v38
    v_mfma_f32_16x16x32_bf16 v[44:47], a[112:115], a[32:35], v[44:47]
    v_exp_f32 v39, v39
    v_smfmac_f32_16x16x64_bf16 a[196:199], a[208:211], v[72:79], v114
    v_exp_f32 v40, v40
    v_smfmac_f32_16x16x64_bf16 a[196:199], a[208:211], v[88:95], v114
    v_exp_f32 v41, v41
    v_mfma_f32_16x16x32_bf16 v[160:163], a[128:131], v[72:75], v[160:163]
    v_exp_f32 v42, v42
    v_mfma_f32_16x16x32_bf16 v[160:163], a[132:135], v[76:79], v[160:163]
    v_exp_f32 v43, v43
    v_mfma_f32_16x16x32_bf16 v[160:163], a[228:231], v[88:91], v[160:163]
    v_exp_f32 v44, v44
    v_mfma_f32_16x16x32_bf16 v[164:167], a[136:139], v[72:75], v[164:167]
    v_cvt_pk_bf16_f32 v80, v32, v33
    v_cvt_pk_bf16_f32 v81, v34, v35
    v_mfma_f32_16x16x32_bf16 v[164:167], a[140:143], v[76:79], v[164:167]
    v_accvgpr_read_b32 v122, a196
    v_accvgpr_read_b32 v123, a197
    v_mfma_f32_16x16x32_bf16 v[164:167], a[230:233], v[88:91], v[164:167]
    v_add_f32 v122, v122, v123
    v_cvt_pk_bf16_f32 v82, v36, v37
    v_mfma_f32_16x16x32_bf16 v[168:171], a[144:147], v[72:75], v[168:171]
    v_rcp_f32 v123, v122
    v_mfma_f32_16x16x32_bf16 v[168:171], a[148:151], v[76:79], v[168:171]
    v_subrev_u32 v122, 0x2b800000, v122
    v_max_u32 v124, v124, v122
    v_mfma_f32_16x16x32_bf16 v[168:171], a[232:235], v[88:91], v[168:171]
    v_exp_f32 v45, v45
    v_mfma_f32_16x16x32_bf16 v[172:175], a[152:155], v[72:75], v[172:175]
    v_cvt_pk_bf16_f32 v83, v38, v39
    v_cvt_pk_bf16_f32 v84, v40, v41
    v_mfma_f32_16x16x32_bf16 v[172:175], a[156:159], v[76:79], v[172:175]
    v_mul_f32 v160, v123, v160
    v_mul_f32 v161, v123, v161
    v_mfma_f32_16x16x32_bf16 v[172:175], a[234:237], v[88:91], v[172:175]
    v_mul_f32 v162, v123, v162
    v_mul_f32 v163, v123, v163
    v_mfma_f32_16x16x32_bf16 v[176:179], a[160:163], v[72:75], v[176:179]
    v_mul_f32 v164, v123, v164
    v_mul_f32 v165, v123, v165
    v_mfma_f32_16x16x32_bf16 v[176:179], a[164:167], v[76:79], v[176:179]
    v_mul_f32 v166, v123, v166
    v_mul_f32 v167, v123, v167
    v_mfma_f32_16x16x32_bf16 v[176:179], a[236:239], v[88:91], v[176:179]
    v_cvt_pk_bf16_f32 v160, v160, v161
    v_cvt_pk_bf16_f32 v161, v162, v163
    v_mfma_f32_16x16x32_bf16 v[180:183], a[168:171], v[72:75], v[180:183]
    v_cvt_pk_bf16_f32 v162, v164, v165
    v_cvt_pk_bf16_f32 v163, v166, v167
    v_mfma_f32_16x16x32_bf16 v[180:183], a[172:175], v[76:79], v[180:183]
    ds_write_b64 v125, v[160:161] offset:0
    v_cvt_pk_bf16_f32 v85, v42, v43
    v_mfma_f32_16x16x32_bf16 v[180:183], a[238:241], v[88:91], v[180:183]
    ds_write_b64 v125, v[162:163] offset:32
    v_mul_f32 v168, v123, v168
    v_mfma_f32_16x16x32_bf16 v[184:187], a[176:179], v[72:75], v[184:187]
    v_exp_f32 v46, v46
    v_mfma_f32_16x16x32_bf16 v[184:187], a[180:183], v[76:79], v[184:187]
    v_mul_f32 v169, v123, v169
    v_mul_f32 v170, v123, v170
    v_mfma_f32_16x16x32_bf16 v[184:187], a[240:243], v[88:91], v[184:187]
    v_exp_f32 v2, v2
    v_mfma_f32_16x16x32_bf16 v[188:191], a[184:187], v[72:75], v[188:191]
    v_mul_f32 v171, v123, v171
    v_cvt_pk_bf16_f32 v86, v44, v45
    v_mfma_f32_16x16x32_bf16 v[188:191], a[188:191], v[76:79], v[188:191]
    v_exp_f32 v47, v47
    v_mfma_f32_16x16x32_bf16 v[188:191], a[242:245], v[88:91], v[188:191]
    v_mul_f32 v172, v123, v172
    v_mul_f32 v173, v123, v173
    v_mfma_f32_16x16x32_bf16 v[16:19], a[212:215], a[48:51], v[116:119]
    v_cvt_pk_bf16_f32 v87, v46, v47
    v_cvt_pk_bf16_f32 v64, v0, v1
    v_mfma_f32_16x16x32_bf16 v[16:19], a[216:219], a[52:55], v[16:19]
    v_exp_f32 v3, v3
    v_mfma_f32_16x16x32_bf16 v[16:19], a[220:223], a[56:59], v[16:19]
    v_mul_f32 v174, v123, v174
    v_mul_f32 v175, v123, v175
    v_mfma_f32_16x16x32_bf16 v[16:19], a[224:227], a[60:63], v[16:19]
    v_cvt_pk_bf16_f32 v65, v2, v3
    v_mov_b32 v66, 0
    v_mfma_f32_16x16x32_bf16 v[48:51], a[64:67], a[48:51], 0
    v_mov_b32 v67, 0
    v_mov_b32 v68, 0
    v_cvt_pk_bf16_f32 v168, v168, v169
    v_cvt_pk_bf16_f32 v169, v170, v171
    v_cvt_pk_bf16_f32 v170, v172, v173
    v_cvt_pk_bf16_f32 v171, v174, v175
    ds_write_b64 v125, v[168:169] offset:64
    ds_write_b64 v125, v[170:171] offset:96
    ds_read_b128 v[164:167], v126 offset:0
    ds_read_b128 v[172:175], v126 offset:3200
    v_pk_mul_f32 v[176:177], v[176:177], v[122:123] op_sel:[0,1] op_sel_hi:[1,1]
    v_pk_mul_f32 v[178:179], v[178:179], v[122:123] op_sel:[0,1] op_sel_hi:[1,1]
    v_pk_mul_f32 v[180:181], v[180:181], v[122:123] op_sel:[0,1] op_sel_hi:[1,1]
    v_pk_mul_f32 v[182:183], v[182:183], v[122:123] op_sel:[0,1] op_sel_hi:[1,1]
    v_cvt_pk_bf16_f32 v176, v176, v177
    v_cvt_pk_bf16_f32 v177, v178, v179
    v_cvt_pk_bf16_f32 v178, v180, v181
    v_cvt_pk_bf16_f32 v179, v182, v183
    s_waitcnt lgkmcnt(1)
    buffer_store_dwordx4 v[164:167], v127, s[16:19], s72 offen offset:0 sc1
    ds_write_b64 v125, v[176:177] offset:128
    ds_write_b64 v125, v[178:179] offset:160
    v_pk_mul_f32 v[184:185], v[184:185], v[122:123] op_sel:[0,1] op_sel_hi:[1,1]
    v_pk_mul_f32 v[186:187], v[186:187], v[122:123] op_sel:[0,1] op_sel_hi:[1,1]
    v_pk_mul_f32 v[188:189], v[188:189], v[122:123] op_sel:[0,1] op_sel_hi:[1,1]
    v_pk_mul_f32 v[190:191], v[190:191], v[122:123] op_sel:[0,1] op_sel_hi:[1,1]
    s_waitcnt lgkmcnt(2)
    buffer_store_dwordx4 v[172:175], v127, s[16:19], s72 offen offset:2048 sc1
    v_cvt_pk_bf16_f32 v184, v184, v185
    v_cvt_pk_bf16_f32 v185, v186, v187
    v_cvt_pk_bf16_f32 v186, v188, v189
    v_cvt_pk_bf16_f32 v187, v190, v191
    ds_write_b64 v125, v[184:185] offset:192
    ds_write_b64 v125, v[186:187] offset:224
    ds_read_b128 v[180:183], v126 offset:128
    ds_read_b128 v[188:191], v126 offset:3328
    v_mfma_f32_16x16x32_bf16 v[48:51], a[68:71], a[52:55], v[48:51]
    v_mov_b32 v69, 0
    v_mov_b32 v70, 0
    v_mfma_f32_16x16x32_bf16 v[48:51], a[72:75], a[56:59], v[48:51]
    v_mov_b32 v71, 0
    v_mov_b32 v74, 0
    v_mfma_f32_16x16x32_bf16 v[48:51], a[76:79], a[60:63], v[48:51]
    v_mov_b32 v75, 0
    v_mov_b32 v76, 0
    v_mfma_f32_16x16x32_bf16 v[52:55], a[92:95], a[60:63], 0
    v_exp_f32 v16, v16
    v_mfma_f32_16x16x32_bf16 v[52:55], a[88:91], a[56:59], v[52:55]
    v_exp_f32 v17, v17
    v_mfma_f32_16x16x32_bf16 v[52:55], a[84:87], a[52:55], v[52:55]
    v_exp_f32 v18, v18
    v_mfma_f32_16x16x32_bf16 v[52:55], a[80:83], a[48:51], v[52:55]
    v_exp_f32 v19, v19
    v_mfma_f32_16x16x32_bf16 v[56:59], a[96:99], a[48:51], 0
    v_exp_f32 v48, v48
    s_waitcnt lgkmcnt(1)
    buffer_store_dwordx4 v[180:183], v127, s[16:19], s72 offen offset:128 sc1
    s_waitcnt lgkmcnt(0)
    buffer_store_dwordx4 v[188:191], v127, s[16:19], s72 offen offset:2176 sc1
    v_mfma_f32_16x16x32_bf16 v[56:59], a[100:103], a[52:55], v[56:59]
    v_exp_f32 v49, v49
    v_mfma_f32_16x16x32_bf16 v[56:59], a[104:107], a[56:59], v[56:59]
    v_exp_f32 v50, v50
    v_mfma_f32_16x16x32_bf16 v[56:59], a[108:111], a[60:63], v[56:59]
    v_exp_f32 v51, v51
    v_mfma_f32_16x16x32_bf16 v[60:63], a[124:127], a[60:63], 0
    v_exp_f32 v52, v52
    v_mfma_f32_16x16x32_bf16 v[60:63], a[120:123], a[56:59], v[60:63]
    v_exp_f32 v53, v53
    v_mfma_f32_16x16x32_bf16 v[60:63], a[116:119], a[52:55], v[60:63]
    v_exp_f32 v54, v54
    v_mfma_f32_16x16x32_bf16 v[60:63], a[112:115], a[48:51], v[60:63]
    v_exp_f32 v55, v55
    v_smfmac_f32_16x16x64_bf16 a[200:203], a[208:211], v[80:87], v114
    v_exp_f32 v56, v56
    v_smfmac_f32_16x16x64_bf16 a[200:203], a[208:211], v[64:71], v114
    v_exp_f32 v57, v57
    v_mfma_f32_16x16x32_bf16 v[192:195], a[128:131], v[80:83], v[192:195]
    v_exp_f32 v58, v58
    v_mfma_f32_16x16x32_bf16 v[192:195], a[132:135], v[84:87], v[192:195]
    v_exp_f32 v59, v59
    v_mfma_f32_16x16x32_bf16 v[192:195], a[228:231], v[64:67], v[192:195]
    v_exp_f32 v60, v60
    v_mfma_f32_16x16x32_bf16 v[196:199], a[136:139], v[80:83], v[196:199]
    v_cvt_pk_bf16_f32 v88, v48, v49
    v_cvt_pk_bf16_f32 v89, v50, v51
    v_mfma_f32_16x16x32_bf16 v[196:199], a[140:143], v[84:87], v[196:199]
    v_exp_f32 v61, v61
    v_mfma_f32_16x16x32_bf16 v[196:199], a[230:233], v[64:67], v[196:199]
    v_cvt_pk_bf16_f32 v90, v52, v53
    v_accvgpr_read_b32 v120, a200
    v_mfma_f32_16x16x32_bf16 v[200:203], a[144:147], v[80:83], v[200:203]
    v_accvgpr_read_b32 v121, a201
    v_cvt_pk_bf16_f32 v91, v54, v55
    v_mfma_f32_16x16x32_bf16 v[200:203], a[148:151], v[84:87], v[200:203]
    v_add_f32 v120, v120, v121
    v_cvt_pk_bf16_f32 v92, v56, v57
    v_mfma_f32_16x16x32_bf16 v[200:203], a[232:235], v[64:67], v[200:203]
    v_rcp_f32 v121, v120
    v_mfma_f32_16x16x32_bf16 v[204:207], a[152:155], v[80:83], v[204:207]
    v_exp_f32 v62, v62
    v_mfma_f32_16x16x32_bf16 v[204:207], a[156:159], v[84:87], v[204:207]
    v_subrev_u32 v120, 0x2b800000, v120
    v_max_u32 v124, v124, v120
    v_mfma_f32_16x16x32_bf16 v[204:207], a[234:237], v[64:67], v[204:207]
    v_cvt_pk_bf16_f32 v93, v58, v59
    v_cvt_pk_bf16_f32 v94, v60, v61
    v_mfma_f32_16x16x32_bf16 v[208:211], a[160:163], v[80:83], v[208:211]
    v_exp_f32 v63, v63
    v_mfma_f32_16x16x32_bf16 v[208:211], a[164:167], v[84:87], v[208:211]
    v_cvt_pk_bf16_f32 v95, v62, v63
    v_cvt_pk_bf16_f32 v72, v16, v17
    v_mfma_f32_16x16x32_bf16 v[208:211], a[236:239], v[64:67], v[208:211]
    v_cvt_pk_bf16_f32 v73, v18, v19
    v_mov_b32 v77, 0
    v_mfma_f32_16x16x32_bf16 v[212:215], a[168:171], v[80:83], v[212:215]
    v_mov_b32 v78, 0
    v_mov_b32 v79, 0
    v_mfma_f32_16x16x32_bf16 v[212:215], a[172:175], v[84:87], v[212:215]
    v_mul_f32 v192, v121, v192
    v_mul_f32 v193, v121, v193
    v_mfma_f32_16x16x32_bf16 v[212:215], a[238:241], v[64:67], v[212:215]
    v_mul_f32 v194, v121, v194
    v_mul_f32 v195, v121, v195
    v_mfma_f32_16x16x32_bf16 v[216:219], a[176:179], v[80:83], v[216:219]
    v_mul_f32 v196, v121, v196
    v_mul_f32 v197, v121, v197
    v_mfma_f32_16x16x32_bf16 v[216:219], a[180:183], v[84:87], v[216:219]
    v_mul_f32 v198, v121, v198
    v_mul_f32 v199, v121, v199
    v_mfma_f32_16x16x32_bf16 v[216:219], a[240:243], v[64:67], v[216:219]
    v_cvt_pk_bf16_f32 v192, v192, v193
    v_cvt_pk_bf16_f32 v193, v194, v195
    v_mfma_f32_16x16x32_bf16 v[220:223], a[184:187], v[80:83], v[220:223]
    v_cvt_pk_bf16_f32 v194, v196, v197
    v_cvt_pk_bf16_f32 v195, v198, v199
    v_mfma_f32_16x16x32_bf16 v[220:223], a[188:191], v[84:87], v[220:223]
    ds_write_b64 v125, v[192:193] offset:0
    ds_write_b64 v125, v[194:195] offset:32
    v_mfma_f32_16x16x32_bf16 v[220:223], a[242:245], v[64:67], v[220:223]
    v_mul_f32 v200, v121, v200
    v_mul_f32 v201, v121, v201
    v_smfmac_f32_16x16x64_bf16 a[204:207], a[208:211], v[88:95], v114
    v_mul_f32 v202, v121, v202
    v_mul_f32 v203, v121, v203
    v_smfmac_f32_16x16x64_bf16 a[204:207], a[208:211], v[72:79], v114
    v_mul_f32 v204, v121, v204
    v_mul_f32 v205, v121, v205
    v_mfma_f32_16x16x32_bf16 v[224:227], a[128:131], v[88:91], v[224:227]
    v_mul_f32 v206, v121, v206
    v_mul_f32 v207, v121, v207
    v_mfma_f32_16x16x32_bf16 v[224:227], a[132:135], v[92:95], v[224:227]
    v_cvt_pk_bf16_f32 v200, v200, v201
    v_cvt_pk_bf16_f32 v201, v202, v203
    v_mfma_f32_16x16x32_bf16 v[224:227], a[228:231], v[72:75], v[224:227]
    v_cvt_pk_bf16_f32 v202, v204, v205
    v_cvt_pk_bf16_f32 v203, v206, v207
    ds_write_b64 v125, v[200:201] offset:64
    ds_write_b64 v125, v[202:203] offset:96
    ds_read_b128 v[196:199], v126 offset:0
    ds_read_b128 v[204:207], v126 offset:3200
    v_pk_mul_f32 v[208:209], v[208:209], v[120:121] op_sel:[0,1] op_sel_hi:[1,1]
    v_pk_mul_f32 v[210:211], v[210:211], v[120:121] op_sel:[0,1] op_sel_hi:[1,1]
    v_pk_mul_f32 v[212:213], v[212:213], v[120:121] op_sel:[0,1] op_sel_hi:[1,1]
    v_pk_mul_f32 v[214:215], v[214:215], v[120:121] op_sel:[0,1] op_sel_hi:[1,1]
    v_cvt_pk_bf16_f32 v208, v208, v209
    v_cvt_pk_bf16_f32 v209, v210, v211
    v_cvt_pk_bf16_f32 v210, v212, v213
    v_cvt_pk_bf16_f32 v211, v214, v215
    s_waitcnt lgkmcnt(1)
    buffer_store_dwordx4 v[196:199], v127, s[16:19], s73 offen offset:0 sc1
    ds_write_b64 v125, v[208:209] offset:128
    ds_write_b64 v125, v[210:211] offset:160
    v_pk_mul_f32 v[216:217], v[216:217], v[120:121] op_sel:[0,1] op_sel_hi:[1,1]
    v_pk_mul_f32 v[218:219], v[218:219], v[120:121] op_sel:[0,1] op_sel_hi:[1,1]
    v_pk_mul_f32 v[220:221], v[220:221], v[120:121] op_sel:[0,1] op_sel_hi:[1,1]
    v_pk_mul_f32 v[222:223], v[222:223], v[120:121] op_sel:[0,1] op_sel_hi:[1,1]
    s_waitcnt lgkmcnt(2)
    buffer_store_dwordx4 v[204:207], v127, s[16:19], s73 offen offset:2048 sc1
    v_cvt_pk_bf16_f32 v216, v216, v217
    v_cvt_pk_bf16_f32 v217, v218, v219
    v_cvt_pk_bf16_f32 v218, v220, v221
    v_cvt_pk_bf16_f32 v219, v222, v223
    ds_write_b64 v125, v[216:217] offset:192
    ds_write_b64 v125, v[218:219] offset:224
    ds_read_b128 v[212:215], v126 offset:128
    ds_read_b128 v[220:223], v126 offset:3328
    v_mfma_f32_16x16x32_bf16 v[228:231], a[136:139], v[88:91], v[228:231]
    v_mfma_f32_16x16x32_bf16 v[228:231], a[140:143], v[92:95], v[228:231]
    v_accvgpr_read_b32 v122, a204
    v_accvgpr_read_b32 v123, a205
    v_mfma_f32_16x16x32_bf16 v[228:231], a[230:233], v[72:75], v[228:231]
    v_add_f32 v122, v122, v123
    v_mfma_f32_16x16x32_bf16 v[232:235], a[144:147], v[88:91], v[232:235]
    v_rcp_f32 v123, v122
    v_mfma_f32_16x16x32_bf16 v[232:235], a[148:151], v[92:95], v[232:235]
    v_subrev_u32 v122, 0x2b800000, v122
    v_max_u32 v124, v124, v122
    v_mfma_f32_16x16x32_bf16 v[232:235], a[232:235], v[72:75], v[232:235]
    v_mfma_f32_16x16x32_bf16 v[236:239], a[152:155], v[88:91], v[236:239]
    v_mfma_f32_16x16x32_bf16 v[236:239], a[156:159], v[92:95], v[236:239]
    v_mul_f32 v224, v123, v224
    v_mul_f32 v225, v123, v225
    s_waitcnt lgkmcnt(1)
    buffer_store_dwordx4 v[212:215], v127, s[16:19], s73 offen offset:128 sc1
    s_waitcnt lgkmcnt(0)
    buffer_store_dwordx4 v[220:223], v127, s[16:19], s73 offen offset:2176 sc1
    v_mfma_f32_16x16x32_bf16 v[236:239], a[234:237], v[72:75], v[236:239]
    v_mul_f32 v226, v123, v226
    v_mul_f32 v227, v123, v227
    v_mfma_f32_16x16x32_bf16 v[240:243], a[160:163], v[88:91], v[240:243]
    v_mul_f32 v228, v123, v228
    v_mul_f32 v229, v123, v229
    v_mfma_f32_16x16x32_bf16 v[240:243], a[164:167], v[92:95], v[240:243]
    v_mul_f32 v230, v123, v230
    v_mul_f32 v231, v123, v231
    v_mfma_f32_16x16x32_bf16 v[240:243], a[236:239], v[72:75], v[240:243]
    v_cvt_pk_bf16_f32 v224, v224, v225
    v_cvt_pk_bf16_f32 v225, v226, v227
    v_mfma_f32_16x16x32_bf16 v[244:247], a[168:171], v[88:91], v[244:247]
    v_cvt_pk_bf16_f32 v226, v228, v229
    v_cvt_pk_bf16_f32 v227, v230, v231
    v_mfma_f32_16x16x32_bf16 v[244:247], a[172:175], v[92:95], v[244:247]
    ds_write_b64 v125, v[224:225] offset:0
    ds_write_b64 v125, v[226:227] offset:32
    v_mfma_f32_16x16x32_bf16 v[244:247], a[238:241], v[72:75], v[244:247]
    v_mul_f32 v232, v123, v232
    v_mul_f32 v233, v123, v233
    v_mfma_f32_16x16x32_bf16 v[248:251], a[176:179], v[88:91], v[248:251]
    v_mul_f32 v234, v123, v234
    v_mul_f32 v235, v123, v235
    v_mfma_f32_16x16x32_bf16 v[248:251], a[180:183], v[92:95], v[248:251]
    v_mul_f32 v236, v123, v236
    v_mul_f32 v237, v123, v237
    v_mfma_f32_16x16x32_bf16 v[248:251], a[240:243], v[72:75], v[248:251]
    v_mul_f32 v238, v123, v238
    v_mul_f32 v239, v123, v239
    v_mfma_f32_16x16x32_bf16 v[252:255], a[184:187], v[88:91], v[252:255]
    v_cvt_pk_bf16_f32 v232, v232, v233
    v_cvt_pk_bf16_f32 v233, v234, v235
    v_mfma_f32_16x16x32_bf16 v[252:255], a[188:191], v[92:95], v[252:255]
    v_cvt_pk_bf16_f32 v234, v236, v237
    v_cvt_pk_bf16_f32 v235, v238, v239
    v_mfma_f32_16x16x32_bf16 v[252:255], a[242:245], v[72:75], v[252:255]
    ds_write_b64 v125, v[232:233] offset:64
    ds_write_b64 v125, v[234:235] offset:96
    ds_read_b128 v[228:231], v126 offset:0
    ds_read_b128 v[236:239], v126 offset:3200
    v_pk_mul_f32 v[240:241], v[240:241], v[122:123] op_sel:[0,1] op_sel_hi:[1,1]
    v_pk_mul_f32 v[242:243], v[242:243], v[122:123] op_sel:[0,1] op_sel_hi:[1,1]
    v_pk_mul_f32 v[244:245], v[244:245], v[122:123] op_sel:[0,1] op_sel_hi:[1,1]
    v_pk_mul_f32 v[246:247], v[246:247], v[122:123] op_sel:[0,1] op_sel_hi:[1,1]
    v_cvt_pk_bf16_f32 v240, v240, v241
    v_cvt_pk_bf16_f32 v241, v242, v243
    v_cvt_pk_bf16_f32 v242, v244, v245
    v_cvt_pk_bf16_f32 v243, v246, v247
    s_waitcnt lgkmcnt(1)
    buffer_store_dwordx4 v[228:231], v127, s[16:19], s74 offen offset:0 sc1
    ds_write_b64 v125, v[240:241] offset:128
    ds_write_b64 v125, v[242:243] offset:160
    v_pk_mul_f32 v[248:249], v[248:249], v[122:123] op_sel:[0,1] op_sel_hi:[1,1]
    v_pk_mul_f32 v[250:251], v[250:251], v[122:123] op_sel:[0,1] op_sel_hi:[1,1]
    v_pk_mul_f32 v[252:253], v[252:253], v[122:123] op_sel:[0,1] op_sel_hi:[1,1]
    v_pk_mul_f32 v[254:255], v[254:255], v[122:123] op_sel:[0,1] op_sel_hi:[1,1]
    s_waitcnt lgkmcnt(2)
    buffer_store_dwordx4 v[236:239], v127, s[16:19], s74 offen offset:2048 sc1
    v_cvt_pk_bf16_f32 v248, v248, v249
    v_cvt_pk_bf16_f32 v249, v250, v251
    v_cvt_pk_bf16_f32 v250, v252, v253
    v_cvt_pk_bf16_f32 v251, v254, v255
    ds_write_b64 v125, v[248:249] offset:192
    ds_write_b64 v125, v[250:251] offset:224
    ds_read_b128 v[244:247], v126 offset:128
    ds_read_b128 v[252:255], v126 offset:3328
    s_waitcnt lgkmcnt(1)
    buffer_store_dwordx4 v[244:247], v127, s[16:19], s74 offen offset:128 sc1
    s_waitcnt lgkmcnt(0)
    buffer_store_dwordx4 v[252:255], v127, s[16:19], s74 offen offset:2176 sc1
    v_cmp_lt_u32 vcc, 0x28000000, v124
    s_cmp_lg_u32 s70, 0
    s_cbranch_scc1 L_slow
    s_nop 3
    s_cbranch_vccnz L_slow
    s_endpgm
L_pfend:
L_tail234:
    s_cmp_eq_u32 s68, 3
    s_cbranch_scc1 L_tail3
    s_cmp_eq_u32 s68, 4
    s_cbranch_scc1 L_tail4
    v_mfma_f32_16x16x32_bf16 v[0:3], a[64:67], a[0:3], 0
    s_waitcnt vmcnt(8)
    v_exp_f32 v58, v58
    v_mfma_f32_16x16x32_bf16 v[0:3], a[68:71], a[4:7], v[0:3]
    s_barrier
    v_mfma_f32_16x16x32_bf16 v[0:3], a[72:75], a[8:11], v[0:3]
    v_exp_f32 v59, v59
    v_mfma_f32_16x16x32_bf16 v[0:3], a[76:79], a[12:15], v[0:3]
    v_exp_f32 v60, v60
    v_mfma_f32_16x16x32_bf16 v[4:7], a[92:95], a[12:15], 0
    v_exp_f32 v61, v61
    v_mfma_f32_16x16x32_bf16 v[4:7], a[88:91], a[8:11], v[4:7]
    v_exp_f32 v62, v62
    v_mfma_f32_16x16x32_bf16 v[4:7], a[84:87], a[4:7], v[4:7]
    v_cvt_pk_bf16_f32 v93, v58, v59
    v_cvt_pk_bf16_f32 v94, v60, v61
    v_mfma_f32_16x16x32_bf16 v[4:7], a[80:83], a[0:3], v[4:7]
    v_exp_f32 v63, v63
    v_mfma_f32_16x16x32_bf16 v[8:11], a[96:99], a[0:3], 0
    s_add_u32 m0, s65, 49152
    v_exp_f32 v0, v0
    v_mfma_f32_16x16x32_bf16 v[8:11], a[100:103], a[4:7], v[8:11]
    v_exp_f32 v1, v1
    v_mfma_f32_16x16x32_bf16 v[8:11], a[104:107], a[8:11], v[8:11]
    s_nop 0
    buffer_load_dwordx4 v113, s[12:15], s60 offen offset:0 sc1 lds
    v_mfma_f32_16x16x32_bf16 v[8:11], a[108:111], a[12:15], v[8:11]
    s_waitcnt lgkmcnt(0)
    v_cvt_pk_bf16_f32 v95, v62, v63
    v_cvt_pk_bf16_f32 v64, v0, v1
    v_mfma_f32_16x16x32_bf16 v[12:15], a[124:127], a[12:15], 0
    v_exp_f32 v2, v2
    v_mfma_f32_16x16x32_bf16 v[12:15], a[120:123], a[8:11], v[12:15]
    v_exp_f32 v3, v3
    v_mfma_f32_16x16x32_bf16 v[12:15], a[116:119], a[4:7], v[12:15]
    s_nop 0
    buffer_load_dwordx4 v113, s[12:15], s61 offen offset:1024 sc1 lds
    v_mfma_f32_16x16x32_bf16 v[12:15], a[112:115], a[0:3], v[12:15]
    v_exp_f32 v4, v4
    v_mfma_f32_16x16x32_bf16 v[192:195], a[128:131], v[80:83], v[192:195]
    v_exp_f32 v5, v5
    v_mfma_f32_16x16x32_bf16 v[192:195], a[132:135], v[84:87], v[192:195]
    v_exp_f32 v6, v6
    v_mfma_f32_16x16x32_bf16 v[196:199], a[136:139], v[80:83], v[196:199]
    s_nop 0
    buffer_load_dwordx4 v113, s[12:15], s62 offen offset:2048 sc1 lds
    v_mfma_f32_16x16x32_bf16 v[196:199], a[140:143], v[84:87], v[196:199]
    v_exp_f32 v7, v7
    v_mfma_f32_16x16x32_bf16 v[200:203], a[144:147], v[80:83], v[200:203]
    v_exp_f32 v8, v8
    v_mfma_f32_16x16x32_bf16 v[200:203], a[148:151], v[84:87], v[200:203]
    v_exp_f32 v9, v9
    v_mfma_f32_16x16x32_bf16 v[204:207], a[152:155], v[80:83], v[204:207]
    s_nop 0
    buffer_load_dwordx4 v113, s[12:15], s63 offen offset:3072 sc1 lds
    v_mfma_f32_16x16x32_bf16 v[204:207], a[156:159], v[84:87], v[204:207]
    v_exp_f32 v10, v10
    v_mfma_f32_16x16x32_bf16 v[208:211], a[160:163], v[80:83], v[208:211]
    v_exp_f32 v11, v11
    v_mfma_f32_16x16x32_bf16 v[208:211], a[164:167], v[84:87], v[208:211]
    v_exp_f32 v12, v12
    v_mfma_f32_16x16x32_bf16 v[212:215], a[168:171], v[80:83], v[212:215]
    v_cvt_pk_bf16_f32 v65, v2, v3
    v_cvt_pk_bf16_f32 v66, v4, v5
    v_mfma_f32_16x16x32_bf16 v[212:215], a[172:175], v[84:87], v[212:215]
    v_exp_f32 v13, v13
    v_mfma_f32_16x16x32_bf16 v[216:219], a[176:179], v[80:83], v[216:219]
    v_cvt_pk_bf16_f32 v67, v6, v7
    v_cvt_pk_bf16_f32 v68, v8, v9
    v_mfma_f32_16x16x32_bf16 v[216:219], a[180:183], v[84:87], v[216:219]
    v_exp_f32 v14, v14
    v_mfma_f32_16x16x32_bf16 v[220:223], a[184:187], v[80:83], v[220:223]
    v_cvt_pk_bf16_f32 v69, v10, v11
    v_cvt_pk_bf16_f32 v70, v12, v13
    v_mfma_f32_16x16x32_bf16 v[220:223], a[188:191], v[84:87], v[220:223]
    v_exp_f32 v15, v15
    v_smfmac_f32_16x16x64_bf16 a[200:203], a[208:211], v[80:87], v114
    v_cvt_pk_bf16_f32 v71, v14, v15
    v_mbcnt_lo_u32_b32 v120, -1, 0
    v_mfma_f32_16x16x32_bf16 v[16:19], a[64:67], a[16:19], 0
    v_mbcnt_hi_u32_b32 v120, -1, v120
    v_and_b32 v121, 15, v120
    v_mfma_f32_16x16x32_bf16 v[16:19], a[68:71], a[20:23], v[16:19]
    ds_read_b128 a[64:67], v96 offset:32768
    v_lshrrev_b32 v122, 4, v120
    v_mfma_f32_16x16x32_bf16 v[16:19], a[72:75], a[24:27], v[16:19]
    ds_read_b128 a[68:71], v97 offset:32768
    v_mul_u32_u24 v125, 400, v121
    v_mfma_f32_16x16x32_bf16 v[16:19], a[76:79], a[28:31], v[16:19]
    ds_read_b128 a[72:75], v98 offset:32768
    v_lshl_add_u32 v125, v122, 3, v125
    v_mfma_f32_16x16x32_bf16 v[20:23], a[92:95], a[28:31], 0
    ds_read_b128 a[76:79], v99 offset:32768
    v_lshrrev_b32 v121, 3, v120
    v_mfma_f32_16x16x32_bf16 v[20:23], a[88:91], a[24:27], v[20:23]
    ds_read_b128 a[92:95], v99 offset:33792
    v_and_b32 v122, 7, v120
    v_mfma_f32_16x16x32_bf16 v[20:23], a[84:87], a[20:23], v[20:23]
    ds_read_b128 a[88:91], v98 offset:33792
    v_mul_u32_u24 v126, 400, v121
    v_mfma_f32_16x16x32_bf16 v[20:23], a[80:83], a[16:19], v[20:23]
    ds_read_b128 a[84:87], v97 offset:33792
    v_lshl_add_u32 v126, v122, 4, v126
    v_mfma_f32_16x16x32_bf16 v[24:27], a[96:99], a[16:19], 0
    ds_read_b128 a[80:83], v96 offset:33792
    v_add_u32 v125, s81, v125
    v_mfma_f32_16x16x32_bf16 v[24:27], a[100:103], a[20:23], v[24:27]
    ds_read_b128 a[96:99], v96 offset:34816
    v_add_u32 v126, s81, v126
    v_mfma_f32_16x16x32_bf16 v[24:27], a[104:107], a[24:27], v[24:27]
    ds_read_b128 a[100:103], v97 offset:34816
    v_lshlrev_b32 v127, 8, v121
    v_mfma_f32_16x16x32_bf16 v[24:27], a[108:111], a[28:31], v[24:27]
    ds_read_b128 a[104:107], v98 offset:34816
    v_lshl_add_u32 v127, v122, 4, v127
    v_mfma_f32_16x16x32_bf16 v[28:31], a[124:127], a[28:31], 0
    ds_read_b128 a[108:111], v99 offset:34816
    v_add_u32 v127, s82, v127
    v_mfma_f32_16x16x32_bf16 v[28:31], a[120:123], a[24:27], v[28:31]
    v_exp_f32 v16, v16
    v_mfma_f32_16x16x32_bf16 v[28:31], a[116:119], a[20:23], v[28:31]
    v_exp_f32 v17, v17
    v_mfma_f32_16x16x32_bf16 v[28:31], a[112:115], a[16:19], v[28:31]
    ds_read_b128 a[124:127], v99 offset:35840
    v_cvt_pk_bf16_f32 v72, v16, v17
    v_mfma_f32_16x16x32_bf16 v[224:227], a[128:131], v[88:91], v[224:227]
    v_exp_f32 v18, v18
    v_mfma_f32_16x16x32_bf16 v[224:227], a[132:135], v[92:95], v[224:227]
    ds_read_b128 a[120:123], v98 offset:35840
    ds_read_b64_tr_b16 a[128:129], v100 offset:16384
    v_mfma_f32_16x16x32_bf16 v[228:231], a[136:139], v[88:91], v[228:231]
    ds_read_b128 a[116:119], v97 offset:35840
    v_mfma_f32_16x16x32_bf16 v[228:231], a[140:143], v[92:95], v[228:231]
    ds_read_b128 a[112:115], v96 offset:35840
    ds_read_b64_tr_b16 a[130:131], v100 offset:17408
    v_mfma_f32_16x16x32_bf16 v[232:235], a[144:147], v[88:91], v[232:235]
    ds_read_b64_tr_b16 a[132:133], v100 offset:18432
    v_mfma_f32_16x16x32_bf16 v[232:235], a[148:151], v[92:95], v[232:235]
    ds_read_b64_tr_b16 a[134:135], v100 offset:19456
    ds_read_b64_tr_b16 a[136:137], v101 offset:16384
    v_mfma_f32_16x16x32_bf16 v[236:239], a[152:155], v[88:91], v[236:239]
    ds_read_b64_tr_b16 a[138:139], v101 offset:17408
    v_mfma_f32_16x16x32_bf16 v[236:239], a[156:159], v[92:95], v[236:239]
    ds_read_b64_tr_b16 a[140:141], v101 offset:18432
    ds_read_b64_tr_b16 a[142:143], v101 offset:19456
    v_mfma_f32_16x16x32_bf16 v[240:243], a[160:163], v[88:91], v[240:243]
    ds_read_b64_tr_b16 a[144:145], v102 offset:16384
    v_mfma_f32_16x16x32_bf16 v[240:243], a[164:167], v[92:95], v[240:243]
    ds_read_b64_tr_b16 a[146:147], v102 offset:17408
    ds_read_b64_tr_b16 a[148:149], v102 offset:18432
    v_mfma_f32_16x16x32_bf16 v[244:247], a[168:171], v[88:91], v[244:247]
    ds_read_b64_tr_b16 a[150:151], v102 offset:19456
    v_mfma_f32_16x16x32_bf16 v[244:247], a[172:175], v[92:95], v[244:247]
    ds_read_b64_tr_b16 a[152:153], v103 offset:16384
    ds_read_b64_tr_b16 a[154:155], v103 offset:17408
    v_mfma_f32_16x16x32_bf16 v[248:251], a[176:179], v[88:91], v[248:251]
    ds_read_b64_tr_b16 a[156:157], v103 offset:18432
    v_mfma_f32_16x16x32_bf16 v[248:251], a[180:183], v[92:95], v[248:251]
    v_exp_f32 v19, v19
    v_mfma_f32_16x16x32_bf16 v[252:255], a[184:187], v[88:91], v[252:255]
    ds_read_b64_tr_b16 a[158:159], v103 offset:19456
    v_cvt_pk_bf16_f32 v73, v18, v19
    v_mfma_f32_16x16x32_bf16 v[252:255], a[188:191], v[92:95], v[252:255]
    ds_read_b64_tr_b16 a[160:161], v104 offset:16384
    ds_read_b64_tr_b16 a[162:163], v104 offset:17408
    v_smfmac_f32_16x16x64_bf16 a[204:207], a[208:211], v[88:95], v114
    s_waitcnt lgkmcnt(9)
    ds_read_b64_tr_b16 a[164:165], v104 offset:18432
    v_mfma_f32_16x16x32_bf16 v[32:35], a[64:67], a[0:3], 0
    v_exp_f32 v20, v20
    v_mfma_f32_16x16x32_bf16 v[32:35], a[68:71], a[4:7], v[32:35]
    ds_read_b64_tr_b16 a[166:167], v104 offset:19456
    ds_read_b64_tr_b16 a[168:169], v105 offset:16384
    v_mfma_f32_16x16x32_bf16 v[32:35], a[72:75], a[8:11], v[32:35]
    ds_read_b64_tr_b16 a[170:171], v105 offset:17408
    v_mfma_f32_16x16x32_bf16 v[32:35], a[76:79], a[12:15], v[32:35]
    ds_read_b64_tr_b16 a[172:173], v105 offset:18432
    ds_read_b64_tr_b16 a[174:175], v105 offset:19456
    v_mfma_f32_16x16x32_bf16 v[36:39], a[92:95], a[12:15], 0
    v_exp_f32 v21, v21
    v_mfma_f32_16x16x32_bf16 v[36:39], a[88:91], a[8:11], v[36:39]
    ds_read_b64_tr_b16 a[176:177], v106 offset:16384
    v_cvt_pk_bf16_f32 v74, v20, v21
    v_mfma_f32_16x16x32_bf16 v[36:39], a[84:87], a[4:7], v[36:39]
    ds_read_b64_tr_b16 a[178:179], v106 offset:17408
    ds_read_b64_tr_b16 a[180:181], v106 offset:18432
    v_mfma_f32_16x16x32_bf16 v[36:39], a[80:83], a[0:3], v[36:39]
    v_exp_f32 v22, v22
    v_mfma_f32_16x16x32_bf16 v[40:43], a[96:99], a[0:3], 0
    ds_read_b64_tr_b16 a[182:183], v106 offset:19456
    ds_read_b64_tr_b16 a[184:185], v107 offset:16384
    v_mfma_f32_16x16x32_bf16 v[40:43], a[100:103], a[4:7], v[40:43]
    ds_read_b64_tr_b16 a[186:187], v107 offset:17408
    v_mfma_f32_16x16x32_bf16 v[40:43], a[104:107], a[8:11], v[40:43]
    ds_read_b64_tr_b16 a[188:189], v107 offset:18432
    ds_read_b64_tr_b16 a[190:191], v107 offset:19456
    v_mfma_f32_16x16x32_bf16 v[40:43], a[108:111], a[12:15], v[40:43]
    v_exp_f32 v23, v23
    v_mfma_f32_16x16x32_bf16 v[44:47], a[124:127], a[12:15], 0
    v_exp_f32 v24, v24
    v_mfma_f32_16x16x32_bf16 v[44:47], a[120:123], a[8:11], v[44:47]
    v_exp_f32 v25, v25
    v_mfma_f32_16x16x32_bf16 v[44:47], a[116:119], a[4:7], v[44:47]
    v_exp_f32 v26, v26
    v_mfma_f32_16x16x32_bf16 v[44:47], a[112:115], a[0:3], v[44:47]
    v_exp_f32 v27, v27
    v_mfma_f32_16x16x32_bf16 v[48:51], a[64:67], a[16:19], 0
    v_exp_f32 v32, v32
    v_mfma_f32_16x16x32_bf16 v[48:51], a[68:71], a[20:23], v[48:51]
    v_exp_f32 v28, v28
    v_mfma_f32_16x16x32_bf16 v[48:51], a[72:75], a[24:27], v[48:51]
    v_exp_f32 v33, v33
    v_mfma_f32_16x16x32_bf16 v[48:51], a[76:79], a[28:31], v[48:51]
    v_exp_f32 v29, v29
    v_mfma_f32_16x16x32_bf16 v[52:55], a[92:95], a[28:31], 0
    v_cvt_pk_bf16_f32 v75, v22, v23
    v_cvt_pk_bf16_f32 v76, v24, v25
    v_mfma_f32_16x16x32_bf16 v[52:55], a[88:91], a[24:27], v[52:55]
    v_exp_f32 v34, v34
    v_mfma_f32_16x16x32_bf16 v[52:55], a[84:87], a[20:23], v[52:55]
    v_exp_f32 v30, v30
    v_mfma_f32_16x16x32_bf16 v[52:55], a[80:83], a[16:19], v[52:55]
    v_cvt_pk_bf16_f32 v77, v26, v27
    v_cvt_pk_bf16_f32 v78, v28, v29
    v_mfma_f32_16x16x32_bf16 v[56:59], a[96:99], a[16:19], 0
    v_exp_f32 v35, v35
    v_mfma_f32_16x16x32_bf16 v[56:59], a[100:103], a[20:23], v[56:59]
    s_waitcnt vmcnt(0)
    v_exp_f32 v31, v31
    v_mfma_f32_16x16x32_bf16 v[56:59], a[104:107], a[24:27], v[56:59]
    s_barrier
    v_mfma_f32_16x16x32_bf16 v[56:59], a[108:111], a[28:31], v[56:59]
    ds_read_b128 a[64:67], v96 offset:49152
    v_cvt_pk_bf16_f32 v79, v30, v31
    v_mfma_f32_16x16x32_bf16 v[60:63], a[124:127], a[28:31], 0
    ds_read_b128 a[68:71], v97 offset:49152
    v_cvt_pk_bf16_f32 v80, v32, v33
    v_mfma_f32_16x16x32_bf16 v[60:63], a[120:123], a[24:27], v[60:63]
    ds_read_b128 a[72:75], v98 offset:49152
    v_cvt_pk_bf16_f32 v81, v34, v35
    v_mfma_f32_16x16x32_bf16 v[60:63], a[116:119], a[20:23], v[60:63]
    ds_read_b128 a[76:79], v99 offset:49152
    ds_read_b64_tr_b16 a[212:213], v100 offset:49152
    v_mfma_f32_16x16x32_bf16 v[60:63], a[112:115], a[16:19], v[60:63]
    ds_read_b128 a[92:95], v99 offset:50176
    v_mfma_f32_16x16x32_bf16 v[128:131], a[128:131], v[64:67], v[128:131]
    ds_read_b128 a[88:91], v98 offset:50176
    ds_read_b64_tr_b16 a[214:215], v100 offset:50176
    v_mfma_f32_16x16x32_bf16 v[128:131], a[132:135], v[68:71], v[128:131]
    ds_read_b128 a[84:87], v97 offset:50176
    v_mfma_f32_16x16x32_bf16 v[132:135], a[136:139], v[64:67], v[132:135]
    ds_read_b128 a[80:83], v96 offset:50176
    ds_read_b64_tr_b16 a[216:217], v101 offset:49152
    v_mfma_f32_16x16x32_bf16 v[132:135], a[140:143], v[68:71], v[132:135]
    s_waitcnt lgkmcnt(10)
    v_exp_f32 v36, v36
    v_mfma_f32_16x16x32_bf16 v[136:139], a[144:147], v[64:67], v[136:139]
    v_exp_f32 v37, v37
    v_mfma_f32_16x16x32_bf16 v[136:139], a[148:151], v[68:71], v[136:139]
    v_exp_f32 v38, v38
    v_mfma_f32_16x16x32_bf16 v[140:143], a[152:155], v[64:67], v[140:143]
    v_exp_f32 v39, v39
    v_mfma_f32_16x16x32_bf16 v[140:143], a[156:159], v[68:71], v[140:143]
    v_exp_f32 v40, v40
    v_mfma_f32_16x16x32_bf16 v[144:147], a[160:163], v[64:67], v[144:147]
    v_exp_f32 v41, v41
    v_mfma_f32_16x16x32_bf16 v[144:147], a[164:167], v[68:71], v[144:147]
    v_exp_f32 v42, v42
    v_mfma_f32_16x16x32_bf16 v[148:151], a[168:171], v[64:67], v[148:151]
    v_exp_f32 v43, v43
    v_mfma_f32_16x16x32_bf16 v[148:151], a[172:175], v[68:71], v[148:151]
    v_exp_f32 v44, v44
    v_mfma_f32_16x16x32_bf16 v[152:155], a[176:179], v[64:67], v[152:155]
    v_exp_f32 v45, v45
    v_mfma_f32_16x16x32_bf16 v[152:155], a[180:183], v[68:71], v[152:155]
    v_cvt_pk_bf16_f32 v82, v36, v37
    v_cvt_pk_bf16_f32 v83, v38, v39
    v_mfma_f32_16x16x32_bf16 v[156:159], a[184:187], v[64:67], v[156:159]
    v_exp_f32 v46, v46
    v_mfma_f32_16x16x32_bf16 v[156:159], a[188:191], v[68:71], v[156:159]
    v_cvt_pk_bf16_f32 v84, v40, v41
    v_cvt_pk_bf16_f32 v85, v42, v43
    v_smfmac_f32_16x16x64_bf16 a[192:195], a[208:211], v[64:71], v114
    v_exp_f32 v47, v47
    v_mfma_f32_16x16x32_bf16 v[0:3], a[64:67], a[0:3], 0
    s_waitcnt lgkmcnt(0)
    v_cvt_pk_bf16_f32 v86, v44, v45
    v_cvt_pk_bf16_f32 v87, v46, v47
    v_mfma_f32_16x16x32_bf16 v[0:3], a[68:71], a[4:7], v[0:3]
    v_mov_b32 v68, 0
    v_mov_b32 v69, 0
    v_mfma_f32_16x16x32_bf16 v[0:3], a[72:75], a[8:11], v[0:3]
    v_mov_b32 v70, 0
    v_mov_b32 v71, 0
    v_mfma_f32_16x16x32_bf16 v[0:3], a[76:79], a[12:15], v[0:3]
    ds_read_b64_tr_b16 a[218:219], v101 offset:50176
    ds_read_b64_tr_b16 a[220:221], v102 offset:49152
    v_mfma_f32_16x16x32_bf16 v[4:7], a[92:95], a[12:15], v[116:119]
    ds_read_b64_tr_b16 a[222:223], v102 offset:50176
    v_mfma_f32_16x16x32_bf16 v[4:7], a[88:91], a[8:11], v[4:7]
    ds_read_b64_tr_b16 a[224:225], v103 offset:49152
    ds_read_b64_tr_b16 a[226:227], v103 offset:50176
    v_mfma_f32_16x16x32_bf16 v[4:7], a[84:87], a[4:7], v[4:7]
    ds_read_b64_tr_b16 a[228:229], v104 offset:49152
    v_mfma_f32_16x16x32_bf16 v[4:7], a[80:83], a[0:3], v[4:7]
    v_exp_f32 v48, v48
    v_mfma_f32_16x16x32_bf16 v[16:19], a[64:67], a[16:19], 0
    v_exp_f32 v0, v0
    v_mfma_f32_16x16x32_bf16 v[16:19], a[68:71], a[20:23], v[16:19]
    v_exp_f32 v1, v1
    v_mfma_f32_16x16x32_bf16 v[16:19], a[72:75], a[24:27], v[16:19]
    v_exp_f32 v2, v2
    v_mfma_f32_16x16x32_bf16 v[16:19], a[76:79], a[28:31], v[16:19]
    v_exp_f32 v3, v3
    v_mfma_f32_16x16x32_bf16 v[20:23], a[92:95], a[28:31], v[116:119]
    v_exp_f32 v4, v4
    v_mfma_f32_16x16x32_bf16 v[20:23], a[88:91], a[24:27], v[20:23]
    v_exp_f32 v5, v5
    v_mfma_f32_16x16x32_bf16 v[20:23], a[84:87], a[20:23], v[20:23]
    v_exp_f32 v6, v6
    v_mfma_f32_16x16x32_bf16 v[20:23], a[80:83], a[16:19], v[20:23]
    v_cvt_pk_bf16_f32 v64, v0, v1
    v_cvt_pk_bf16_f32 v65, v2, v3
    v_mfma_f32_16x16x32_bf16 v[160:163], a[128:131], v[72:75], v[160:163]
    v_exp_f32 v7, v7
    v_mfma_f32_16x16x32_bf16 v[160:163], a[132:135], v[76:79], v[160:163]
    ds_read_b64_tr_b16 a[128:129], v100 offset:32768
    v_cvt_pk_bf16_f32 v66, v4, v5
    v_mfma_f32_16x16x32_bf16 v[164:167], a[136:139], v[72:75], v[164:167]
    ds_read_b64_tr_b16 a[130:131], v100 offset:33792
    v_cvt_pk_bf16_f32 v67, v6, v7
    v_mfma_f32_16x16x32_bf16 v[164:167], a[140:143], v[76:79], v[164:167]
    ds_read_b64_tr_b16 a[132:133], v100 offset:34816
    ds_read_b64_tr_b16 a[134:135], v100 offset:35840
    v_mfma_f32_16x16x32_bf16 v[168:171], a[144:147], v[72:75], v[168:171]
    ds_read_b64_tr_b16 a[136:137], v101 offset:32768
    v_mfma_f32_16x16x32_bf16 v[168:171], a[148:151], v[76:79], v[168:171]
    ds_read_b64_tr_b16 a[138:139], v101 offset:33792
    ds_read_b64_tr_b16 a[140:141], v101 offset:34816
    v_mfma_f32_16x16x32_bf16 v[172:175], a[152:155], v[72:75], v[172:175]
    ds_read_b64_tr_b16 a[142:143], v101 offset:35840
    v_mfma_f32_16x16x32_bf16 v[172:175], a[156:159], v[76:79], v[172:175]
    ds_read_b64_tr_b16 a[144:145], v102 offset:32768
    ds_read_b64_tr_b16 a[146:147], v102 offset:33792
    v_mfma_f32_16x16x32_bf16 v[176:179], a[160:163], v[72:75], v[176:179]
    ds_read_b64_tr_b16 a[148:149], v102 offset:34816
    v_mfma_f32_16x16x32_bf16 v[176:179], a[164:167], v[76:79], v[176:179]
    ds_read_b64_tr_b16 a[150:151], v102 offset:35840
    ds_read_b64_tr_b16 a[152:153], v103 offset:32768
    v_mfma_f32_16x16x32_bf16 v[180:183], a[168:171], v[72:75], v[180:183]
    ds_read_b64_tr_b16 a[154:155], v103 offset:33792
    v_mfma_f32_16x16x32_bf16 v[180:183], a[172:175], v[76:79], v[180:183]
    ds_read_b64_tr_b16 a[156:157], v103 offset:34816
    ds_read_b64_tr_b16 a[158:159], v103 offset:35840
    v_mfma_f32_16x16x32_bf16 v[184:187], a[176:179], v[72:75], v[184:187]
    ds_read_b64_tr_b16 a[160:161], v104 offset:32768
    v_mfma_f32_16x16x32_bf16 v[184:187], a[180:183], v[76:79], v[184:187]
    ds_read_b64_tr_b16 a[162:163], v104 offset:33792
    ds_read_b64_tr_b16 a[164:165], v104 offset:34816
    v_mfma_f32_16x16x32_bf16 v[188:191], a[184:187], v[72:75], v[188:191]
    ds_read_b64_tr_b16 a[166:167], v104 offset:35840
    v_mfma_f32_16x16x32_bf16 v[188:191], a[188:191], v[76:79], v[188:191]
    ds_read_b64_tr_b16 a[168:169], v105 offset:32768
    ds_read_b64_tr_b16 a[230:231], v104 offset:50176
    v_smfmac_f32_16x16x64_bf16 a[196:199], a[208:211], v[72:79], v114
    ds_read_b64_tr_b16 a[170:171], v105 offset:33792
    v_smfmac_f32_16x16x64_bf16 a[192:195], a[208:211], v[80:87], v114
    ds_read_b64_tr_b16 a[172:173], v105 offset:34816
    v_mov_b32 v76, 0
    v_smfmac_f32_16x16x64_bf16 a[192:195], a[208:211], v[64:71], v114
    s_waitcnt lgkmcnt(10)
    v_exp_f32 v49, v49
    v_mfma_f32_16x16x32_bf16 v[128:131], a[128:131], v[80:83], v[128:131]
    ds_read_b64_tr_b16 a[174:175], v105 offset:35840
    ds_read_b64_tr_b16 a[232:233], v105 offset:49152
    v_mfma_f32_16x16x32_bf16 v[128:131], a[132:135], v[84:87], v[128:131]
    ds_read_b64_tr_b16 a[176:177], v106 offset:32768
    v_cvt_pk_bf16_f32 v88, v48, v49
    v_mfma_f32_16x16x32_bf16 v[128:131], a[212:215], v[64:67], v[128:131]
    ds_read_b64_tr_b16 a[234:235], v105 offset:50176
    ds_read_b64_tr_b16 a[178:179], v106 offset:33792
    v_mfma_f32_16x16x32_bf16 v[132:135], a[136:139], v[80:83], v[132:135]
    v_exp_f32 v50, v50
    v_mfma_f32_16x16x32_bf16 v[132:135], a[140:143], v[84:87], v[132:135]
    ds_read_b64_tr_b16 a[180:181], v106 offset:34816
    ds_read_b64_tr_b16 a[182:183], v106 offset:35840
    v_mfma_f32_16x16x32_bf16 v[132:135], a[216:219], v[64:67], v[132:135]
    ds_read_b64_tr_b16 a[236:237], v106 offset:49152
    v_accvgpr_read_b32 v120, a192
    v_mfma_f32_16x16x32_bf16 v[136:139], a[144:147], v[80:83], v[136:139]
    v_exp_f32 v51, v51
    v_mfma_f32_16x16x32_bf16 v[136:139], a[148:151], v[84:87], v[136:139]
    ds_read_b64_tr_b16 a[184:185], v107 offset:32768
    ds_read_b64_tr_b16 a[238:239], v106 offset:50176
    v_mfma_f32_16x16x32_bf16 v[136:139], a[220:223], v[64:67], v[136:139]
    ds_read_b64_tr_b16 a[186:187], v107 offset:33792
    v_accvgpr_read_b32 v121, a193
    v_mfma_f32_16x16x32_bf16 v[140:143], a[152:155], v[80:83], v[140:143]
    s_waitcnt lgkmcnt(8)
    ds_read_b64_tr_b16 a[188:189], v107 offset:34816
    ds_read_b64_tr_b16 a[190:191], v107 offset:35840
    v_mfma_f32_16x16x32_bf16 v[140:143], a[156:159], v[84:87], v[140:143]
    v_exp_f32 v52, v52
    v_mfma_f32_16x16x32_bf16 v[140:143], a[224:227], v[64:67], v[140:143]
    ds_read_b64_tr_b16 a[240:241], v107 offset:49152
    ds_read_b64_tr_b16 a[242:243], v107 offset:50176
    v_mfma_f32_16x16x32_bf16 v[144:147], a[160:163], v[80:83], v[144:147]
    v_exp_f32 v53, v53
    v_mfma_f32_16x16x32_bf16 v[144:147], a[164:167], v[84:87], v[144:147]
    ds_read_b128 a[64:67], v96 offset:16384
    v_add_f32 v120, v120, v121
    v_mfma_f32_16x16x32_bf16 v[144:147], a[228:231], v[64:67], v[144:147]
    ds_read_b128 a[68:71], v97 offset:16384
    v_cvt_pk_bf16_f32 v89, v50, v51
    v_mfma_f32_16x16x32_bf16 v[148:151], a[168:171], v[80:83], v[148:151]
    v_rcp_f32 v121, v120
    v_mfma_f32_16x16x32_bf16 v[148:151], a[172:175], v[84:87], v[148:151]
    s_waitcnt lgkmcnt(6)
    v_exp_f32 v54, v54
    v_mfma_f32_16x16x32_bf16 v[148:151], a[232:235], v[64:67], v[148:151]
    ds_read_b128 a[72:75], v98 offset:16384
    v_subrev_u32 v120, 0x2b800000, v120
    v_mfma_f32_16x16x32_bf16 v[152:155], a[176:179], v[80:83], v[152:155]
    ds_read_b128 a[76:79], v99 offset:16384
    v_mov_b32 v124, v120
    v_mfma_f32_16x16x32_bf16 v[152:155], a[180:183], v[84:87], v[152:155]
    v_exp_f32 v55, v55
    v_mfma_f32_16x16x32_bf16 v[152:155], a[236:239], v[64:67], v[152:155]
    ds_read_b128 a[92:95], v99 offset:17408
    v_mul_f32 v128, v121, v128
    v_mfma_f32_16x16x32_bf16 v[156:159], a[184:187], v[80:83], v[156:159]
    s_waitcnt lgkmcnt(4)
    ds_read_b128 a[88:91], v98 offset:17408
    v_mul_f32 v129, v121, v129
    v_mfma_f32_16x16x32_bf16 v[156:159], a[188:191], v[84:87], v[156:159]
    ds_read_b128 a[84:87], v97 offset:17408
    v_exp_f32 v56, v56
    v_mfma_f32_16x16x32_bf16 v[156:159], a[240:243], v[64:67], v[156:159]
    ds_read_b128 a[80:83], v96 offset:17408
    v_exp_f32 v16, v16
    v_mfma_f32_16x16x32_bf16 v[32:35], a[64:67], a[32:35], 0
    s_waitcnt lgkmcnt(6)
    ds_read_b128 a[96:99], v96 offset:18432
    v_exp_f32 v57, v57
    v_mfma_f32_16x16x32_bf16 v[32:35], a[68:71], a[36:39], v[32:35]
    s_waitcnt lgkmcnt(6)
    ds_read_b128 a[100:103], v97 offset:18432
    v_exp_f32 v17, v17
    v_mfma_f32_16x16x32_bf16 v[32:35], a[72:75], a[40:43], v[32:35]
    s_waitcnt lgkmcnt(6)
    ds_read_b128 a[104:107], v98 offset:18432
    v_exp_f32 v58, v58
    v_mfma_f32_16x16x32_bf16 v[32:35], a[76:79], a[44:47], v[32:35]
    s_waitcnt lgkmcnt(6)
    ds_read_b128 a[108:111], v99 offset:18432
    v_mul_f32 v130, v121, v130
    v_mul_f32 v131, v121, v131
    v_exp_f32 v18, v18
    v_mfma_f32_16x16x32_bf16 v[36:39], a[92:95], a[44:47], 0
    ds_read_b128 a[124:127], v99 offset:19456
    v_mul_f32 v132, v121, v132
    v_mul_f32 v133, v121, v133
    v_exp_f32 v59, v59
    v_pk_mul_f32 v[134:135], v[134:135], v[120:121] op_sel:[0,1] op_sel_hi:[1,1]
    v_cvt_pk_bf16_f32 v128, v128, v129
    v_cvt_pk_bf16_f32 v129, v130, v131
    v_cvt_pk_bf16_f32 v130, v132, v133
    v_cvt_pk_bf16_f32 v131, v134, v135
    ds_write_b64 v125, v[128:129] offset:0
    ds_write_b64 v125, v[130:131] offset:32
    v_pk_mul_f32 v[136:137], v[136:137], v[120:121] op_sel:[0,1] op_sel_hi:[1,1]
    v_pk_mul_f32 v[138:139], v[138:139], v[120:121] op_sel:[0,1] op_sel_hi:[1,1]
    v_pk_mul_f32 v[140:141], v[140:141], v[120:121] op_sel:[0,1] op_sel_hi:[1,1]
    v_pk_mul_f32 v[142:143], v[142:143], v[120:121] op_sel:[0,1] op_sel_hi:[1,1]
    v_cvt_pk_bf16_f32 v136, v136, v137
    v_cvt_pk_bf16_f32 v137, v138, v139
    v_cvt_pk_bf16_f32 v138, v140, v141
    v_cvt_pk_bf16_f32 v139, v142, v143
    ds_write_b64 v125, v[136:137] offset:64
    ds_write_b64 v125, v[138:139] offset:96
    ds_read_b128 v[132:135], v126 offset:0
    ds_read_b128 v[140:143], v126 offset:3200
    v_pk_mul_f32 v[144:145], v[144:145], v[120:121] op_sel:[0,1] op_sel_hi:[1,1]
    v_pk_mul_f32 v[146:147], v[146:147], v[120:121] op_sel:[0,1] op_sel_hi:[1,1]
    v_pk_mul_f32 v[148:149], v[148:149], v[120:121] op_sel:[0,1] op_sel_hi:[1,1]
    v_pk_mul_f32 v[150:151], v[150:151], v[120:121] op_sel:[0,1] op_sel_hi:[1,1]
    v_cvt_pk_bf16_f32 v144, v144, v145
    v_cvt_pk_bf16_f32 v145, v146, v147
    v_cvt_pk_bf16_f32 v146, v148, v149
    v_cvt_pk_bf16_f32 v147, v150, v151
    s_waitcnt lgkmcnt(1)
    buffer_store_dwordx4 v[132:135], v127, s[16:19], s77 offen offset:0 sc1
    ds_write_b64 v125, v[144:145] offset:128
    ds_write_b64 v125, v[146:147] offset:160
    v_pk_mul_f32 v[152:153], v[152:153], v[120:121] op_sel:[0,1] op_sel_hi:[1,1]
    v_pk_mul_f32 v[154:155], v[154:155], v[120:121] op_sel:[0,1] op_sel_hi:[1,1]
    v_pk_mul_f32 v[156:157], v[156:157], v[120:121] op_sel:[0,1] op_sel_hi:[1,1]
    v_pk_mul_f32 v[158:159], v[158:159], v[120:121] op_sel:[0,1] op_sel_hi:[1,1]
    s_waitcnt lgkmcnt(2)
    buffer_store_dwordx4 v[140:143], v127, s[16:19], s77 offen offset:2048 sc1
    v_cvt_pk_bf16_f32 v152, v152, v153
    v_cvt_pk_bf16_f32 v153, v154, v155
    v_cvt_pk_bf16_f32 v154, v156, v157
    v_cvt_pk_bf16_f32 v155, v158, v159
    ds_write_b64 v125, v[152:153] offset:192
    ds_write_b64 v125, v[154:155] offset:224
    ds_read_b128 v[148:151], v126 offset:128
    ds_read_b128 v[156:159], v126 offset:3328
    v_mfma_f32_16x16x32_bf16 v[36:39], a[88:91], a[40:43], v[36:39]
    ds_read_b128 a[120:123], v98 offset:19456
    v_exp_f32 v19, v19
    v_mfma_f32_16x16x32_bf16 v[36:39], a[84:87], a[36:39], v[36:39]
    ds_read_b128 a[116:119], v97 offset:19456
    v_exp_f32 v60, v60
    v_mfma_f32_16x16x32_bf16 v[36:39], a[80:83], a[32:35], v[36:39]
    ds_read_b128 a[112:115], v96 offset:19456
    v_exp_f32 v20, v20
    v_mfma_f32_16x16x32_bf16 v[40:43], a[96:99], a[32:35], 0
    v_exp_f32 v61, v61
    v_cvt_pk_bf16_f32 v90, v52, v53
    v_mfma_f32_16x16x32_bf16 v[40:43], a[100:103], a[36:39], v[40:43]
    v_cvt_pk_bf16_f32 v91, v54, v55
    v_cvt_pk_bf16_f32 v92, v56, v57
    v_exp_f32 v21, v21
    v_mfma_f32_16x16x32_bf16 v[40:43], a[104:107], a[40:43], v[40:43]
    v_exp_f32 v62, v62
    v_mfma_f32_16x16x32_bf16 v[40:43], a[108:111], a[44:47], v[40:43]
    v_cvt_pk_bf16_f32 v93, v58, v59
    v_cvt_pk_bf16_f32 v72, v16, v17
    v_exp_f32 v22, v22
    v_mfma_f32_16x16x32_bf16 v[44:47], a[124:127], a[44:47], 0
    s_waitcnt lgkmcnt(2)
    v_exp_f32 v63, v63
    v_cvt_pk_bf16_f32 v94, v60, v61
    v_cvt_pk_bf16_f32 v73, v18, v19
    s_waitcnt lgkmcnt(4)
    buffer_store_dwordx4 v[148:151], v127, s[16:19], s77 offen offset:128 sc1
    s_waitcnt lgkmcnt(3)
    buffer_store_dwordx4 v[156:159], v127, s[16:19], s77 offen offset:2176 sc1
    v_mfma_f32_16x16x32_bf16 v[44:47], a[120:123], a[40:43], v[44:47]
    s_waitcnt lgkmcnt(1)
    v_cvt_pk_bf16_f32 v95, v62, v63
    v_cvt_pk_bf16_f32 v74, v20, v21
    v_exp_f32 v23, v23
    v_mfma_f32_16x16x32_bf16 v[44:47], a[116:119], a[36:39], v[44:47]
    s_waitcnt lgkmcnt(0)
    v_cvt_pk_bf16_f32 v75, v22, v23
    v_mov_b32 v77, 0
    v_mov_b32 v78, 0
    v_mov_b32 v79, 0
    v_mfma_f32_16x16x32_bf16 v[44:47], a[112:115], a[32:35], v[44:47]
    v_exp_f32 v32, v32
    v_smfmac_f32_16x16x64_bf16 a[196:199], a[208:211], v[88:95], v114
    v_exp_f32 v33, v33
    v_smfmac_f32_16x16x64_bf16 a[196:199], a[208:211], v[72:79], v114
    v_exp_f32 v34, v34
    v_mfma_f32_16x16x32_bf16 v[160:163], a[128:131], v[88:91], v[160:163]
    v_exp_f32 v35, v35
    v_mfma_f32_16x16x32_bf16 v[160:163], a[132:135], v[92:95], v[160:163]
    v_exp_f32 v36, v36
    v_mfma_f32_16x16x32_bf16 v[160:163], a[212:215], v[72:75], v[160:163]
    v_exp_f32 v37, v37
    v_mfma_f32_16x16x32_bf16 v[164:167], a[136:139], v[88:91], v[164:167]
    v_exp_f32 v38, v38
    v_mfma_f32_16x16x32_bf16 v[164:167], a[140:143], v[92:95], v[164:167]
    v_accvgpr_read_b32 v122, a196
    v_accvgpr_read_b32 v123, a197
    v_mfma_f32_16x16x32_bf16 v[164:167], a[216:219], v[72:75], v[164:167]
    v_add_f32 v122, v122, v123
    v_cvt_pk_bf16_f32 v80, v32, v33
    v_mfma_f32_16x16x32_bf16 v[168:171], a[144:147], v[88:91], v[168:171]
    v_rcp_f32 v123, v122
    v_mfma_f32_16x16x32_bf16 v[168:171], a[148:151], v[92:95], v[168:171]
    v_subrev_u32 v122, 0x2b800000, v122
    v_max_u32 v124, v124, v122
    v_mfma_f32_16x16x32_bf16 v[168:171], a[220:223], v[72:75], v[168:171]
    v_exp_f32 v39, v39
    v_mfma_f32_16x16x32_bf16 v[172:175], a[152:155], v[88:91], v[172:175]
    v_exp_f32 v40, v40
    v_mfma_f32_16x16x32_bf16 v[172:175], a[156:159], v[92:95], v[172:175]
    v_mul_f32 v160, v123, v160
    v_mul_f32 v161, v123, v161
    v_mfma_f32_16x16x32_bf16 v[172:175], a[224:227], v[72:75], v[172:175]
    v_mul_f32 v162, v123, v162
    v_mul_f32 v163, v123, v163
    v_mfma_f32_16x16x32_bf16 v[176:179], a[160:163], v[88:91], v[176:179]
    v_mul_f32 v164, v123, v164
    v_mul_f32 v165, v123, v165
    v_mfma_f32_16x16x32_bf16 v[176:179], a[164:167], v[92:95], v[176:179]
    v_mul_f32 v166, v123, v166
    v_mul_f32 v167, v123, v167
    v_mfma_f32_16x16x32_bf16 v[176:179], a[228:231], v[72:75], v[176:179]
    v_cvt_pk_bf16_f32 v160, v160, v161
    v_cvt_pk_bf16_f32 v161, v162, v163
    v_mfma_f32_16x16x32_bf16 v[180:183], a[168:171], v[88:91], v[180:183]
    v_cvt_pk_bf16_f32 v162, v164, v165
    v_cvt_pk_bf16_f32 v163, v166, v167
    v_mfma_f32_16x16x32_bf16 v[180:183], a[172:175], v[92:95], v[180:183]
    ds_write_b64 v125, v[160:161] offset:0
    v_cvt_pk_bf16_f32 v81, v34, v35
    v_mfma_f32_16x16x32_bf16 v[180:183], a[232:235], v[72:75], v[180:183]
    ds_write_b64 v125, v[162:163] offset:32
    v_mul_f32 v168, v123, v168
    v_mfma_f32_16x16x32_bf16 v[184:187], a[176:179], v[88:91], v[184:187]
    v_mul_f32 v169, v123, v169
    v_mul_f32 v170, v123, v170
    v_mfma_f32_16x16x32_bf16 v[184:187], a[180:183], v[92:95], v[184:187]
    v_mul_f32 v171, v123, v171
    v_mul_f32 v172, v123, v172
    v_mfma_f32_16x16x32_bf16 v[184:187], a[236:239], v[72:75], v[184:187]
    v_exp_f32 v41, v41
    v_mfma_f32_16x16x32_bf16 v[188:191], a[184:187], v[88:91], v[188:191]
    v_mul_f32 v173, v123, v173
    v_mul_f32 v174, v123, v174
    v_mfma_f32_16x16x32_bf16 v[188:191], a[188:191], v[92:95], v[188:191]
    v_mul_f32 v175, v123, v175
    v_cvt_pk_bf16_f32 v168, v168, v169
    v_mfma_f32_16x16x32_bf16 v[188:191], a[240:243], v[72:75], v[188:191]
    v_exp_f32 v42, v42
    v_mfma_f32_16x16x32_bf16 v[48:51], a[64:67], a[48:51], 0
    v_cvt_pk_bf16_f32 v169, v170, v171
    v_cvt_pk_bf16_f32 v170, v172, v173
    v_mfma_f32_16x16x32_bf16 v[48:51], a[68:71], a[52:55], v[48:51]
    ds_read_b128 a[64:67], v96 offset:32768
    v_cvt_pk_bf16_f32 v171, v174, v175
    v_mfma_f32_16x16x32_bf16 v[48:51], a[72:75], a[56:59], v[48:51]
    ds_read_b128 a[68:71], v97 offset:32768
    v_cvt_pk_bf16_f32 v82, v36, v37
    v_mfma_f32_16x16x32_bf16 v[48:51], a[76:79], a[60:63], v[48:51]
    ds_read_b128 a[72:75], v98 offset:32768
    v_cvt_pk_bf16_f32 v83, v38, v39
    v_mfma_f32_16x16x32_bf16 v[52:55], a[92:95], a[60:63], 0
    ds_read_b128 a[76:79], v99 offset:32768
    v_cvt_pk_bf16_f32 v84, v40, v41
    ds_write_b64 v125, v[168:169] offset:64
    ds_write_b64 v125, v[170:171] offset:96
    ds_read_b128 v[164:167], v126 offset:0
    ds_read_b128 v[172:175], v126 offset:3200
    v_pk_mul_f32 v[176:177], v[176:177], v[122:123] op_sel:[0,1] op_sel_hi:[1,1]
    v_pk_mul_f32 v[178:179], v[178:179], v[122:123] op_sel:[0,1] op_sel_hi:[1,1]
    v_pk_mul_f32 v[180:181], v[180:181], v[122:123] op_sel:[0,1] op_sel_hi:[1,1]
    v_pk_mul_f32 v[182:183], v[182:183], v[122:123] op_sel:[0,1] op_sel_hi:[1,1]
    v_cvt_pk_bf16_f32 v176, v176, v177
    v_cvt_pk_bf16_f32 v177, v178, v179
    v_cvt_pk_bf16_f32 v178, v180, v181
    v_cvt_pk_bf16_f32 v179, v182, v183
    s_waitcnt lgkmcnt(1)
    buffer_store_dwordx4 v[164:167], v127, s[16:19], s72 offen offset:0 sc1
    ds_write_b64 v125, v[176:177] offset:128
    ds_write_b64 v125, v[178:179] offset:160
    v_pk_mul_f32 v[184:185], v[184:185], v[122:123] op_sel:[0,1] op_sel_hi:[1,1]
    v_pk_mul_f32 v[186:187], v[186:187], v[122:123] op_sel:[0,1] op_sel_hi:[1,1]
    v_pk_mul_f32 v[188:189], v[188:189], v[122:123] op_sel:[0,1] op_sel_hi:[1,1]
    v_pk_mul_f32 v[190:191], v[190:191], v[122:123] op_sel:[0,1] op_sel_hi:[1,1]
    s_waitcnt lgkmcnt(2)
    buffer_store_dwordx4 v[172:175], v127, s[16:19], s72 offen offset:2048 sc1
    v_cvt_pk_bf16_f32 v184, v184, v185
    v_cvt_pk_bf16_f32 v185, v186, v187
    v_cvt_pk_bf16_f32 v186, v188, v189
    v_cvt_pk_bf16_f32 v187, v190, v191
    ds_write_b64 v125, v[184:185] offset:192
    ds_write_b64 v125, v[186:187] offset:224
    ds_read_b128 v[180:183], v126 offset:128
    ds_read_b128 v[188:191], v126 offset:3328
    v_mfma_f32_16x16x32_bf16 v[52:55], a[88:91], a[56:59], v[52:55]
    ds_read_b128 a[92:95], v99 offset:33792
    ds_read_b64_tr_b16 a[128:129], v100 offset:16384
    v_mfma_f32_16x16x32_bf16 v[52:55], a[84:87], a[52:55], v[52:55]
    ds_read_b128 a[88:91], v98 offset:33792
    v_mfma_f32_16x16x32_bf16 v[52:55], a[80:83], a[48:51], v[52:55]
    ds_read_b128 a[84:87], v97 offset:33792
    ds_read_b64_tr_b16 a[130:131], v100 offset:17408
    v_mfma_f32_16x16x32_bf16 v[56:59], a[96:99], a[48:51], 0
    ds_read_b128 a[80:83], v96 offset:33792
    v_mfma_f32_16x16x32_bf16 v[56:59], a[100:103], a[52:55], v[56:59]
    ds_read_b128 a[96:99], v96 offset:34816
    ds_read_b64_tr_b16 a[132:133], v100 offset:18432
    v_mfma_f32_16x16x32_bf16 v[56:59], a[104:107], a[56:59], v[56:59]
    ds_read_b128 a[100:103], v97 offset:34816
    v_mfma_f32_16x16x32_bf16 v[56:59], a[108:111], a[60:63], v[56:59]
    ds_read_b128 a[104:107], v98 offset:34816
    ds_read_b64_tr_b16 a[134:135], v100 offset:19456
    v_mfma_f32_16x16x32_bf16 v[60:63], a[124:127], a[60:63], 0
    ds_read_b128 a[108:111], v99 offset:34816
    s_waitcnt lgkmcnt(13)
    buffer_store_dwordx4 v[180:183], v127, s[16:19], s72 offen offset:128 sc1
    s_waitcnt lgkmcnt(12)
    buffer_store_dwordx4 v[188:191], v127, s[16:19], s72 offen offset:2176 sc1
    v_mfma_f32_16x16x32_bf16 v[60:63], a[120:123], a[56:59], v[60:63]
    v_exp_f32 v43, v43
    v_mfma_f32_16x16x32_bf16 v[60:63], a[116:119], a[52:55], v[60:63]
    ds_read_b128 a[124:127], v99 offset:35840
    v_cvt_pk_bf16_f32 v85, v42, v43
    v_mfma_f32_16x16x32_bf16 v[60:63], a[112:115], a[48:51], v[60:63]
    ds_read_b128 a[120:123], v98 offset:35840
    ds_read_b64_tr_b16 a[136:137], v101 offset:16384
    v_mfma_f32_16x16x32_bf16 v[0:3], a[64:67], a[32:35], 0
    v_exp_f32 v44, v44
    v_mfma_f32_16x16x32_bf16 v[0:3], a[68:71], a[36:39], v[0:3]
    ds_read_b128 a[116:119], v97 offset:35840
    ds_read_b64_tr_b16 a[138:139], v101 offset:17408
    v_mfma_f32_16x16x32_bf16 v[0:3], a[72:75], a[40:43], v[0:3]
    ds_read_b128 a[112:115], v96 offset:35840
    v_mfma_f32_16x16x32_bf16 v[0:3], a[76:79], a[44:47], v[0:3]
    s_waitcnt lgkmcnt(7)
    v_exp_f32 v45, v45
    v_mfma_f32_16x16x32_bf16 v[4:7], a[92:95], a[44:47], 0
    v_exp_f32 v48, v48
    v_mfma_f32_16x16x32_bf16 v[4:7], a[88:91], a[40:43], v[4:7]
    v_exp_f32 v46, v46
    v_mfma_f32_16x16x32_bf16 v[4:7], a[84:87], a[36:39], v[4:7]
    ds_read_b64_tr_b16 a[140:141], v101 offset:18432
    ds_read_b64_tr_b16 a[142:143], v101 offset:19456
    v_mfma_f32_16x16x32_bf16 v[4:7], a[80:83], a[32:35], v[4:7]
    v_exp_f32 v49, v49
    v_mfma_f32_16x16x32_bf16 v[8:11], a[96:99], a[32:35], 0
    ds_read_b64_tr_b16 a[144:145], v102 offset:16384
    v_cvt_pk_bf16_f32 v86, v44, v45
    v_mfma_f32_16x16x32_bf16 v[8:11], a[100:103], a[36:39], v[8:11]
    v_exp_f32 v47, v47
    v_mfma_f32_16x16x32_bf16 v[8:11], a[104:107], a[40:43], v[8:11]
    s_waitcnt lgkmcnt(3)
    ds_read_b64_tr_b16 a[146:147], v102 offset:17408
    ds_read_b64_tr_b16 a[148:149], v102 offset:18432
    v_mfma_f32_16x16x32_bf16 v[8:11], a[108:111], a[44:47], v[8:11]
    ds_read_b64_tr_b16 a[150:151], v102 offset:19456
    v_cvt_pk_bf16_f32 v87, v46, v47
    v_mfma_f32_16x16x32_bf16 v[12:15], a[124:127], a[44:47], 0
    v_exp_f32 v50, v50
    v_mfma_f32_16x16x32_bf16 v[12:15], a[120:123], a[40:43], v[12:15]
    ds_read_b64_tr_b16 a[152:153], v103 offset:16384
    ds_read_b64_tr_b16 a[154:155], v103 offset:17408
    v_mfma_f32_16x16x32_bf16 v[12:15], a[116:119], a[36:39], v[12:15]
    ds_read_b64_tr_b16 a[156:157], v103 offset:18432
    ds_read_b64_tr_b16 a[158:159], v103 offset:19456
    v_mfma_f32_16x16x32_bf16 v[12:15], a[112:115], a[32:35], v[12:15]
    ds_read_b64_tr_b16 a[160:161], v104 offset:16384
    v_exp_f32 v51, v51
    v_mfma_f32_16x16x32_bf16 v[192:195], a[128:131], v[80:83], v[192:195]
    ds_read_b64_tr_b16 a[162:163], v104 offset:17408
    ds_read_b64_tr_b16 a[164:165], v104 offset:18432
    v_mfma_f32_16x16x32_bf16 v[192:195], a[132:135], v[84:87], v[192:195]
    ds_read_b64_tr_b16 a[166:167], v104 offset:19456
    ds_read_b64_tr_b16 a[168:169], v105 offset:16384
    v_exp_f32 v52, v52
    v_mfma_f32_16x16x32_bf16 v[196:199], a[136:139], v[80:83], v[196:199]
    s_waitcnt lgkmcnt(10)
    ds_read_b64_tr_b16 a[170:171], v105 offset:17408
    ds_read_b64_tr_b16 a[172:173], v105 offset:18432
    v_mfma_f32_16x16x32_bf16 v[196:199], a[140:143], v[84:87], v[196:199]
    ds_read_b64_tr_b16 a[174:175], v105 offset:19456
    ds_read_b64_tr_b16 a[176:177], v106 offset:16384
    v_exp_f32 v53, v53
    v_mfma_f32_16x16x32_bf16 v[200:203], a[144:147], v[80:83], v[200:203]
    s_waitcnt lgkmcnt(13)
    ds_read_b64_tr_b16 a[178:179], v106 offset:17408
    ds_read_b64_tr_b16 a[180:181], v106 offset:18432
    v_mfma_f32_16x16x32_bf16 v[200:203], a[148:151], v[84:87], v[200:203]
    s_waitcnt lgkmcnt(13)
    ds_read_b64_tr_b16 a[182:183], v106 offset:19456
    ds_read_b64_tr_b16 a[184:185], v107 offset:16384
    v_exp_f32 v54, v54
    v_mfma_f32_16x16x32_bf16 v[204:207], a[152:155], v[80:83], v[204:207]
    s_waitcnt lgkmcnt(13)
    ds_read_b64_tr_b16 a[186:187], v107 offset:17408
    ds_read_b64_tr_b16 a[188:189], v107 offset:18432
    v_mfma_f32_16x16x32_bf16 v[204:207], a[156:159], v[84:87], v[204:207]
    s_waitcnt lgkmcnt(13)
    ds_read_b64_tr_b16 a[190:191], v107 offset:19456
    v_exp_f32 v55, v55
    v_mfma_f32_16x16x32_bf16 v[208:211], a[160:163], v[80:83], v[208:211]
    s_waitcnt lgkmcnt(12)
    v_exp_f32 v56, v56
    v_mfma_f32_16x16x32_bf16 v[208:211], a[164:167], v[84:87], v[208:211]
    s_waitcnt lgkmcnt(10)
    ds_read_b128 a[0:3], v96 offset:49152
    v_cvt_pk_bf16_f32 v88, v48, v49
    v_mfma_f32_16x16x32_bf16 v[212:215], a[168:171], v[80:83], v[212:215]
    s_waitcnt lgkmcnt(9)
    ds_read_b128 a[4:7], v97 offset:49152
    v_cvt_pk_bf16_f32 v89, v50, v51
    v_mfma_f32_16x16x32_bf16 v[212:215], a[172:175], v[84:87], v[212:215]
    s_waitcnt lgkmcnt(8)
    ds_read_b128 a[8:11], v98 offset:49152
    v_exp_f32 v57, v57
    v_mfma_f32_16x16x32_bf16 v[216:219], a[176:179], v[80:83], v[216:219]
    s_waitcnt lgkmcnt(7)
    ds_read_b128 a[12:15], v99 offset:49152
    v_cvt_pk_bf16_f32 v90, v52, v53
    v_mfma_f32_16x16x32_bf16 v[216:219], a[180:183], v[84:87], v[216:219]
    s_waitcnt lgkmcnt(6)
    ds_read_b128 a[28:31], v99 offset:50176
    v_exp_f32 v58, v58
    v_mfma_f32_16x16x32_bf16 v[220:223], a[184:187], v[80:83], v[220:223]
    s_waitcnt lgkmcnt(5)
    ds_read_b128 a[24:27], v98 offset:50176
    v_cvt_pk_bf16_f32 v91, v54, v55
    v_mfma_f32_16x16x32_bf16 v[220:223], a[188:191], v[84:87], v[220:223]
    ds_read_b128 a[20:23], v97 offset:50176
    v_exp_f32 v59, v59
    v_smfmac_f32_16x16x64_bf16 a[200:203], a[208:211], v[80:87], v114
    s_waitcnt lgkmcnt(6)
    ds_read_b128 a[16:19], v96 offset:50176
    v_exp_f32 v0, v0
    v_mfma_f32_16x16x32_bf16 v[32:35], a[0:3], a[32:35], 0
    s_waitcnt lgkmcnt(6)
    v_exp_f32 v60, v60
    v_mfma_f32_16x16x32_bf16 v[32:35], a[4:7], a[36:39], v[32:35]
    s_waitcnt lgkmcnt(5)
    v_exp_f32 v1, v1
    v_mfma_f32_16x16x32_bf16 v[32:35], a[8:11], a[40:43], v[32:35]
    s_waitcnt lgkmcnt(4)
    v_exp_f32 v61, v61
    v_mfma_f32_16x16x32_bf16 v[32:35], a[12:15], a[44:47], v[32:35]
    s_waitcnt lgkmcnt(3)
    v_exp_f32 v2, v2
    v_mfma_f32_16x16x32_bf16 v[36:39], a[28:31], a[44:47], v[116:119]
    s_waitcnt lgkmcnt(2)
    v_exp_f32 v62, v62
    v_cvt_pk_bf16_f32 v92, v56, v57
    v_mfma_f32_16x16x32_bf16 v[36:39], a[24:27], a[40:43], v[36:39]
    s_waitcnt lgkmcnt(1)
    v_cvt_pk_bf16_f32 v93, v58, v59
    v_cvt_pk_bf16_f32 v94, v60, v61
    v_exp_f32 v3, v3
    v_mfma_f32_16x16x32_bf16 v[36:39], a[20:23], a[36:39], v[36:39]
    s_waitcnt lgkmcnt(0)
    v_exp_f32 v63, v63
    v_mfma_f32_16x16x32_bf16 v[36:39], a[16:19], a[32:35], v[36:39]
    v_cvt_pk_bf16_f32 v95, v62, v63
    v_cvt_pk_bf16_f32 v64, v0, v1
    v_exp_f32 v4, v4
    v_mfma_f32_16x16x32_bf16 v[48:51], a[0:3], a[48:51], 0
    v_exp_f32 v5, v5
    v_mfma_f32_16x16x32_bf16 v[48:51], a[4:7], a[52:55], v[48:51]
    v_exp_f32 v6, v6
    v_mfma_f32_16x16x32_bf16 v[48:51], a[8:11], a[56:59], v[48:51]
    v_exp_f32 v7, v7
    v_mfma_f32_16x16x32_bf16 v[48:51], a[12:15], a[60:63], v[48:51]
    v_exp_f32 v8, v8
    v_mfma_f32_16x16x32_bf16 v[52:55], a[28:31], a[60:63], v[116:119]
    v_exp_f32 v32, v32
    v_mfma_f32_16x16x32_bf16 v[52:55], a[24:27], a[56:59], v[52:55]
    v_exp_f32 v9, v9
    v_mfma_f32_16x16x32_bf16 v[52:55], a[20:23], a[52:55], v[52:55]
    v_exp_f32 v33, v33
    v_mfma_f32_16x16x32_bf16 v[52:55], a[16:19], a[48:51], v[52:55]
    v_exp_f32 v10, v10
    v_mfma_f32_16x16x32_bf16 v[224:227], a[128:131], v[88:91], v[224:227]
    v_exp_f32 v34, v34
    v_mfma_f32_16x16x32_bf16 v[224:227], a[132:135], v[92:95], v[224:227]
    v_exp_f32 v11, v11
    v_mfma_f32_16x16x32_bf16 v[228:231], a[136:139], v[88:91], v[228:231]
    v_exp_f32 v35, v35
    v_mfma_f32_16x16x32_bf16 v[228:231], a[140:143], v[92:95], v[228:231]
    v_exp_f32 v12, v12
    v_mfma_f32_16x16x32_bf16 v[232:235], a[144:147], v[88:91], v[232:235]
    v_cvt_pk_bf16_f32 v65, v2, v3
    v_cvt_pk_bf16_f32 v66, v4, v5
    v_mfma_f32_16x16x32_bf16 v[232:235], a[148:151], v[92:95], v[232:235]
    v_exp_f32 v36, v36
    v_mfma_f32_16x16x32_bf16 v[236:239], a[152:155], v[88:91], v[236:239]
    v_exp_f32 v13, v13
    v_mfma_f32_16x16x32_bf16 v[236:239], a[156:159], v[92:95], v[236:239]
    ds_read_b64_tr_b16 a[128:129], v100 offset:32768
    v_cvt_pk_bf16_f32 v67, v6, v7
    v_mfma_f32_16x16x32_bf16 v[240:243], a[160:163], v[88:91], v[240:243]
    v_exp_f32 v37, v37
    v_mfma_f32_16x16x32_bf16 v[240:243], a[164:167], v[92:95], v[240:243]
    v_exp_f32 v14, v14
    v_mfma_f32_16x16x32_bf16 v[244:247], a[168:171], v[88:91], v[244:247]
    ds_read_b64_tr_b16 a[130:131], v100 offset:33792
    v_cvt_pk_bf16_f32 v68, v8, v9
    v_mfma_f32_16x16x32_bf16 v[244:247], a[172:175], v[92:95], v[244:247]
    ds_read_b64_tr_b16 a[132:133], v100 offset:34816
    v_cvt_pk_bf16_f32 v69, v10, v11
    v_mfma_f32_16x16x32_bf16 v[248:251], a[176:179], v[88:91], v[248:251]
    ds_read_b64_tr_b16 a[134:135], v100 offset:35840
    v_exp_f32 v38, v38
    v_cvt_pk_bf16_f32 v80, v32, v33
    v_mfma_f32_16x16x32_bf16 v[248:251], a[180:183], v[92:95], v[248:251]
    ds_read_b64_tr_b16 a[136:137], v101 offset:32768
    v_exp_f32 v15, v15
    v_cvt_pk_bf16_f32 v70, v12, v13
    v_cvt_pk_bf16_f32 v81, v34, v35
    v_mfma_f32_16x16x32_bf16 v[252:255], a[184:187], v[88:91], v[252:255]
    ds_read_b64_tr_b16 a[138:139], v101 offset:33792
    ds_read_b64_tr_b16 a[140:141], v101 offset:34816
    v_cvt_pk_bf16_f32 v71, v14, v15
    v_cvt_pk_bf16_f32 v82, v36, v37
    v_exp_f32 v39, v39
    v_mfma_f32_16x16x32_bf16 v[252:255], a[188:191], v[92:95], v[252:255]
    ds_read_b64_tr_b16 a[142:143], v101 offset:35840
    v_cvt_pk_bf16_f32 v83, v38, v39
    v_mov_b32 v84, 0
    v_mov_b32 v85, 0
    v_mov_b32 v86, 0
    v_mov_b32 v87, 0
    v_smfmac_f32_16x16x64_bf16 a[204:207], a[208:211], v[88:95], v114
    ds_read_b64_tr_b16 a[144:145], v102 offset:32768
    ds_read_b64_tr_b16 a[146:147], v102 offset:33792
    v_smfmac_f32_16x16x64_bf16 a[200:203], a[208:211], v[64:71], v114
    ds_read_b64_tr_b16 a[148:149], v102 offset:34816
    ds_read_b64_tr_b16 a[150:151], v102 offset:35840
    v_smfmac_f32_16x16x64_bf16 a[200:203], a[208:211], v[80:87], v114
    s_waitcnt lgkmcnt(10)
    ds_read_b64_tr_b16 a[152:153], v103 offset:32768
    ds_read_b64_tr_b16 a[154:155], v103 offset:33792
    v_mfma_f32_16x16x32_bf16 v[192:195], a[128:131], v[64:67], v[192:195]
    s_waitcnt lgkmcnt(10)
    ds_read_b64_tr_b16 a[156:157], v103 offset:34816
    ds_read_b64_tr_b16 a[158:159], v103 offset:35840
    v_mfma_f32_16x16x32_bf16 v[192:195], a[132:135], v[68:71], v[192:195]
    ds_read_b64_tr_b16 a[160:161], v104 offset:32768
    v_mov_b32 v92, 0
    v_mfma_f32_16x16x32_bf16 v[192:195], a[212:215], v[80:83], v[192:195]
    s_waitcnt lgkmcnt(11)
    ds_read_b64_tr_b16 a[162:163], v104 offset:33792
    ds_read_b64_tr_b16 a[164:165], v104 offset:34816
    v_mfma_f32_16x16x32_bf16 v[196:199], a[136:139], v[64:67], v[196:199]
    s_waitcnt lgkmcnt(11)
    ds_read_b64_tr_b16 a[166:167], v104 offset:35840
    v_mov_b32 v93, 0
    v_mfma_f32_16x16x32_bf16 v[196:199], a[140:143], v[68:71], v[196:199]
    ds_read_b64_tr_b16 a[168:169], v105 offset:32768
    ds_read_b64_tr_b16 a[170:171], v105 offset:33792
    v_mfma_f32_16x16x32_bf16 v[196:199], a[216:219], v[80:83], v[196:199]
    s_waitcnt lgkmcnt(12)
    ds_read_b64_tr_b16 a[172:173], v105 offset:34816
    v_accvgpr_read_b32 v120, a200
    v_mfma_f32_16x16x32_bf16 v[200:203], a[144:147], v[64:67], v[200:203]
    s_waitcnt lgkmcnt(11)
    ds_read_b64_tr_b16 a[174:175], v105 offset:35840
    ds_read_b64_tr_b16 a[176:177], v106 offset:32768
    v_mfma_f32_16x16x32_bf16 v[200:203], a[148:151], v[68:71], v[200:203]
    ds_read_b64_tr_b16 a[178:179], v106 offset:33792
    v_accvgpr_read_b32 v121, a201
    v_mfma_f32_16x16x32_bf16 v[200:203], a[220:223], v[80:83], v[200:203]
    s_waitcnt lgkmcnt(10)
    ds_read_b64_tr_b16 a[180:181], v106 offset:34816
    ds_read_b64_tr_b16 a[182:183], v106 offset:35840
    v_mfma_f32_16x16x32_bf16 v[204:207], a[152:155], v[64:67], v[204:207]
    ds_read_b64_tr_b16 a[184:185], v107 offset:32768
    v_add_f32 v120, v120, v121
    v_mfma_f32_16x16x32_bf16 v[204:207], a[156:159], v[68:71], v[204:207]
    ds_read_b64_tr_b16 a[186:187], v107 offset:33792
    ds_read_b64_tr_b16 a[188:189], v107 offset:34816
    v_mfma_f32_16x16x32_bf16 v[204:207], a[224:227], v[80:83], v[204:207]
    s_waitcnt lgkmcnt(11)
    ds_read_b64_tr_b16 a[190:191], v107 offset:35840
    v_mov_b32 v94, 0
    v_mfma_f32_16x16x32_bf16 v[208:211], a[160:163], v[64:67], v[208:211]
    v_rcp_f32 v121, v120
    v_mfma_f32_16x16x32_bf16 v[208:211], a[164:167], v[68:71], v[208:211]
    v_subrev_u32 v120, 0x2b800000, v120
    v_max_u32 v124, v124, v120
    v_mfma_f32_16x16x32_bf16 v[208:211], a[228:231], v[80:83], v[208:211]
    s_waitcnt lgkmcnt(7)
    v_exp_f32 v48, v48
    v_mfma_f32_16x16x32_bf16 v[212:215], a[168:171], v[64:67], v[212:215]
    v_exp_f32 v49, v49
    v_mfma_f32_16x16x32_bf16 v[212:215], a[172:175], v[68:71], v[212:215]
    v_mul_f32 v192, v121, v192
    v_mul_f32 v193, v121, v193
    v_mfma_f32_16x16x32_bf16 v[212:215], a[232:235], v[80:83], v[212:215]
    s_waitcnt lgkmcnt(3)
    v_exp_f32 v50, v50
    v_mfma_f32_16x16x32_bf16 v[216:219], a[176:179], v[64:67], v[216:219]
    v_mul_f32 v194, v121, v194
    v_mul_f32 v195, v121, v195
    v_mfma_f32_16x16x32_bf16 v[216:219], a[180:183], v[68:71], v[216:219]
    v_mul_f32 v196, v121, v196
    v_mul_f32 v197, v121, v197
    v_mfma_f32_16x16x32_bf16 v[216:219], a[236:239], v[80:83], v[216:219]
    s_waitcnt lgkmcnt(0)
    v_exp_f32 v51, v51
    v_mfma_f32_16x16x32_bf16 v[220:223], a[184:187], v[64:67], v[220:223]
    v_mul_f32 v198, v121, v198
    v_mul_f32 v199, v121, v199
    v_mfma_f32_16x16x32_bf16 v[220:223], a[188:191], v[68:71], v[220:223]
    v_cvt_pk_bf16_f32 v192, v192, v193
    v_cvt_pk_bf16_f32 v193, v194, v195
    v_mfma_f32_16x16x32_bf16 v[220:223], a[240:243], v[80:83], v[220:223]
    v_exp_f32 v52, v52
    v_mfma_f32_16x16x32_bf16 v[16:19], a[64:67], a[48:51], 0
    v_cvt_pk_bf16_f32 v194, v196, v197
    v_cvt_pk_bf16_f32 v195, v198, v199
    v_mfma_f32_16x16x32_bf16 v[16:19], a[68:71], a[52:55], v[16:19]
    ds_write_b64 v125, v[192:193] offset:0
    ds_write_b64 v125, v[194:195] offset:32
    v_mfma_f32_16x16x32_bf16 v[16:19], a[72:75], a[56:59], v[16:19]
    v_exp_f32 v53, v53
    v_mfma_f32_16x16x32_bf16 v[16:19], a[76:79], a[60:63], v[16:19]
    v_exp_f32 v54, v54
    v_mfma_f32_16x16x32_bf16 v[20:23], a[92:95], a[60:63], 0
    v_cvt_pk_bf16_f32 v88, v48, v49
    v_cvt_pk_bf16_f32 v89, v50, v51
    v_pk_mul_f32 v[200:201], v[200:201], v[120:121] op_sel:[0,1] op_sel_hi:[1,1]
    v_pk_mul_f32 v[202:203], v[202:203], v[120:121] op_sel:[0,1] op_sel_hi:[1,1]
    v_pk_mul_f32 v[204:205], v[204:205], v[120:121] op_sel:[0,1] op_sel_hi:[1,1]
    v_pk_mul_f32 v[206:207], v[206:207], v[120:121] op_sel:[0,1] op_sel_hi:[1,1]
    v_cvt_pk_bf16_f32 v200, v200, v201
    v_cvt_pk_bf16_f32 v201, v202, v203
    v_cvt_pk_bf16_f32 v202, v204, v205
    v_cvt_pk_bf16_f32 v203, v206, v207
    ds_write_b64 v125, v[200:201] offset:64
    ds_write_b64 v125, v[202:203] offset:96
    ds_read_b128 v[196:199], v126 offset:0
    ds_read_b128 v[204:207], v126 offset:3200
    v_pk_mul_f32 v[208:209], v[208:209], v[120:121] op_sel:[0,1] op_sel_hi:[1,1]
    v_pk_mul_f32 v[210:211], v[210:211], v[120:121] op_sel:[0,1] op_sel_hi:[1,1]
    v_pk_mul_f32 v[212:213], v[212:213], v[120:121] op_sel:[0,1] op_sel_hi:[1,1]
    v_pk_mul_f32 v[214:215], v[214:215], v[120:121] op_sel:[0,1] op_sel_hi:[1,1]
    v_cvt_pk_bf16_f32 v208, v208, v209
    v_cvt_pk_bf16_f32 v209, v210, v211
    v_cvt_pk_bf16_f32 v210, v212, v213
    v_cvt_pk_bf16_f32 v211, v214, v215
    s_waitcnt lgkmcnt(1)
    buffer_store_dwordx4 v[196:199], v127, s[16:19], s73 offen offset:0 sc1
    ds_write_b64 v125, v[208:209] offset:128
    ds_write_b64 v125, v[210:211] offset:160
    v_pk_mul_f32 v[216:217], v[216:217], v[120:121] op_sel:[0,1] op_sel_hi:[1,1]
    v_pk_mul_f32 v[218:219], v[218:219], v[120:121] op_sel:[0,1] op_sel_hi:[1,1]
    v_pk_mul_f32 v[220:221], v[220:221], v[120:121] op_sel:[0,1] op_sel_hi:[1,1]
    v_pk_mul_f32 v[222:223], v[222:223], v[120:121] op_sel:[0,1] op_sel_hi:[1,1]
    s_waitcnt lgkmcnt(2)
    buffer_store_dwordx4 v[204:207], v127, s[16:19], s73 offen offset:2048 sc1
    v_cvt_pk_bf16_f32 v216, v216, v217
    v_cvt_pk_bf16_f32 v217, v218, v219
    v_cvt_pk_bf16_f32 v218, v220, v221
    v_cvt_pk_bf16_f32 v219, v222, v223
    ds_write_b64 v125, v[216:217] offset:192
    ds_write_b64 v125, v[218:219] offset:224
    ds_read_b128 v[212:215], v126 offset:128
    ds_read_b128 v[220:223], v126 offset:3328
    v_mfma_f32_16x16x32_bf16 v[20:23], a[88:91], a[56:59], v[20:23]
    v_exp_f32 v55, v55
    v_mfma_f32_16x16x32_bf16 v[20:23], a[84:87], a[52:55], v[20:23]
    v_cvt_pk_bf16_f32 v90, v52, v53
    v_cvt_pk_bf16_f32 v91, v54, v55
    v_mfma_f32_16x16x32_bf16 v[20:23], a[80:83], a[48:51], v[20:23]
    v_mov_b32 v95, 0
    v_mfma_f32_16x16x32_bf16 v[24:27], a[96:99], a[48:51], 0
    v_exp_f32 v16, v16
    v_mfma_f32_16x16x32_bf16 v[24:27], a[100:103], a[52:55], v[24:27]
    v_exp_f32 v17, v17
    v_mfma_f32_16x16x32_bf16 v[24:27], a[104:107], a[56:59], v[24:27]
    v_exp_f32 v18, v18
    v_mfma_f32_16x16x32_bf16 v[24:27], a[108:111], a[60:63], v[24:27]
    v_exp_f32 v19, v19
    v_mfma_f32_16x16x32_bf16 v[28:31], a[124:127], a[60:63], 0
    v_exp_f32 v20, v20
    s_waitcnt lgkmcnt(1)
    buffer_store_dwordx4 v[212:215], v127, s[16:19], s73 offen offset:128 sc1
    s_waitcnt lgkmcnt(0)
    buffer_store_dwordx4 v[220:223], v127, s[16:19], s73 offen offset:2176 sc1
    v_mfma_f32_16x16x32_bf16 v[28:31], a[120:123], a[56:59], v[28:31]
    v_exp_f32 v21, v21
    v_mfma_f32_16x16x32_bf16 v[28:31], a[116:119], a[52:55], v[28:31]
    v_exp_f32 v22, v22
    v_mfma_f32_16x16x32_bf16 v[28:31], a[112:115], a[48:51], v[28:31]
    v_exp_f32 v23, v23
    v_cvt_pk_bf16_f32 v72, v16, v17
    v_smfmac_f32_16x16x64_bf16 a[204:207], a[208:211], v[88:95], v114
    v_exp_f32 v24, v24
    v_cvt_pk_bf16_f32 v73, v18, v19
    v_mfma_f32_16x16x32_bf16 v[224:227], a[212:215], v[88:91], v[224:227]
    v_exp_f32 v25, v25
    v_cvt_pk_bf16_f32 v74, v20, v21
    v_mfma_f32_16x16x32_bf16 v[228:231], a[216:219], v[88:91], v[228:231]
    v_exp_f32 v26, v26
    v_cvt_pk_bf16_f32 v75, v22, v23
    v_mfma_f32_16x16x32_bf16 v[232:235], a[220:223], v[88:91], v[232:235]
    v_exp_f32 v27, v27
    v_cvt_pk_bf16_f32 v76, v24, v25
    v_mfma_f32_16x16x32_bf16 v[236:239], a[224:227], v[88:91], v[236:239]
    v_exp_f32 v28, v28
    v_cvt_pk_bf16_f32 v77, v26, v27
    v_mfma_f32_16x16x32_bf16 v[240:243], a[228:231], v[88:91], v[240:243]
    v_exp_f32 v29, v29
    v_exp_f32 v30, v30
    v_exp_f32 v31, v31
    v_mfma_f32_16x16x32_bf16 v[244:247], a[232:235], v[88:91], v[244:247]
    v_cvt_pk_bf16_f32 v78, v28, v29
    v_cvt_pk_bf16_f32 v79, v30, v31
    v_mfma_f32_16x16x32_bf16 v[248:251], a[236:239], v[88:91], v[248:251]
    v_mfma_f32_16x16x32_bf16 v[252:255], a[240:243], v[88:91], v[252:255]
    v_smfmac_f32_16x16x64_bf16 a[204:207], a[208:211], v[72:79], v114
    v_mfma_f32_16x16x32_bf16 v[224:227], a[128:131], v[72:75], v[224:227]
    v_mfma_f32_16x16x32_bf16 v[224:227], a[132:135], v[76:79], v[224:227]
    v_mfma_f32_16x16x32_bf16 v[228:231], a[136:139], v[72:75], v[228:231]
    v_mfma_f32_16x16x32_bf16 v[228:231], a[140:143], v[76:79], v[228:231]
    v_mfma_f32_16x16x32_bf16 v[232:235], a[144:147], v[72:75], v[232:235]
    s_nop 2
    v_accvgpr_read_b32 v122, a204
    v_accvgpr_read_b32 v123, a205
    v_mfma_f32_16x16x32_bf16 v[232:235], a[148:151], v[76:79], v[232:235]
    v_add_f32 v122, v122, v123
    v_mfma_f32_16x16x32_bf16 v[236:239], a[152:155], v[72:75], v[236:239]
    v_rcp_f32 v123, v122
    v_mfma_f32_16x16x32_bf16 v[236:239], a[156:159], v[76:79], v[236:239]
    v_subrev_u32 v122, 0x2b800000, v122
    v_max_u32 v124, v124, v122
    v_mfma_f32_16x16x32_bf16 v[240:243], a[160:163], v[72:75], v[240:243]
    v_mul_f32 v224, v123, v224
    v_mul_f32 v225, v123, v225
    v_mfma_f32_16x16x32_bf16 v[240:243], a[164:167], v[76:79], v[240:243]
    v_mul_f32 v226, v123, v226
    v_mul_f32 v227, v123, v227
    v_mfma_f32_16x16x32_bf16 v[244:247], a[168:171], v[72:75], v[244:247]
    v_mul_f32 v228, v123, v228
    v_mul_f32 v229, v123, v229
    v_mfma_f32_16x16x32_bf16 v[244:247], a[172:175], v[76:79], v[244:247]
    v_mul_f32 v230, v123, v230
    v_mul_f32 v231, v123, v231
    v_mfma_f32_16x16x32_bf16 v[248:251], a[176:179], v[72:75], v[248:251]
    v_cvt_pk_bf16_f32 v224, v224, v225
    v_cvt_pk_bf16_f32 v225, v226, v227
    v_mfma_f32_16x16x32_bf16 v[248:251], a[180:183], v[76:79], v[248:251]
    v_cvt_pk_bf16_f32 v226, v228, v229
    v_cvt_pk_bf16_f32 v227, v230, v231
    v_mfma_f32_16x16x32_bf16 v[252:255], a[184:187], v[72:75], v[252:255]
    ds_write_b64 v125, v[224:225] offset:0
    ds_write_b64 v125, v[226:227] offset:32
    v_mfma_f32_16x16x32_bf16 v[252:255], a[188:191], v[76:79], v[252:255]
    v_mul_f32 v232, v123, v232
    v_mul_f32 v233, v123, v233
    v_pk_mul_f32 v[234:235], v[234:235], v[122:123] op_sel:[0,1] op_sel_hi:[1,1]
    v_pk_mul_f32 v[236:237], v[236:237], v[122:123] op_sel:[0,1] op_sel_hi:[1,1]
    v_pk_mul_f32 v[238:239], v[238:239], v[122:123] op_sel:[0,1] op_sel_hi:[1,1]
    v_cvt_pk_bf16_f32 v232, v232, v233
    v_cvt_pk_bf16_f32 v233, v234, v235
    v_cvt_pk_bf16_f32 v234, v236, v237
    v_cvt_pk_bf16_f32 v235, v238, v239
    ds_write_b64 v125, v[232:233] offset:64
    ds_write_b64 v125, v[234:235] offset:96
    ds_read_b128 v[228:231], v126 offset:0
    ds_read_b128 v[236:239], v126 offset:3200
    v_pk_mul_f32 v[240:241], v[240:241], v[122:123] op_sel:[0,1] op_sel_hi:[1,1]
    v_pk_mul_f32 v[242:243], v[242:243], v[122:123] op_sel:[0,1] op_sel_hi:[1,1]
    v_pk_mul_f32 v[244:245], v[244:245], v[122:123] op_sel:[0,1] op_sel_hi:[1,1]
    v_pk_mul_f32 v[246:247], v[246:247], v[122:123] op_sel:[0,1] op_sel_hi:[1,1]
    v_cvt_pk_bf16_f32 v240, v240, v241
    v_cvt_pk_bf16_f32 v241, v242, v243
    v_cvt_pk_bf16_f32 v242, v244, v245
    v_cvt_pk_bf16_f32 v243, v246, v247
    s_waitcnt lgkmcnt(1)
    buffer_store_dwordx4 v[228:231], v127, s[16:19], s74 offen offset:0 sc1
    ds_write_b64 v125, v[240:241] offset:128
    ds_write_b64 v125, v[242:243] offset:160
    v_pk_mul_f32 v[248:249], v[248:249], v[122:123] op_sel:[0,1] op_sel_hi:[1,1]
    v_pk_mul_f32 v[250:251], v[250:251], v[122:123] op_sel:[0,1] op_sel_hi:[1,1]
    v_pk_mul_f32 v[252:253], v[252:253], v[122:123] op_sel:[0,1] op_sel_hi:[1,1]
    v_pk_mul_f32 v[254:255], v[254:255], v[122:123] op_sel:[0,1] op_sel_hi:[1,1]
    s_waitcnt lgkmcnt(2)
    buffer_store_dwordx4 v[236:239], v127, s[16:19], s74 offen offset:2048 sc1
    v_cvt_pk_bf16_f32 v248, v248, v249
    v_cvt_pk_bf16_f32 v249, v250, v251
    v_cvt_pk_bf16_f32 v250, v252, v253
    v_cvt_pk_bf16_f32 v251, v254, v255
    ds_write_b64 v125, v[248:249] offset:192
    ds_write_b64 v125, v[250:251] offset:224
    ds_read_b128 v[244:247], v126 offset:128
    ds_read_b128 v[252:255], v126 offset:3328
    s_waitcnt lgkmcnt(1)
    buffer_store_dwordx4 v[244:247], v127, s[16:19], s74 offen offset:128 sc1
    s_waitcnt lgkmcnt(0)
    buffer_store_dwordx4 v[252:255], v127, s[16:19], s74 offen offset:2176 sc1
    v_cmp_lt_u32 vcc, 0x28000000, v124
    s_cmp_lg_u32 s70, 0
    s_cbranch_scc1 L_slow
    s_nop 3
    s_cbranch_vccnz L_slow
    s_endpgm
L_tail3:
    v_mfma_f32_16x16x32_bf16 v[0:3], a[64:67], a[0:3], 0
    s_waitcnt vmcnt(8)
    v_exp_f32 v58, v58
    v_mfma_f32_16x16x32_bf16 v[0:3], a[68:71], a[4:7], v[0:3]
    s_barrier
    v_mfma_f32_16x16x32_bf16 v[0:3], a[72:75], a[8:11], v[0:3]
    v_exp_f32 v59, v59
    v_mfma_f32_16x16x32_bf16 v[0:3], a[76:79], a[12:15], v[0:3]
    v_exp_f32 v60, v60
    v_mfma_f32_16x16x32_bf16 v[4:7], a[92:95], a[12:15], 0
    v_exp_f32 v61, v61
    v_mfma_f32_16x16x32_bf16 v[4:7], a[88:91], a[8:11], v[4:7]
    v_exp_f32 v62, v62
    v_mfma_f32_16x16x32_bf16 v[4:7], a[84:87], a[4:7], v[4:7]
    v_cvt_pk_bf16_f32 v93, v58, v59
    v_cvt_pk_bf16_f32 v94, v60, v61
    v_mfma_f32_16x16x32_bf16 v[4:7], a[80:83], a[0:3], v[4:7]
    v_exp_f32 v63, v63
    v_mfma_f32_16x16x32_bf16 v[8:11], a[96:99], a[0:3], 0
    s_add_u32 m0, s65, 49152
    v_exp_f32 v0, v0
    v_mfma_f32_16x16x32_bf16 v[8:11], a[100:103], a[4:7], v[8:11]
    v_exp_f32 v1, v1
    v_mfma_f32_16x16x32_bf16 v[8:11], a[104:107], a[8:11], v[8:11]
    s_nop 0
    buffer_load_dwordx4 v113, s[12:15], s60 offen offset:0 sc1 lds
    v_mfma_f32_16x16x32_bf16 v[8:11], a[108:111], a[12:15], v[8:11]
    s_waitcnt lgkmcnt(0)
    v_cvt_pk_bf16_f32 v95, v62, v63
    v_cvt_pk_bf16_f32 v64, v0, v1
    v_mfma_f32_16x16x32_bf16 v[12:15], a[124:127], a[12:15], 0
    v_exp_f32 v2, v2
    v_mfma_f32_16x16x32_bf16 v[12:15], a[120:123], a[8:11], v[12:15]
    v_exp_f32 v3, v3
    v_mfma_f32_16x16x32_bf16 v[12:15], a[116:119], a[4:7], v[12:15]
    s_nop 0
    buffer_load_dwordx4 v113, s[12:15], s61 offen offset:1024 sc1 lds
    v_mfma_f32_16x16x32_bf16 v[12:15], a[112:115], a[0:3], v[12:15]
    v_exp_f32 v4, v4
    v_mfma_f32_16x16x32_bf16 v[192:195], a[128:131], v[80:83], v[192:195]
    v_exp_f32 v5, v5
    v_mfma_f32_16x16x32_bf16 v[192:195], a[132:135], v[84:87], v[192:195]
    v_exp_f32 v6, v6
    v_mfma_f32_16x16x32_bf16 v[196:199], a[136:139], v[80:83], v[196:199]
    s_nop 0
    buffer_load_dwordx4 v113, s[12:15], s62 offen offset:2048 sc1 lds
    v_mfma_f32_16x16x32_bf16 v[196:199], a[140:143], v[84:87], v[196:199]
    v_exp_f32 v7, v7
    v_mfma_f32_16x16x32_bf16 v[200:203], a[144:147], v[80:83], v[200:203]
    v_exp_f32 v8, v8
    v_mfma_f32_16x16x32_bf16 v[200:203], a[148:151], v[84:87], v[200:203]
    v_exp_f32 v9, v9
    v_mfma_f32_16x16x32_bf16 v[204:207], a[152:155], v[80:83], v[204:207]
    s_nop 0
    buffer_load_dwordx4 v113, s[12:15], s63 offen offset:3072 sc1 lds
    v_mfma_f32_16x16x32_bf16 v[204:207], a[156:159], v[84:87], v[204:207]
    v_exp_f32 v10, v10
    v_mfma_f32_16x16x32_bf16 v[208:211], a[160:163], v[80:83], v[208:211]
    v_exp_f32 v11, v11
    v_mfma_f32_16x16x32_bf16 v[208:211], a[164:167], v[84:87], v[208:211]
    v_exp_f32 v12, v12
    v_mfma_f32_16x16x32_bf16 v[212:215], a[168:171], v[80:83], v[212:215]
    v_cvt_pk_bf16_f32 v65, v2, v3
    v_cvt_pk_bf16_f32 v66, v4, v5
    v_mfma_f32_16x16x32_bf16 v[212:215], a[172:175], v[84:87], v[212:215]
    v_exp_f32 v13, v13
    v_mfma_f32_16x16x32_bf16 v[216:219], a[176:179], v[80:83], v[216:219]
    v_cvt_pk_bf16_f32 v67, v6, v7
    v_cvt_pk_bf16_f32 v68, v8, v9
    v_mfma_f32_16x16x32_bf16 v[216:219], a[180:183], v[84:87], v[216:219]
    v_exp_f32 v14, v14
    v_mfma_f32_16x16x32_bf16 v[220:223], a[184:187], v[80:83], v[220:223]
    v_cvt_pk_bf16_f32 v69, v10, v11
    v_cvt_pk_bf16_f32 v70, v12, v13
    v_mfma_f32_16x16x32_bf16 v[220:223], a[188:191], v[84:87], v[220:223]
    v_exp_f32 v15, v15
    v_smfmac_f32_16x16x64_bf16 a[200:203], a[208:211], v[80:87], v114
    v_cvt_pk_bf16_f32 v71, v14, v15
    v_mbcnt_lo_u32_b32 v120, -1, 0
    v_mfma_f32_16x16x32_bf16 v[16:19], a[64:67], a[16:19], 0
    v_mbcnt_hi_u32_b32 v120, -1, v120
    v_and_b32 v121, 15, v120
    v_mfma_f32_16x16x32_bf16 v[16:19], a[68:71], a[20:23], v[16:19]
    ds_read_b128 a[64:67], v96 offset:32768
    v_lshrrev_b32 v122, 4, v120
    v_mfma_f32_16x16x32_bf16 v[16:19], a[72:75], a[24:27], v[16:19]
    ds_read_b128 a[68:71], v97 offset:32768
    v_mul_u32_u24 v125, 400, v121
    v_mfma_f32_16x16x32_bf16 v[16:19], a[76:79], a[28:31], v[16:19]
    ds_read_b128 a[72:75], v98 offset:32768
    v_lshl_add_u32 v125, v122, 3, v125
    v_mfma_f32_16x16x32_bf16 v[20:23], a[92:95], a[28:31], 0
    ds_read_b128 a[76:79], v99 offset:32768
    v_lshrrev_b32 v121, 3, v120
    v_mfma_f32_16x16x32_bf16 v[20:23], a[88:91], a[24:27], v[20:23]
    ds_read_b128 a[92:95], v99 offset:33792
    v_and_b32 v122, 7, v120
    v_mfma_f32_16x16x32_bf16 v[20:23], a[84:87], a[20:23], v[20:23]
    ds_read_b128 a[88:91], v98 offset:33792
    v_mul_u32_u24 v126, 400, v121
    v_mfma_f32_16x16x32_bf16 v[20:23], a[80:83], a[16:19], v[20:23]
    ds_read_b128 a[84:87], v97 offset:33792
    v_lshl_add_u32 v126, v122, 4, v126
    v_mfma_f32_16x16x32_bf16 v[24:27], a[96:99], a[16:19], 0
    ds_read_b128 a[80:83], v96 offset:33792
    v_add_u32 v125, s81, v125
    v_mfma_f32_16x16x32_bf16 v[24:27], a[100:103], a[20:23], v[24:27]
    ds_read_b128 a[96:99], v96 offset:34816
    v_add_u32 v126, s81, v126
    v_mfma_f32_16x16x32_bf16 v[24:27], a[104:107], a[24:27], v[24:27]
    ds_read_b128 a[100:103], v97 offset:34816
    v_lshlrev_b32 v127, 8, v121
    v_mfma_f32_16x16x32_bf16 v[24:27], a[108:111], a[28:31], v[24:27]
    ds_read_b128 a[104:107], v98 offset:34816
    v_lshl_add_u32 v127, v122, 4, v127
    v_mfma_f32_16x16x32_bf16 v[28:31], a[124:127], a[28:31], 0
    ds_read_b128 a[108:111], v99 offset:34816
    v_add_u32 v127, s82, v127
    v_mfma_f32_16x16x32_bf16 v[28:31], a[120:123], a[24:27], v[28:31]
    v_exp_f32 v16, v16
    v_mfma_f32_16x16x32_bf16 v[28:31], a[116:119], a[20:23], v[28:31]
    v_exp_f32 v17, v17
    v_mfma_f32_16x16x32_bf16 v[28:31], a[112:115], a[16:19], v[28:31]
    ds_read_b128 a[124:127], v99 offset:35840
    v_cvt_pk_bf16_f32 v72, v16, v17
    v_mfma_f32_16x16x32_bf16 v[224:227], a[128:131], v[88:91], v[224:227]
    v_exp_f32 v18, v18
    v_mfma_f32_16x16x32_bf16 v[224:227], a[132:135], v[92:95], v[224:227]
    ds_read_b128 a[120:123], v98 offset:35840
    ds_read_b64_tr_b16 a[128:129], v100 offset:16384
    v_mfma_f32_16x16x32_bf16 v[228:231], a[136:139], v[88:91], v[228:231]
    ds_read_b128 a[116:119], v97 offset:35840
    v_mfma_f32_16x16x32_bf16 v[228:231], a[140:143], v[92:95], v[228:231]
    ds_read_b128 a[112:115], v96 offset:35840
    ds_read_b64_tr_b16 a[130:131], v100 offset:17408
    v_mfma_f32_16x16x32_bf16 v[232:235], a[144:147], v[88:91], v[232:235]
    v_exp_f32 v19, v19
    v_mfma_f32_16x16x32_bf16 v[232:235], a[148:151], v[92:95], v[232:235]
    v_exp_f32 v20, v20
    v_mfma_f32_16x16x32_bf16 v[236:239], a[152:155], v[88:91], v[236:239]
    ds_read_b64_tr_b16 a[132:133], v100 offset:18432
    v_cvt_pk_bf16_f32 v73, v18, v19
    v_mfma_f32_16x16x32_bf16 v[236:239], a[156:159], v[92:95], v[236:239]
    v_exp_f32 v21, v21
    v_mfma_f32_16x16x32_bf16 v[240:243], a[160:163], v[88:91], v[240:243]
    ds_read_b64_tr_b16 a[134:135], v100 offset:19456
    v_cvt_pk_bf16_f32 v74, v20, v21
    v_mfma_f32_16x16x32_bf16 v[240:243], a[164:167], v[92:95], v[240:243]
    ds_read_b64_tr_b16 a[136:137], v101 offset:16384
    ds_read_b64_tr_b16 a[138:139], v101 offset:17408
    v_mfma_f32_16x16x32_bf16 v[244:247], a[168:171], v[88:91], v[244:247]
    ds_read_b64_tr_b16 a[140:141], v101 offset:18432
    v_mfma_f32_16x16x32_bf16 v[244:247], a[172:175], v[92:95], v[244:247]
    v_exp_f32 v22, v22
    v_mfma_f32_16x16x32_bf16 v[248:251], a[176:179], v[88:91], v[248:251]
    ds_read_b64_tr_b16 a[142:143], v101 offset:19456
    ds_read_b64_tr_b16 a[144:145], v102 offset:16384
    v_mfma_f32_16x16x32_bf16 v[248:251], a[180:183], v[92:95], v[248:251]
    ds_read_b64_tr_b16 a[146:147], v102 offset:17408
    v_mfma_f32_16x16x32_bf16 v[252:255], a[184:187], v[88:91], v[252:255]
    ds_read_b64_tr_b16 a[148:149], v102 offset:18432
    ds_read_b64_tr_b16 a[150:151], v102 offset:19456
    v_mfma_f32_16x16x32_bf16 v[252:255], a[188:191], v[92:95], v[252:255]
    v_exp_f32 v23, v23
    v_smfmac_f32_16x16x64_bf16 a[204:207], a[208:211], v[88:95], v114
    s_waitcnt lgkmcnt(8)
    ds_read_b64_tr_b16 a[152:153], v103 offset:16384
    v_cvt_pk_bf16_f32 v75, v22, v23
    v_mfma_f32_16x16x32_bf16 v[32:35], a[64:67], a[0:3], 0
    ds_read_b64_tr_b16 a[154:155], v103 offset:17408
    ds_read_b64_tr_b16 a[156:157], v103 offset:18432
    v_mfma_f32_16x16x32_bf16 v[32:35], a[68:71], a[4:7], v[32:35]
    v_exp_f32 v24, v24
    v_mfma_f32_16x16x32_bf16 v[32:35], a[72:75], a[8:11], v[32:35]
    ds_read_b64_tr_b16 a[158:159], v103 offset:19456
    ds_read_b64_tr_b16 a[160:161], v104 offset:16384
    v_mfma_f32_16x16x32_bf16 v[32:35], a[76:79], a[12:15], v[32:35]
    ds_read_b64_tr_b16 a[162:163], v104 offset:17408
    v_mfma_f32_16x16x32_bf16 v[36:39], a[92:95], a[12:15], 0
    ds_read_b64_tr_b16 a[164:165], v104 offset:18432
    ds_read_b64_tr_b16 a[166:167], v104 offset:19456
    v_mfma_f32_16x16x32_bf16 v[36:39], a[88:91], a[8:11], v[36:39]
    v_exp_f32 v25, v25
    v_mfma_f32_16x16x32_bf16 v[36:39], a[84:87], a[4:7], v[36:39]
    ds_read_b64_tr_b16 a[168:169], v105 offset:16384
    v_cvt_pk_bf16_f32 v76, v24, v25
    v_mfma_f32_16x16x32_bf16 v[36:39], a[80:83], a[0:3], v[36:39]
    ds_read_b64_tr_b16 a[170:171], v105 offset:17408
    ds_read_b64_tr_b16 a[172:173], v105 offset:18432
    v_mfma_f32_16x16x32_bf16 v[40:43], a[96:99], a[0:3], 0
    v_exp_f32 v26, v26
    v_mfma_f32_16x16x32_bf16 v[40:43], a[100:103], a[4:7], v[40:43]
    ds_read_b64_tr_b16 a[174:175], v105 offset:19456
    ds_read_b64_tr_b16 a[176:177], v106 offset:16384
    v_mfma_f32_16x16x32_bf16 v[40:43], a[104:107], a[8:11], v[40:43]
    ds_read_b64_tr_b16 a[178:179], v106 offset:17408
    v_mfma_f32_16x16x32_bf16 v[40:43], a[108:111], a[12:15], v[40:43]
    ds_read_b64_tr_b16 a[180:181], v106 offset:18432
    ds_read_b64_tr_b16 a[182:183], v106 offset:19456
    v_mfma_f32_16x16x32_bf16 v[44:47], a[124:127], a[12:15], 0
    v_exp_f32 v27, v27
    v_mfma_f32_16x16x32_bf16 v[44:47], a[120:123], a[8:11], v[44:47]
    ds_read_b64_tr_b16 a[184:185], v107 offset:16384
    v_cvt_pk_bf16_f32 v77, v26, v27
    v_mfma_f32_16x16x32_bf16 v[44:47], a[116:119], a[4:7], v[44:47]
    ds_read_b64_tr_b16 a[186:187], v107 offset:17408
    ds_read_b64_tr_b16 a[188:189], v107 offset:18432
    v_mfma_f32_16x16x32_bf16 v[44:47], a[112:115], a[0:3], v[44:47]
    v_exp_f32 v28, v28
    v_mfma_f32_16x16x32_bf16 v[48:51], a[64:67], a[16:19], 0
    v_exp_f32 v29, v29
    v_mfma_f32_16x16x32_bf16 v[48:51], a[68:71], a[20:23], v[48:51]
    ds_read_b64_tr_b16 a[190:191], v107 offset:19456
    v_cvt_pk_bf16_f32 v78, v28, v29
    v_mfma_f32_16x16x32_bf16 v[48:51], a[72:75], a[24:27], v[48:51]
    v_exp_f32 v30, v30
    v_mfma_f32_16x16x32_bf16 v[48:51], a[76:79], a[28:31], v[48:51]
    v_exp_f32 v31, v31
    v_mfma_f32_16x16x32_bf16 v[52:55], a[92:95], a[28:31], 0
    v_exp_f32 v32, v32
    v_mfma_f32_16x16x32_bf16 v[52:55], a[88:91], a[24:27], v[52:55]
    v_exp_f32 v33, v33
    v_mfma_f32_16x16x32_bf16 v[52:55], a[84:87], a[20:23], v[52:55]
    v_cvt_pk_bf16_f32 v79, v30, v31
    v_cvt_pk_bf16_f32 v80, v32, v33
    v_mfma_f32_16x16x32_bf16 v[52:55], a[80:83], a[16:19], v[52:55]
    v_exp_f32 v34, v34
    v_mfma_f32_16x16x32_bf16 v[56:59], a[96:99], a[16:19], 0
    v_exp_f32 v35, v35
    v_mfma_f32_16x16x32_bf16 v[56:59], a[100:103], a[20:23], v[56:59]
    s_waitcnt vmcnt(0)
    v_exp_f32 v36, v36
    v_mfma_f32_16x16x32_bf16 v[56:59], a[104:107], a[24:27], v[56:59]
    s_barrier
    v_mfma_f32_16x16x32_bf16 v[56:59], a[108:111], a[28:31], v[56:59]
    ds_read_b128 a[64:67], v96 offset:49152
    v_cvt_pk_bf16_f32 v81, v34, v35
    v_mfma_f32_16x16x32_bf16 v[60:63], a[124:127], a[28:31], 0
    v_exp_f32 v37, v37
    v_mfma_f32_16x16x32_bf16 v[60:63], a[120:123], a[24:27], v[60:63]
    ds_read_b128 a[68:71], v97 offset:49152
    v_cvt_pk_bf16_f32 v82, v36, v37
    v_mfma_f32_16x16x32_bf16 v[60:63], a[116:119], a[20:23], v[60:63]
    v_exp_f32 v38, v38
    v_mfma_f32_16x16x32_bf16 v[60:63], a[112:115], a[16:19], v[60:63]
    v_exp_f32 v39, v39
    v_mfma_f32_16x16x32_bf16 v[128:131], a[128:131], v[64:67], v[128:131]
    ds_read_b128 a[72:75], v98 offset:49152
    v_cvt_pk_bf16_f32 v83, v38, v39
    v_mfma_f32_16x16x32_bf16 v[128:131], a[132:135], v[68:71], v[128:131]
    s_waitcnt lgkmcnt(3)
    v_exp_f32 v40, v40
    v_mfma_f32_16x16x32_bf16 v[132:135], a[136:139], v[64:67], v[132:135]
    v_exp_f32 v48, v48
    v_mfma_f32_16x16x32_bf16 v[132:135], a[140:143], v[68:71], v[132:135]
    v_exp_f32 v41, v41
    v_mfma_f32_16x16x32_bf16 v[136:139], a[144:147], v[64:67], v[136:139]
    ds_read_b128 a[76:79], v99 offset:49152
    v_cvt_pk_bf16_f32 v84, v40, v41
    v_mfma_f32_16x16x32_bf16 v[136:139], a[148:151], v[68:71], v[136:139]
    v_exp_f32 v49, v49
    v_mfma_f32_16x16x32_bf16 v[140:143], a[152:155], v[64:67], v[140:143]
    ds_read_b128 a[92:95], v99 offset:50176
    v_cvt_pk_bf16_f32 v88, v48, v49
    v_mfma_f32_16x16x32_bf16 v[140:143], a[156:159], v[68:71], v[140:143]
    v_exp_f32 v42, v42
    v_mfma_f32_16x16x32_bf16 v[144:147], a[160:163], v[64:67], v[144:147]
    v_exp_f32 v50, v50
    v_mfma_f32_16x16x32_bf16 v[144:147], a[164:167], v[68:71], v[144:147]
    v_exp_f32 v43, v43
    v_mfma_f32_16x16x32_bf16 v[148:151], a[168:171], v[64:67], v[148:151]
    ds_read_b128 a[88:91], v98 offset:50176
    v_cvt_pk_bf16_f32 v85, v42, v43
    v_mfma_f32_16x16x32_bf16 v[148:151], a[172:175], v[68:71], v[148:151]
    v_exp_f32 v51, v51
    v_mfma_f32_16x16x32_bf16 v[152:155], a[176:179], v[64:67], v[152:155]
    ds_read_b128 a[84:87], v97 offset:50176
    v_cvt_pk_bf16_f32 v89, v50, v51
    v_mfma_f32_16x16x32_bf16 v[152:155], a[180:183], v[68:71], v[152:155]
    v_exp_f32 v44, v44
    v_mfma_f32_16x16x32_bf16 v[156:159], a[184:187], v[64:67], v[156:159]
    v_exp_f32 v52, v52
    v_mfma_f32_16x16x32_bf16 v[156:159], a[188:191], v[68:71], v[156:159]
    v_exp_f32 v45, v45
    v_smfmac_f32_16x16x64_bf16 a[192:195], a[208:211], v[64:71], v114
    ds_read_b128 a[80:83], v96 offset:50176
    v_cvt_pk_bf16_f32 v86, v44, v45
    v_mfma_f32_16x16x32_bf16 v[160:163], a[128:131], v[72:75], v[160:163]
    ds_read_b128 a[96:99], v96 offset:51200
    v_mov_b32 v70, 0
    v_mfma_f32_16x16x32_bf16 v[160:163], a[132:135], v[76:79], v[160:163]
    ds_read_b128 a[100:103], v97 offset:51200
    v_mov_b32 v71, 0
    v_mfma_f32_16x16x32_bf16 v[164:167], a[136:139], v[72:75], v[164:167]
    ds_read_b128 a[104:107], v98 offset:51200
    ds_read_b64_tr_b16 a[128:129], v100 offset:32768
    v_mfma_f32_16x16x32_bf16 v[164:167], a[140:143], v[76:79], v[164:167]
    ds_read_b128 a[108:111], v99 offset:51200
    v_mfma_f32_16x16x32_bf16 v[168:171], a[144:147], v[72:75], v[168:171]
    ds_read_b64_tr_b16 a[130:131], v100 offset:33792
    ds_read_b64_tr_b16 a[132:133], v100 offset:34816
    v_mfma_f32_16x16x32_bf16 v[168:171], a[148:151], v[76:79], v[168:171]
    v_exp_f32 v53, v53
    v_mfma_f32_16x16x32_bf16 v[172:175], a[152:155], v[72:75], v[172:175]
    ds_read_b64_tr_b16 a[134:135], v100 offset:35840
    v_cvt_pk_bf16_f32 v90, v52, v53
    v_mfma_f32_16x16x32_bf16 v[172:175], a[156:159], v[76:79], v[172:175]
    ds_read_b64_tr_b16 a[136:137], v101 offset:32768
    ds_read_b64_tr_b16 a[138:139], v101 offset:33792
    v_mfma_f32_16x16x32_bf16 v[176:179], a[160:163], v[72:75], v[176:179]
    v_exp_f32 v46, v46
    v_mfma_f32_16x16x32_bf16 v[176:179], a[164:167], v[76:79], v[176:179]
    ds_read_b64_tr_b16 a[140:141], v101 offset:34816
    ds_read_b64_tr_b16 a[142:143], v101 offset:35840
    v_mfma_f32_16x16x32_bf16 v[180:183], a[168:171], v[72:75], v[180:183]
    v_exp_f32 v54, v54
    v_mfma_f32_16x16x32_bf16 v[180:183], a[172:175], v[76:79], v[180:183]
    ds_read_b64_tr_b16 a[144:145], v102 offset:32768
    ds_read_b64_tr_b16 a[146:147], v102 offset:33792
    v_mfma_f32_16x16x32_bf16 v[184:187], a[176:179], v[72:75], v[184:187]
    v_exp_f32 v47, v47
    v_mfma_f32_16x16x32_bf16 v[184:187], a[180:183], v[76:79], v[184:187]
    ds_read_b64_tr_b16 a[148:149], v102 offset:34816
    v_cvt_pk_bf16_f32 v87, v46, v47
    v_mfma_f32_16x16x32_bf16 v[188:191], a[184:187], v[72:75], v[188:191]
    v_exp_f32 v55, v55
    v_mfma_f32_16x16x32_bf16 v[188:191], a[188:191], v[76:79], v[188:191]
    ds_read_b64_tr_b16 a[150:151], v102 offset:35840
    v_cvt_pk_bf16_f32 v91, v54, v55
    v_smfmac_f32_16x16x64_bf16 a[196:199], a[208:211], v[72:79], v114
    s_waitcnt lgkmcnt(6)
    ds_read_b64_tr_b16 a[152:153], v103 offset:32768
    ds_read_b64_tr_b16 a[154:155], v103 offset:33792
    v_mfma_f32_16x16x32_bf16 v[0:3], a[64:67], a[0:3], 0
    ds_read_b64_tr_b16 a[156:157], v103 offset:34816
    v_mov_b32 v78, 0
    v_mfma_f32_16x16x32_bf16 v[0:3], a[68:71], a[4:7], v[0:3]
    v_exp_f32 v56, v56
    v_mfma_f32_16x16x32_bf16 v[0:3], a[72:75], a[8:11], v[0:3]
    ds_read_b64_tr_b16 a[158:159], v103 offset:35840
    v_mov_b32 v79, 0
    v_mfma_f32_16x16x32_bf16 v[0:3], a[76:79], a[12:15], v[0:3]
    ds_read_b64_tr_b16 a[160:161], v104 offset:32768
    ds_read_b64_tr_b16 a[162:163], v104 offset:33792
    v_mfma_f32_16x16x32_bf16 v[4:7], a[92:95], a[12:15], 0
    ds_read_b64_tr_b16 a[164:165], v104 offset:34816
    v_mfma_f32_16x16x32_bf16 v[4:7], a[88:91], a[8:11], v[4:7]
    v_exp_f32 v57, v57
    v_mfma_f32_16x16x32_bf16 v[4:7], a[84:87], a[4:7], v[4:7]
    ds_read_b64_tr_b16 a[166:167], v104 offset:35840
    v_cvt_pk_bf16_f32 v92, v56, v57
    v_mfma_f32_16x16x32_bf16 v[4:7], a[80:83], a[0:3], v[4:7]
    ds_read_b64_tr_b16 a[168:169], v105 offset:32768
    ds_read_b64_tr_b16 a[170:171], v105 offset:33792
    v_mfma_f32_16x16x32_bf16 v[8:11], a[96:99], a[0:3], v[116:119]
    ds_read_b64_tr_b16 a[172:173], v105 offset:34816
    v_mfma_f32_16x16x32_bf16 v[8:11], a[100:103], a[4:7], v[8:11]
    v_exp_f32 v58, v58
    v_mfma_f32_16x16x32_bf16 v[8:11], a[104:107], a[8:11], v[8:11]
    ds_read_b64_tr_b16 a[174:175], v105 offset:35840
    ds_read_b64_tr_b16 a[176:177], v106 offset:32768
    v_mfma_f32_16x16x32_bf16 v[8:11], a[108:111], a[12:15], v[8:11]
    ds_read_b64_tr_b16 a[178:179], v106 offset:33792
    v_mfma_f32_16x16x32_bf16 v[16:19], a[64:67], a[16:19], 0
    ds_read_b64_tr_b16 a[180:181], v106 offset:34816
    ds_read_b64_tr_b16 a[182:183], v106 offset:35840
    v_mfma_f32_16x16x32_bf16 v[16:19], a[68:71], a[20:23], v[16:19]
    v_exp_f32 v59, v59
    v_mfma_f32_16x16x32_bf16 v[16:19], a[72:75], a[24:27], v[16:19]
    ds_read_b64_tr_b16 a[184:185], v107 offset:32768
    v_cvt_pk_bf16_f32 v93, v58, v59
    v_mfma_f32_16x16x32_bf16 v[16:19], a[76:79], a[28:31], v[16:19]
    ds_read_b64_tr_b16 a[186:187], v107 offset:33792
    ds_read_b64_tr_b16 a[188:189], v107 offset:34816
    v_mfma_f32_16x16x32_bf16 v[20:23], a[92:95], a[28:31], 0
    v_exp_f32 v60, v60
    v_mfma_f32_16x16x32_bf16 v[20:23], a[88:91], a[24:27], v[20:23]
    ds_read_b64_tr_b16 a[190:191], v107 offset:35840
    ds_read_b128 a[64:67], v96 offset:16384
    v_mfma_f32_16x16x32_bf16 v[20:23], a[84:87], a[20:23], v[20:23]
    v_exp_f32 v61, v61
    v_mfma_f32_16x16x32_bf16 v[20:23], a[80:83], a[16:19], v[20:23]
    v_exp_f32 v62, v62
    v_mfma_f32_16x16x32_bf16 v[24:27], a[96:99], a[16:19], v[116:119]
    v_exp_f32 v63, v63
    v_mfma_f32_16x16x32_bf16 v[24:27], a[100:103], a[20:23], v[24:27]
    v_cvt_pk_bf16_f32 v94, v60, v61
    v_cvt_pk_bf16_f32 v95, v62, v63
    v_mfma_f32_16x16x32_bf16 v[24:27], a[104:107], a[24:27], v[24:27]
    v_exp_f32 v0, v0
    v_mfma_f32_16x16x32_bf16 v[24:27], a[108:111], a[28:31], v[24:27]
    v_exp_f32 v1, v1
    v_mfma_f32_16x16x32_bf16 v[128:131], a[128:131], v[80:83], v[128:131]
    ds_read_b128 a[68:71], v97 offset:16384
    v_cvt_pk_bf16_f32 v64, v0, v1
    v_mfma_f32_16x16x32_bf16 v[128:131], a[132:135], v[84:87], v[128:131]
    v_exp_f32 v2, v2
    v_mfma_f32_16x16x32_bf16 v[132:135], a[136:139], v[80:83], v[132:135]
    s_waitcnt lgkmcnt(1)
    v_exp_f32 v3, v3
    v_mfma_f32_16x16x32_bf16 v[132:135], a[140:143], v[84:87], v[132:135]
    ds_read_b128 a[72:75], v98 offset:16384
    v_cvt_pk_bf16_f32 v65, v2, v3
    v_mfma_f32_16x16x32_bf16 v[136:139], a[144:147], v[80:83], v[136:139]
    v_exp_f32 v4, v4
    v_mfma_f32_16x16x32_bf16 v[136:139], a[148:151], v[84:87], v[136:139]
    v_exp_f32 v5, v5
    v_mfma_f32_16x16x32_bf16 v[140:143], a[152:155], v[80:83], v[140:143]
    ds_read_b128 a[76:79], v99 offset:16384
    v_cvt_pk_bf16_f32 v66, v4, v5
    v_mfma_f32_16x16x32_bf16 v[140:143], a[156:159], v[84:87], v[140:143]
    v_exp_f32 v6, v6
    v_mfma_f32_16x16x32_bf16 v[144:147], a[160:163], v[80:83], v[144:147]
    v_exp_f32 v7, v7
    v_mfma_f32_16x16x32_bf16 v[144:147], a[164:167], v[84:87], v[144:147]
    ds_read_b128 a[92:95], v99 offset:17408
    v_cvt_pk_bf16_f32 v67, v6, v7
    v_mfma_f32_16x16x32_bf16 v[148:151], a[168:171], v[80:83], v[148:151]
    v_exp_f32 v8, v8
    v_mfma_f32_16x16x32_bf16 v[148:151], a[172:175], v[84:87], v[148:151]
    v_exp_f32 v16, v16
    v_mfma_f32_16x16x32_bf16 v[152:155], a[176:179], v[80:83], v[152:155]
    v_exp_f32 v9, v9
    v_mfma_f32_16x16x32_bf16 v[152:155], a[180:183], v[84:87], v[152:155]
    ds_read_b128 a[88:91], v98 offset:17408
    v_cvt_pk_bf16_f32 v68, v8, v9
    v_mfma_f32_16x16x32_bf16 v[156:159], a[184:187], v[80:83], v[156:159]
    v_exp_f32 v17, v17
    v_mfma_f32_16x16x32_bf16 v[156:159], a[188:191], v[84:87], v[156:159]
    ds_read_b128 a[84:87], v97 offset:17408
    v_cvt_pk_bf16_f32 v72, v16, v17
    v_smfmac_f32_16x16x64_bf16 a[192:195], a[208:211], v[80:87], v114
    v_exp_f32 v10, v10
    v_mfma_f32_16x16x32_bf16 v[160:163], a[128:131], v[88:91], v[160:163]
    v_exp_f32 v18, v18
    v_mfma_f32_16x16x32_bf16 v[160:163], a[132:135], v[92:95], v[160:163]
    ds_read_b128 a[80:83], v96 offset:17408
    ds_read_b64_tr_b16 a[128:129], v100 offset:49152
    v_mfma_f32_16x16x32_bf16 v[164:167], a[136:139], v[88:91], v[164:167]
    ds_read_b128 a[96:99], v96 offset:18432
    v_mfma_f32_16x16x32_bf16 v[164:167], a[140:143], v[92:95], v[164:167]
    ds_read_b128 a[100:103], v97 offset:18432
    ds_read_b64_tr_b16 a[130:131], v100 offset:50176
    v_mfma_f32_16x16x32_bf16 v[168:171], a[144:147], v[88:91], v[168:171]
    ds_read_b128 a[104:107], v98 offset:18432
    v_mfma_f32_16x16x32_bf16 v[168:171], a[148:151], v[92:95], v[168:171]
    ds_read_b128 a[108:111], v99 offset:18432
    ds_read_b64_tr_b16 a[132:133], v100 offset:51200
    v_mfma_f32_16x16x32_bf16 v[172:175], a[152:155], v[88:91], v[172:175]
    ds_read_b128 a[124:127], v99 offset:19456
    v_mfma_f32_16x16x32_bf16 v[172:175], a[156:159], v[92:95], v[172:175]
    ds_read_b128 a[120:123], v98 offset:19456
    ds_read_b64_tr_b16 a[134:135], v100 offset:52224
    v_mfma_f32_16x16x32_bf16 v[176:179], a[160:163], v[88:91], v[176:179]
    ds_read_b128 a[116:119], v97 offset:19456
    v_mfma_f32_16x16x32_bf16 v[176:179], a[164:167], v[92:95], v[176:179]
    ds_read_b128 a[112:115], v96 offset:19456
    ds_read_b64_tr_b16 a[136:137], v101 offset:49152
    v_mfma_f32_16x16x32_bf16 v[180:183], a[168:171], v[88:91], v[180:183]
    ds_read_b64_tr_b16 a[138:139], v101 offset:50176
    v_mfma_f32_16x16x32_bf16 v[180:183], a[172:175], v[92:95], v[180:183]
    ds_read_b64_tr_b16 a[140:141], v101 offset:51200
    ds_read_b64_tr_b16 a[142:143], v101 offset:52224
    v_mfma_f32_16x16x32_bf16 v[184:187], a[176:179], v[88:91], v[184:187]
    v_exp_f32 v11, v11
    v_mfma_f32_16x16x32_bf16 v[184:187], a[180:183], v[92:95], v[184:187]
    ds_read_b64_tr_b16 a[144:145], v102 offset:49152
    v_cvt_pk_bf16_f32 v69, v10, v11
    v_mfma_f32_16x16x32_bf16 v[188:191], a[184:187], v[88:91], v[188:191]
    v_exp_f32 v19, v19
    v_mfma_f32_16x16x32_bf16 v[188:191], a[188:191], v[92:95], v[188:191]
    ds_read_b64_tr_b16 a[146:147], v102 offset:50176
    v_cvt_pk_bf16_f32 v73, v18, v19
    v_smfmac_f32_16x16x64_bf16 a[196:199], a[208:211], v[88:95], v114
    ds_read_b64_tr_b16 a[148:149], v102 offset:51200
    ds_read_b64_tr_b16 a[150:151], v102 offset:52224
    v_mfma_f32_16x16x32_bf16 v[32:35], a[64:67], a[32:35], 0
    s_waitcnt lgkmcnt(7)
    ds_read_b64_tr_b16 a[152:153], v103 offset:49152
    v_mfma_f32_16x16x32_bf16 v[32:35], a[68:71], a[36:39], v[32:35]
    v_exp_f32 v20, v20
    v_mfma_f32_16x16x32_bf16 v[32:35], a[72:75], a[40:43], v[32:35]
    ds_read_b64_tr_b16 a[154:155], v103 offset:50176
    ds_read_b64_tr_b16 a[156:157], v103 offset:51200
    v_mfma_f32_16x16x32_bf16 v[32:35], a[76:79], a[44:47], v[32:35]
    ds_read_b64_tr_b16 a[158:159], v103 offset:52224
    v_mfma_f32_16x16x32_bf16 v[36:39], a[92:95], a[44:47], 0
    ds_read_b64_tr_b16 a[160:161], v104 offset:49152
    ds_read_b64_tr_b16 a[162:163], v104 offset:50176
    v_mfma_f32_16x16x32_bf16 v[36:39], a[88:91], a[40:43], v[36:39]
    v_exp_f32 v21, v21
    v_mfma_f32_16x16x32_bf16 v[36:39], a[84:87], a[36:39], v[36:39]
    ds_read_b64_tr_b16 a[164:165], v104 offset:51200
    v_cvt_pk_bf16_f32 v74, v20, v21
    v_mfma_f32_16x16x32_bf16 v[36:39], a[80:83], a[32:35], v[36:39]
    ds_read_b64_tr_b16 a[166:167], v104 offset:52224
    ds_read_b64_tr_b16 a[168:169], v105 offset:49152
    v_mfma_f32_16x16x32_bf16 v[40:43], a[96:99], a[32:35], 0
    v_exp_f32 v22, v22
    v_mfma_f32_16x16x32_bf16 v[40:43], a[100:103], a[36:39], v[40:43]
    ds_read_b64_tr_b16 a[170:171], v105 offset:50176
    ds_read_b64_tr_b16 a[172:173], v105 offset:51200
    v_mfma_f32_16x16x32_bf16 v[40:43], a[104:107], a[40:43], v[40:43]
    ds_read_b64_tr_b16 a[174:175], v105 offset:52224
    v_mfma_f32_16x16x32_bf16 v[40:43], a[108:111], a[44:47], v[40:43]
    ds_read_b64_tr_b16 a[176:177], v106 offset:49152
    ds_read_b64_tr_b16 a[178:179], v106 offset:50176
    v_mfma_f32_16x16x32_bf16 v[44:47], a[124:127], a[44:47], 0
    v_exp_f32 v23, v23
    v_mfma_f32_16x16x32_bf16 v[44:47], a[120:123], a[40:43], v[44:47]
    ds_read_b64_tr_b16 a[180:181], v106 offset:51200
    v_cvt_pk_bf16_f32 v75, v22, v23
    v_mfma_f32_16x16x32_bf16 v[44:47], a[116:119], a[36:39], v[44:47]
    ds_read_b64_tr_b16 a[182:183], v106 offset:52224
    ds_read_b64_tr_b16 a[184:185], v107 offset:49152
    v_mfma_f32_16x16x32_bf16 v[44:47], a[112:115], a[32:35], v[44:47]
    v_exp_f32 v24, v24
    v_smfmac_f32_16x16x64_bf16 a[192:195], a[208:211], v[64:71], v114
    ds_read_b64_tr_b16 a[186:187], v107 offset:50176
    ds_read_b64_tr_b16 a[188:189], v107 offset:51200
    v_mfma_f32_16x16x32_bf16 v[128:131], a[128:131], v[64:67], v[128:131]
    v_exp_f32 v25, v25
    v_mfma_f32_16x16x32_bf16 v[128:131], a[132:135], v[68:71], v[128:131]
    s_waitcnt lgkmcnt(7)
    ds_read_b64_tr_b16 a[190:191], v107 offset:52224
    v_cvt_pk_bf16_f32 v76, v24, v25
    v_mfma_f32_16x16x32_bf16 v[132:135], a[136:139], v[64:67], v[132:135]
    v_exp_f32 v26, v26
    v_mfma_f32_16x16x32_bf16 v[132:135], a[140:143], v[68:71], v[132:135]
    v_exp_f32 v27, v27
    v_mfma_f32_16x16x32_bf16 v[136:139], a[144:147], v[64:67], v[136:139]
    v_cvt_pk_bf16_f32 v77, v26, v27
    v_accvgpr_read_b32 v120, a192
    v_mfma_f32_16x16x32_bf16 v[136:139], a[148:151], v[68:71], v[136:139]
    v_accvgpr_read_b32 v121, a193
    v_add_f32 v120, v120, v121
    v_mfma_f32_16x16x32_bf16 v[140:143], a[152:155], v[64:67], v[140:143]
    v_rcp_f32 v121, v120
    v_mfma_f32_16x16x32_bf16 v[140:143], a[156:159], v[68:71], v[140:143]
    v_subrev_u32 v120, 0x2b800000, v120
    v_mov_b32 v124, v120
    v_mfma_f32_16x16x32_bf16 v[144:147], a[160:163], v[64:67], v[144:147]
    v_mul_f32 v128, v121, v128
    v_mul_f32 v129, v121, v129
    v_mfma_f32_16x16x32_bf16 v[144:147], a[164:167], v[68:71], v[144:147]
    v_mul_f32 v130, v121, v130
    v_mul_f32 v131, v121, v131
    v_mfma_f32_16x16x32_bf16 v[148:151], a[168:171], v[64:67], v[148:151]
    v_mul_f32 v132, v121, v132
    v_mul_f32 v133, v121, v133
    v_mfma_f32_16x16x32_bf16 v[148:151], a[172:175], v[68:71], v[148:151]
    s_waitcnt lgkmcnt(0)
    v_mul_f32 v134, v121, v134
    v_mul_f32 v135, v121, v135
    v_mfma_f32_16x16x32_bf16 v[152:155], a[176:179], v[64:67], v[152:155]
    v_cvt_pk_bf16_f32 v128, v128, v129
    v_cvt_pk_bf16_f32 v129, v130, v131
    v_mfma_f32_16x16x32_bf16 v[152:155], a[180:183], v[68:71], v[152:155]
    v_cvt_pk_bf16_f32 v130, v132, v133
    v_cvt_pk_bf16_f32 v131, v134, v135
    v_mfma_f32_16x16x32_bf16 v[156:159], a[184:187], v[64:67], v[156:159]
    ds_write_b64 v125, v[128:129] offset:0
    ds_write_b64 v125, v[130:131] offset:32
    v_mfma_f32_16x16x32_bf16 v[156:159], a[188:191], v[68:71], v[156:159]
    v_exp_f32 v32, v32
    v_smfmac_f32_16x16x64_bf16 a[196:199], a[208:211], v[72:79], v114
    v_exp_f32 v33, v33
    v_mfma_f32_16x16x32_bf16 v[160:163], a[128:131], v[72:75], v[160:163]
    v_mul_f32 v136, v121, v136
    v_mul_f32 v137, v121, v137
    v_mfma_f32_16x16x32_bf16 v[160:163], a[132:135], v[76:79], v[160:163]
    v_exp_f32 v34, v34
    v_mfma_f32_16x16x32_bf16 v[164:167], a[136:139], v[72:75], v[164:167]
    v_mul_f32 v138, v121, v138
    v_mul_f32 v139, v121, v139
    v_mfma_f32_16x16x32_bf16 v[164:167], a[140:143], v[76:79], v[164:167]
    v_mul_f32 v140, v121, v140
    v_mul_f32 v141, v121, v141
    v_pk_mul_f32 v[142:143], v[142:143], v[120:121] op_sel:[0,1] op_sel_hi:[1,1]
    v_cvt_pk_bf16_f32 v136, v136, v137
    v_cvt_pk_bf16_f32 v137, v138, v139
    v_cvt_pk_bf16_f32 v138, v140, v141
    v_cvt_pk_bf16_f32 v139, v142, v143
    ds_write_b64 v125, v[136:137] offset:64
    ds_write_b64 v125, v[138:139] offset:96
    ds_read_b128 v[132:135], v126 offset:0
    ds_read_b128 v[140:143], v126 offset:3200
    v_pk_mul_f32 v[144:145], v[144:145], v[120:121] op_sel:[0,1] op_sel_hi:[1,1]
    v_pk_mul_f32 v[146:147], v[146:147], v[120:121] op_sel:[0,1] op_sel_hi:[1,1]
    v_pk_mul_f32 v[148:149], v[148:149], v[120:121] op_sel:[0,1] op_sel_hi:[1,1]
    v_pk_mul_f32 v[150:151], v[150:151], v[120:121] op_sel:[0,1] op_sel_hi:[1,1]
    v_cvt_pk_bf16_f32 v144, v144, v145
    v_cvt_pk_bf16_f32 v145, v146, v147
    v_cvt_pk_bf16_f32 v146, v148, v149
    v_cvt_pk_bf16_f32 v147, v150, v151
    s_waitcnt lgkmcnt(1)
    buffer_store_dwordx4 v[132:135], v127, s[16:19], s77 offen offset:0 sc1
    ds_write_b64 v125, v[144:145] offset:128
    ds_write_b64 v125, v[146:147] offset:160
    v_pk_mul_f32 v[152:153], v[152:153], v[120:121] op_sel:[0,1] op_sel_hi:[1,1]
    v_pk_mul_f32 v[154:155], v[154:155], v[120:121] op_sel:[0,1] op_sel_hi:[1,1]
    v_pk_mul_f32 v[156:157], v[156:157], v[120:121] op_sel:[0,1] op_sel_hi:[1,1]
    v_pk_mul_f32 v[158:159], v[158:159], v[120:121] op_sel:[0,1] op_sel_hi:[1,1]
    s_waitcnt lgkmcnt(2)
    buffer_store_dwordx4 v[140:143], v127, s[16:19], s77 offen offset:2048 sc1
    v_cvt_pk_bf16_f32 v152, v152, v153
    v_cvt_pk_bf16_f32 v153, v154, v155
    v_cvt_pk_bf16_f32 v154, v156, v157
    v_cvt_pk_bf16_f32 v155, v158, v159
    ds_write_b64 v125, v[152:153] offset:192
    ds_write_b64 v125, v[154:155] offset:224
    ds_read_b128 v[148:151], v126 offset:128
    ds_read_b128 v[156:159], v126 offset:3328
    v_mfma_f32_16x16x32_bf16 v[168:171], a[144:147], v[72:75], v[168:171]
    v_accvgpr_read_b32 v122, a196
    v_accvgpr_read_b32 v123, a197
    v_mfma_f32_16x16x32_bf16 v[168:171], a[148:151], v[76:79], v[168:171]
    v_add_f32 v122, v122, v123
    v_cvt_pk_bf16_f32 v80, v32, v33
    v_mfma_f32_16x16x32_bf16 v[172:175], a[152:155], v[72:75], v[172:175]
    v_rcp_f32 v123, v122
    v_mfma_f32_16x16x32_bf16 v[172:175], a[156:159], v[76:79], v[172:175]
    v_subrev_u32 v122, 0x2b800000, v122
    v_max_u32 v124, v124, v122
    v_mfma_f32_16x16x32_bf16 v[176:179], a[160:163], v[72:75], v[176:179]
    v_exp_f32 v35, v35
    v_mfma_f32_16x16x32_bf16 v[176:179], a[164:167], v[76:79], v[176:179]
    v_exp_f32 v36, v36
    v_mfma_f32_16x16x32_bf16 v[180:183], a[168:171], v[72:75], v[180:183]
    v_mul_f32 v160, v123, v160
    v_mul_f32 v161, v123, v161
    v_mfma_f32_16x16x32_bf16 v[180:183], a[172:175], v[76:79], v[180:183]
    v_exp_f32 v37, v37
    s_waitcnt lgkmcnt(1)
    buffer_store_dwordx4 v[148:151], v127, s[16:19], s77 offen offset:128 sc1
    s_waitcnt lgkmcnt(0)
    buffer_store_dwordx4 v[156:159], v127, s[16:19], s77 offen offset:2176 sc1
    v_mfma_f32_16x16x32_bf16 v[184:187], a[176:179], v[72:75], v[184:187]
    v_mul_f32 v162, v123, v162
    v_mul_f32 v163, v123, v163
    v_mfma_f32_16x16x32_bf16 v[184:187], a[180:183], v[76:79], v[184:187]
    v_mul_f32 v164, v123, v164
    v_mul_f32 v165, v123, v165
    v_mfma_f32_16x16x32_bf16 v[188:191], a[184:187], v[72:75], v[188:191]
    v_exp_f32 v38, v38
    v_mfma_f32_16x16x32_bf16 v[188:191], a[188:191], v[76:79], v[188:191]
    v_mul_f32 v166, v123, v166
    v_mul_f32 v167, v123, v167
    v_mfma_f32_16x16x32_bf16 v[48:51], a[64:67], a[48:51], 0
    v_cvt_pk_bf16_f32 v160, v160, v161
    v_cvt_pk_bf16_f32 v161, v162, v163
    v_mfma_f32_16x16x32_bf16 v[48:51], a[68:71], a[52:55], v[48:51]
    ds_read_b128 a[64:67], v96 offset:32768
    v_cvt_pk_bf16_f32 v162, v164, v165
    v_mfma_f32_16x16x32_bf16 v[48:51], a[72:75], a[56:59], v[48:51]
    ds_read_b128 a[68:71], v97 offset:32768
    v_cvt_pk_bf16_f32 v163, v166, v167
    v_mfma_f32_16x16x32_bf16 v[48:51], a[76:79], a[60:63], v[48:51]
    ds_read_b128 a[72:75], v98 offset:32768
    v_cvt_pk_bf16_f32 v81, v34, v35
    v_mfma_f32_16x16x32_bf16 v[52:55], a[92:95], a[60:63], 0
    ds_read_b128 a[76:79], v99 offset:32768
    v_cvt_pk_bf16_f32 v82, v36, v37
    ds_write_b64 v125, v[160:161] offset:0
    ds_write_b64 v125, v[162:163] offset:32
    v_pk_mul_f32 v[168:169], v[168:169], v[122:123] op_sel:[0,1] op_sel_hi:[1,1]
    v_pk_mul_f32 v[170:171], v[170:171], v[122:123] op_sel:[0,1] op_sel_hi:[1,1]
    v_pk_mul_f32 v[172:173], v[172:173], v[122:123] op_sel:[0,1] op_sel_hi:[1,1]
    v_pk_mul_f32 v[174:175], v[174:175], v[122:123] op_sel:[0,1] op_sel_hi:[1,1]
    v_cvt_pk_bf16_f32 v168, v168, v169
    v_cvt_pk_bf16_f32 v169, v170, v171
    v_cvt_pk_bf16_f32 v170, v172, v173
    v_cvt_pk_bf16_f32 v171, v174, v175
    ds_write_b64 v125, v[168:169] offset:64
    ds_write_b64 v125, v[170:171] offset:96
    ds_read_b128 v[164:167], v126 offset:0
    ds_read_b128 v[172:175], v126 offset:3200
    v_pk_mul_f32 v[176:177], v[176:177], v[122:123] op_sel:[0,1] op_sel_hi:[1,1]
    v_pk_mul_f32 v[178:179], v[178:179], v[122:123] op_sel:[0,1] op_sel_hi:[1,1]
    v_pk_mul_f32 v[180:181], v[180:181], v[122:123] op_sel:[0,1] op_sel_hi:[1,1]
    v_pk_mul_f32 v[182:183], v[182:183], v[122:123] op_sel:[0,1] op_sel_hi:[1,1]
    v_cvt_pk_bf16_f32 v176, v176, v177
    v_cvt_pk_bf16_f32 v177, v178, v179
    v_cvt_pk_bf16_f32 v178, v180, v181
    v_cvt_pk_bf16_f32 v179, v182, v183
    s_waitcnt lgkmcnt(1)
    buffer_store_dwordx4 v[164:167], v127, s[16:19], s72 offen offset:0 sc1
    ds_write_b64 v125, v[176:177] offset:128
    ds_write_b64 v125, v[178:179] offset:160
    v_pk_mul_f32 v[184:185], v[184:185], v[122:123] op_sel:[0,1] op_sel_hi:[1,1]
    v_pk_mul_f32 v[186:187], v[186:187], v[122:123] op_sel:[0,1] op_sel_hi:[1,1]
    v_pk_mul_f32 v[188:189], v[188:189], v[122:123] op_sel:[0,1] op_sel_hi:[1,1]
    v_pk_mul_f32 v[190:191], v[190:191], v[122:123] op_sel:[0,1] op_sel_hi:[1,1]
    s_waitcnt lgkmcnt(2)
    buffer_store_dwordx4 v[172:175], v127, s[16:19], s72 offen offset:2048 sc1
    v_cvt_pk_bf16_f32 v184, v184, v185
    v_cvt_pk_bf16_f32 v185, v186, v187
    v_cvt_pk_bf16_f32 v186, v188, v189
    v_cvt_pk_bf16_f32 v187, v190, v191
    ds_write_b64 v125, v[184:185] offset:192
    ds_write_b64 v125, v[186:187] offset:224
    ds_read_b128 v[180:183], v126 offset:128
    ds_read_b128 v[188:191], v126 offset:3328
    v_mfma_f32_16x16x32_bf16 v[52:55], a[88:91], a[56:59], v[52:55]
    v_exp_f32 v39, v39
    v_mfma_f32_16x16x32_bf16 v[52:55], a[84:87], a[52:55], v[52:55]
    ds_read_b128 a[92:95], v99 offset:33792
    v_cvt_pk_bf16_f32 v83, v38, v39
    v_mfma_f32_16x16x32_bf16 v[52:55], a[80:83], a[48:51], v[52:55]
    ds_read_b128 a[88:91], v98 offset:33792
    ds_read_b64_tr_b16 a[128:129], v100 offset:16384
    v_mfma_f32_16x16x32_bf16 v[56:59], a[96:99], a[48:51], 0
    v_exp_f32 v40, v40
    v_mfma_f32_16x16x32_bf16 v[56:59], a[100:103], a[52:55], v[56:59]
    ds_read_b128 a[84:87], v97 offset:33792
    ds_read_b64_tr_b16 a[130:131], v100 offset:17408
    v_mfma_f32_16x16x32_bf16 v[56:59], a[104:107], a[56:59], v[56:59]
    v_exp_f32 v48, v48
    v_mfma_f32_16x16x32_bf16 v[56:59], a[108:111], a[60:63], v[56:59]
    ds_read_b128 a[80:83], v96 offset:33792
    ds_read_b64_tr_b16 a[132:133], v100 offset:18432
    v_mfma_f32_16x16x32_bf16 v[60:63], a[124:127], a[60:63], 0
    v_exp_f32 v41, v41
    s_waitcnt lgkmcnt(8)
    buffer_store_dwordx4 v[180:183], v127, s[16:19], s72 offen offset:128 sc1
    s_waitcnt lgkmcnt(7)
    buffer_store_dwordx4 v[188:191], v127, s[16:19], s72 offen offset:2176 sc1
    v_mfma_f32_16x16x32_bf16 v[60:63], a[120:123], a[56:59], v[60:63]
    ds_read_b128 a[96:99], v96 offset:34816
    v_cvt_pk_bf16_f32 v84, v40, v41
    v_mfma_f32_16x16x32_bf16 v[60:63], a[116:119], a[52:55], v[60:63]
    v_exp_f32 v49, v49
    v_mfma_f32_16x16x32_bf16 v[60:63], a[112:115], a[48:51], v[60:63]
    ds_read_b128 a[100:103], v97 offset:34816
    v_cvt_pk_bf16_f32 v88, v48, v49
    v_mfma_f32_16x16x32_bf16 v[0:3], a[64:67], a[32:35], 0
    v_exp_f32 v42, v42
    v_mfma_f32_16x16x32_bf16 v[0:3], a[68:71], a[36:39], v[0:3]
    ds_read_b128 a[104:107], v98 offset:34816
    ds_read_b64_tr_b16 a[134:135], v100 offset:19456
    v_mfma_f32_16x16x32_bf16 v[0:3], a[72:75], a[40:43], v[0:3]
    v_exp_f32 v50, v50
    v_mfma_f32_16x16x32_bf16 v[0:3], a[76:79], a[44:47], v[0:3]
    s_waitcnt lgkmcnt(4)
    ds_read_b128 a[108:111], v99 offset:34816
    ds_read_b64_tr_b16 a[136:137], v101 offset:16384
    v_mfma_f32_16x16x32_bf16 v[4:7], a[92:95], a[44:47], 0
    ds_read_b128 a[124:127], v99 offset:35840
    v_exp_f32 v43, v43
    v_mfma_f32_16x16x32_bf16 v[4:7], a[88:91], a[40:43], v[4:7]
    ds_read_b128 a[120:123], v98 offset:35840
    v_exp_f32 v51, v51
    v_mfma_f32_16x16x32_bf16 v[4:7], a[84:87], a[36:39], v[4:7]
    ds_read_b128 a[116:119], v97 offset:35840
    v_exp_f32 v44, v44
    v_mfma_f32_16x16x32_bf16 v[4:7], a[80:83], a[32:35], v[4:7]
    s_waitcnt lgkmcnt(7)
    ds_read_b128 a[112:115], v96 offset:35840
    v_exp_f32 v52, v52
    v_mfma_f32_16x16x32_bf16 v[8:11], a[96:99], a[32:35], 0
    v_exp_f32 v45, v45
    v_mfma_f32_16x16x32_bf16 v[8:11], a[100:103], a[36:39], v[8:11]
    s_waitcnt lgkmcnt(6)
    v_exp_f32 v53, v53
    v_mfma_f32_16x16x32_bf16 v[8:11], a[104:107], a[40:43], v[8:11]
    s_waitcnt lgkmcnt(5)
    ds_read_b64_tr_b16 a[138:139], v101 offset:17408
    ds_read_b64_tr_b16 a[140:141], v101 offset:18432
    v_exp_f32 v46, v46
    v_mfma_f32_16x16x32_bf16 v[8:11], a[108:111], a[44:47], v[8:11]
    s_waitcnt lgkmcnt(5)
    ds_read_b64_tr_b16 a[142:143], v101 offset:19456
    ds_read_b64_tr_b16 a[144:145], v102 offset:16384
    v_cvt_pk_bf16_f32 v85, v42, v43
    v_exp_f32 v54, v54
    v_mfma_f32_16x16x32_bf16 v[12:15], a[124:127], a[44:47], 0
    s_waitcnt lgkmcnt(6)
    ds_read_b64_tr_b16 a[146:147], v102 offset:17408
    ds_read_b64_tr_b16 a[148:149], v102 offset:18432
    v_exp_f32 v47, v47
    v_cvt_pk_bf16_f32 v86, v44, v45
    v_mfma_f32_16x16x32_bf16 v[12:15], a[120:123], a[40:43], v[12:15]
    s_waitcnt lgkmcnt(7)
    ds_read_b64_tr_b16 a[150:151], v102 offset:19456
    ds_read_b64_tr_b16 a[152:153], v103 offset:16384
    v_cvt_pk_bf16_f32 v87, v46, v47
    v_exp_f32 v55, v55
    v_mfma_f32_16x16x32_bf16 v[12:15], a[116:119], a[36:39], v[12:15]
    s_waitcnt lgkmcnt(8)
    ds_read_b64_tr_b16 a[154:155], v103 offset:17408
    ds_read_b64_tr_b16 a[156:157], v103 offset:18432
    v_mfma_f32_16x16x32_bf16 v[12:15], a[112:115], a[32:35], v[12:15]
    ds_read_b64_tr_b16 a[158:159], v103 offset:19456
    ds_read_b64_tr_b16 a[160:161], v104 offset:16384
    v_exp_f32 v56, v56
    v_mfma_f32_16x16x32_bf16 v[192:195], a[128:131], v[80:83], v[192:195]
    ds_read_b64_tr_b16 a[162:163], v104 offset:17408
    ds_read_b64_tr_b16 a[164:165], v104 offset:18432
    v_mfma_f32_16x16x32_bf16 v[192:195], a[132:135], v[84:87], v[192:195]
    s_waitcnt lgkmcnt(13)
    ds_read_b64_tr_b16 a[166:167], v104 offset:19456
    ds_read_b64_tr_b16 a[168:169], v105 offset:16384
    v_exp_f32 v57, v57
    v_mfma_f32_16x16x32_bf16 v[196:199], a[136:139], v[80:83], v[196:199]
    s_waitcnt lgkmcnt(13)
    ds_read_b64_tr_b16 a[170:171], v105 offset:17408
    ds_read_b64_tr_b16 a[172:173], v105 offset:18432
    v_mfma_f32_16x16x32_bf16 v[196:199], a[140:143], v[84:87], v[196:199]
    s_waitcnt lgkmcnt(13)
    ds_read_b64_tr_b16 a[174:175], v105 offset:19456
    ds_read_b64_tr_b16 a[176:177], v106 offset:16384
    v_exp_f32 v58, v58
    v_mfma_f32_16x16x32_bf16 v[200:203], a[144:147], v[80:83], v[200:203]
    s_waitcnt lgkmcnt(13)
    ds_read_b64_tr_b16 a[178:179], v106 offset:17408
    ds_read_b64_tr_b16 a[180:181], v106 offset:18432
    v_mfma_f32_16x16x32_bf16 v[200:203], a[148:151], v[84:87], v[200:203]
    s_waitcnt lgkmcnt(13)
    ds_read_b64_tr_b16 a[182:183], v106 offset:19456
    ds_read_b64_tr_b16 a[184:185], v107 offset:16384
    v_exp_f32 v59, v59
    v_mfma_f32_16x16x32_bf16 v[204:207], a[152:155], v[80:83], v[204:207]
    s_waitcnt lgkmcnt(13)
    ds_read_b64_tr_b16 a[186:187], v107 offset:17408
    ds_read_b64_tr_b16 a[188:189], v107 offset:18432
    v_mfma_f32_16x16x32_bf16 v[204:207], a[156:159], v[84:87], v[204:207]
    s_waitcnt lgkmcnt(13)
    ds_read_b64_tr_b16 a[190:191], v107 offset:19456
    v_exp_f32 v60, v60
    v_mfma_f32_16x16x32_bf16 v[208:211], a[160:163], v[80:83], v[208:211]
    s_waitcnt lgkmcnt(12)
    v_cvt_pk_bf16_f32 v89, v50, v51
    v_cvt_pk_bf16_f32 v90, v52, v53
    v_mfma_f32_16x16x32_bf16 v[208:211], a[164:167], v[84:87], v[208:211]
    s_waitcnt lgkmcnt(10)
    v_exp_f32 v61, v61
    v_mfma_f32_16x16x32_bf16 v[212:215], a[168:171], v[80:83], v[212:215]
    s_waitcnt lgkmcnt(8)
    v_cvt_pk_bf16_f32 v91, v54, v55
    v_cvt_pk_bf16_f32 v92, v56, v57
    v_mfma_f32_16x16x32_bf16 v[212:215], a[172:175], v[84:87], v[212:215]
    s_waitcnt lgkmcnt(6)
    v_exp_f32 v62, v62
    v_mfma_f32_16x16x32_bf16 v[216:219], a[176:179], v[80:83], v[216:219]
    s_waitcnt lgkmcnt(4)
    v_cvt_pk_bf16_f32 v93, v58, v59
    v_cvt_pk_bf16_f32 v94, v60, v61
    v_mfma_f32_16x16x32_bf16 v[216:219], a[180:183], v[84:87], v[216:219]
    s_waitcnt lgkmcnt(2)
    v_exp_f32 v63, v63
    v_mfma_f32_16x16x32_bf16 v[220:223], a[184:187], v[80:83], v[220:223]
    s_waitcnt lgkmcnt(0)
    v_cvt_pk_bf16_f32 v95, v62, v63
    v_mfma_f32_16x16x32_bf16 v[220:223], a[188:191], v[84:87], v[220:223]
    v_exp_f32 v0, v0
    v_smfmac_f32_16x16x64_bf16 a[200:203], a[208:211], v[80:87], v114
    v_exp_f32 v1, v1
    v_mfma_f32_16x16x32_bf16 v[224:227], a[128:131], v[88:91], v[224:227]
    v_exp_f32 v2, v2
    v_mfma_f32_16x16x32_bf16 v[224:227], a[132:135], v[92:95], v[224:227]
    v_exp_f32 v3, v3
    v_mfma_f32_16x16x32_bf16 v[228:231], a[136:139], v[88:91], v[228:231]
    v_exp_f32 v4, v4
    v_mfma_f32_16x16x32_bf16 v[228:231], a[140:143], v[92:95], v[228:231]
    v_exp_f32 v5, v5
    v_mfma_f32_16x16x32_bf16 v[232:235], a[144:147], v[88:91], v[232:235]
    v_exp_f32 v6, v6
    v_mfma_f32_16x16x32_bf16 v[232:235], a[148:151], v[92:95], v[232:235]
    v_exp_f32 v7, v7
    v_mfma_f32_16x16x32_bf16 v[236:239], a[152:155], v[88:91], v[236:239]
    v_exp_f32 v8, v8
    v_mfma_f32_16x16x32_bf16 v[236:239], a[156:159], v[92:95], v[236:239]
    v_exp_f32 v9, v9
    v_mfma_f32_16x16x32_bf16 v[240:243], a[160:163], v[88:91], v[240:243]
    v_exp_f32 v10, v10
    v_mfma_f32_16x16x32_bf16 v[240:243], a[164:167], v[92:95], v[240:243]
    v_exp_f32 v11, v11
    v_mfma_f32_16x16x32_bf16 v[244:247], a[168:171], v[88:91], v[244:247]
    v_exp_f32 v12, v12
    v_mfma_f32_16x16x32_bf16 v[244:247], a[172:175], v[92:95], v[244:247]
    v_cvt_pk_bf16_f32 v64, v0, v1
    v_cvt_pk_bf16_f32 v65, v2, v3
    v_mfma_f32_16x16x32_bf16 v[248:251], a[176:179], v[88:91], v[248:251]
    ds_read_b64_tr_b16 a[128:129], v100 offset:32768
    v_cvt_pk_bf16_f32 v66, v4, v5
    v_mfma_f32_16x16x32_bf16 v[248:251], a[180:183], v[92:95], v[248:251]
    v_exp_f32 v13, v13
    v_mfma_f32_16x16x32_bf16 v[252:255], a[184:187], v[88:91], v[252:255]
    ds_read_b64_tr_b16 a[130:131], v100 offset:33792
    v_cvt_pk_bf16_f32 v67, v6, v7
    v_mfma_f32_16x16x32_bf16 v[252:255], a[188:191], v[92:95], v[252:255]
    ds_read_b64_tr_b16 a[132:133], v100 offset:34816
    v_cvt_pk_bf16_f32 v68, v8, v9
    v_smfmac_f32_16x16x64_bf16 a[204:207], a[208:211], v[88:95], v114
    ds_read_b64_tr_b16 a[134:135], v100 offset:35840
    v_cvt_pk_bf16_f32 v69, v10, v11
    v_mfma_f32_16x16x32_bf16 v[16:19], a[64:67], a[48:51], 0
    ds_read_b64_tr_b16 a[136:137], v101 offset:32768
    v_cvt_pk_bf16_f32 v70, v12, v13
    v_mfma_f32_16x16x32_bf16 v[16:19], a[68:71], a[52:55], v[16:19]
    v_exp_f32 v14, v14
    v_mfma_f32_16x16x32_bf16 v[16:19], a[72:75], a[56:59], v[16:19]
    ds_read_b64_tr_b16 a[138:139], v101 offset:33792
    ds_read_b64_tr_b16 a[140:141], v101 offset:34816
    v_mfma_f32_16x16x32_bf16 v[16:19], a[76:79], a[60:63], v[16:19]
    ds_read_b64_tr_b16 a[142:143], v101 offset:35840
    v_mov_b32 v86, 0
    v_mfma_f32_16x16x32_bf16 v[20:23], a[92:95], a[60:63], 0
    ds_read_b64_tr_b16 a[144:145], v102 offset:32768
    ds_read_b64_tr_b16 a[146:147], v102 offset:33792
    v_mfma_f32_16x16x32_bf16 v[20:23], a[88:91], a[56:59], v[20:23]
    v_exp_f32 v15, v15
    v_mfma_f32_16x16x32_bf16 v[20:23], a[84:87], a[52:55], v[20:23]
    ds_read_b64_tr_b16 a[148:149], v102 offset:34816
    v_cvt_pk_bf16_f32 v71, v14, v15
    v_mfma_f32_16x16x32_bf16 v[20:23], a[80:83], a[48:51], v[20:23]
    ds_read_b64_tr_b16 a[150:151], v102 offset:35840
    ds_read_b64_tr_b16 a[152:153], v103 offset:32768
    v_mfma_f32_16x16x32_bf16 v[24:27], a[96:99], a[48:51], 0
    v_exp_f32 v16, v16
    v_mfma_f32_16x16x32_bf16 v[24:27], a[100:103], a[52:55], v[24:27]
    v_exp_f32 v17, v17
    v_mfma_f32_16x16x32_bf16 v[24:27], a[104:107], a[56:59], v[24:27]
    ds_read_b64_tr_b16 a[154:155], v103 offset:33792
    ds_read_b64_tr_b16 a[156:157], v103 offset:34816
    v_mfma_f32_16x16x32_bf16 v[24:27], a[108:111], a[60:63], v[24:27]
    v_exp_f32 v18, v18
    v_mfma_f32_16x16x32_bf16 v[28:31], a[124:127], a[60:63], 0
    ds_read_b64_tr_b16 a[158:159], v103 offset:35840
    ds_read_b64_tr_b16 a[160:161], v104 offset:32768
    v_mfma_f32_16x16x32_bf16 v[28:31], a[120:123], a[56:59], v[28:31]
    ds_read_b64_tr_b16 a[162:163], v104 offset:33792
    v_cvt_pk_bf16_f32 v72, v16, v17
    v_mfma_f32_16x16x32_bf16 v[28:31], a[116:119], a[52:55], v[28:31]
    ds_read_b64_tr_b16 a[164:165], v104 offset:34816
    ds_read_b64_tr_b16 a[166:167], v104 offset:35840
    v_mfma_f32_16x16x32_bf16 v[28:31], a[112:115], a[48:51], v[28:31]
    s_waitcnt lgkmcnt(7)
    v_exp_f32 v19, v19
    v_mfma_f32_16x16x32_bf16 v[192:195], a[128:131], v[64:67], v[192:195]
    ds_read_b64_tr_b16 a[168:169], v105 offset:32768
    ds_read_b64_tr_b16 a[170:171], v105 offset:33792
    v_mfma_f32_16x16x32_bf16 v[192:195], a[132:135], v[68:71], v[192:195]
    ds_read_b64_tr_b16 a[172:173], v105 offset:34816
    ds_read_b64_tr_b16 a[174:175], v105 offset:35840
    v_mfma_f32_16x16x32_bf16 v[196:199], a[136:139], v[64:67], v[196:199]
    v_exp_f32 v20, v20
    v_mfma_f32_16x16x32_bf16 v[196:199], a[140:143], v[68:71], v[196:199]
    ds_read_b64_tr_b16 a[176:177], v106 offset:32768
    ds_read_b64_tr_b16 a[178:179], v106 offset:33792
    v_mfma_f32_16x16x32_bf16 v[200:203], a[144:147], v[64:67], v[200:203]
    ds_read_b64_tr_b16 a[180:181], v106 offset:34816
    ds_read_b64_tr_b16 a[182:183], v106 offset:35840
    v_mfma_f32_16x16x32_bf16 v[200:203], a[148:151], v[68:71], v[200:203]
    s_waitcnt lgkmcnt(10)
    ds_read_b64_tr_b16 a[184:185], v107 offset:32768
    v_exp_f32 v21, v21
    v_mfma_f32_16x16x32_bf16 v[204:207], a[152:155], v[64:67], v[204:207]
    ds_read_b64_tr_b16 a[186:187], v107 offset:33792
    ds_read_b64_tr_b16 a[188:189], v107 offset:34816
    v_mfma_f32_16x16x32_bf16 v[204:207], a[156:159], v[68:71], v[204:207]
    ds_read_b64_tr_b16 a[190:191], v107 offset:35840
    v_exp_f32 v22, v22
    v_mfma_f32_16x16x32_bf16 v[208:211], a[160:163], v[64:67], v[208:211]
    s_waitcnt lgkmcnt(10)
    v_exp_f32 v23, v23
    v_mfma_f32_16x16x32_bf16 v[208:211], a[164:167], v[68:71], v[208:211]
    ds_read_b128 a[64:67], v96 offset:49152
    v_cvt_pk_bf16_f32 v73, v18, v19
    v_mfma_f32_16x16x32_bf16 v[212:215], a[168:171], v[64:67], v[212:215]
    s_waitcnt lgkmcnt(9)
    ds_read_b128 a[68:71], v97 offset:49152
    v_cvt_pk_bf16_f32 v74, v20, v21
    v_mfma_f32_16x16x32_bf16 v[212:215], a[172:175], v[68:71], v[212:215]
    s_waitcnt lgkmcnt(8)
    ds_read_b128 a[72:75], v98 offset:49152
    v_exp_f32 v24, v24
    v_mfma_f32_16x16x32_bf16 v[216:219], a[176:179], v[64:67], v[216:219]
    s_waitcnt lgkmcnt(7)
    ds_read_b128 a[76:79], v99 offset:49152
    v_cvt_pk_bf16_f32 v75, v22, v23
    v_mfma_f32_16x16x32_bf16 v[216:219], a[180:183], v[68:71], v[216:219]
    s_waitcnt lgkmcnt(6)
    ds_read_b128 a[92:95], v99 offset:50176
    v_exp_f32 v25, v25
    v_mfma_f32_16x16x32_bf16 v[220:223], a[184:187], v[64:67], v[220:223]
    s_waitcnt lgkmcnt(5)
    ds_read_b128 a[88:91], v98 offset:50176
    v_cvt_pk_bf16_f32 v76, v24, v25
    v_mfma_f32_16x16x32_bf16 v[220:223], a[188:191], v[68:71], v[220:223]
    ds_read_b128 a[84:87], v97 offset:50176
    v_exp_f32 v26, v26
    v_smfmac_f32_16x16x64_bf16 a[200:203], a[208:211], v[64:71], v114
    s_waitcnt lgkmcnt(6)
    ds_read_b128 a[80:83], v96 offset:50176
    v_mov_b32 v87, 0
    v_mfma_f32_16x16x32_bf16 v[32:35], a[64:67], a[32:35], 0
    s_waitcnt lgkmcnt(6)
    ds_read_b128 a[96:99], v96 offset:51200
    v_exp_f32 v27, v27
    v_mfma_f32_16x16x32_bf16 v[32:35], a[68:71], a[36:39], v[32:35]
    s_waitcnt lgkmcnt(6)
    ds_read_b128 a[100:103], v97 offset:51200
    v_cvt_pk_bf16_f32 v77, v26, v27
    v_mfma_f32_16x16x32_bf16 v[32:35], a[72:75], a[40:43], v[32:35]
    s_waitcnt lgkmcnt(6)
    ds_read_b128 a[104:107], v98 offset:51200
    v_exp_f32 v28, v28
    v_mfma_f32_16x16x32_bf16 v[32:35], a[76:79], a[44:47], v[32:35]
    s_waitcnt lgkmcnt(6)
    ds_read_b128 a[108:111], v99 offset:51200
    v_mov_b32 v94, 0
    v_mfma_f32_16x16x32_bf16 v[36:39], a[92:95], a[44:47], 0
    s_waitcnt lgkmcnt(6)
    v_exp_f32 v29, v29
    v_mfma_f32_16x16x32_bf16 v[36:39], a[88:91], a[40:43], v[36:39]
    s_waitcnt lgkmcnt(5)
    v_exp_f32 v30, v30
    v_mfma_f32_16x16x32_bf16 v[36:39], a[84:87], a[36:39], v[36:39]
    s_waitcnt lgkmcnt(4)
    v_exp_f32 v31, v31
    v_mfma_f32_16x16x32_bf16 v[36:39], a[80:83], a[32:35], v[36:39]
    s_waitcnt lgkmcnt(3)
    v_cvt_pk_bf16_f32 v78, v28, v29
    v_cvt_pk_bf16_f32 v79, v30, v31
    v_mfma_f32_16x16x32_bf16 v[40:43], a[96:99], a[32:35], v[116:119]
    s_waitcnt lgkmcnt(2)
    v_exp_f32 v32, v32
    v_mfma_f32_16x16x32_bf16 v[40:43], a[100:103], a[36:39], v[40:43]
    s_waitcnt lgkmcnt(1)
    v_exp_f32 v33, v33
    v_mfma_f32_16x16x32_bf16 v[40:43], a[104:107], a[40:43], v[40:43]
    s_waitcnt lgkmcnt(0)
    v_exp_f32 v34, v34
    v_mfma_f32_16x16x32_bf16 v[40:43], a[108:111], a[44:47], v[40:43]
    v_exp_f32 v35, v35
    v_mfma_f32_16x16x32_bf16 v[224:227], a[128:131], v[72:75], v[224:227]
    v_exp_f32 v36, v36
    v_mfma_f32_16x16x32_bf16 v[224:227], a[132:135], v[76:79], v[224:227]
    v_exp_f32 v37, v37
    v_mfma_f32_16x16x32_bf16 v[228:231], a[136:139], v[72:75], v[228:231]
    v_exp_f32 v38, v38
    v_mfma_f32_16x16x32_bf16 v[228:231], a[140:143], v[76:79], v[228:231]
    v_exp_f32 v39, v39
    v_mfma_f32_16x16x32_bf16 v[232:235], a[144:147], v[72:75], v[232:235]
    v_exp_f32 v40, v40
    v_mfma_f32_16x16x32_bf16 v[232:235], a[148:151], v[76:79], v[232:235]
    v_exp_f32 v41, v41
    v_mfma_f32_16x16x32_bf16 v[236:239], a[152:155], v[72:75], v[236:239]
    ds_read_b64_tr_b16 a[128:129], v100 offset:49152
    v_cvt_pk_bf16_f32 v80, v32, v33
    v_mfma_f32_16x16x32_bf16 v[236:239], a[156:159], v[76:79], v[236:239]
    ds_read_b64_tr_b16 a[130:131], v100 offset:50176
    v_cvt_pk_bf16_f32 v81, v34, v35
    v_mfma_f32_16x16x32_bf16 v[240:243], a[160:163], v[72:75], v[240:243]
    ds_read_b64_tr_b16 a[132:133], v100 offset:51200
    v_cvt_pk_bf16_f32 v82, v36, v37
    v_mfma_f32_16x16x32_bf16 v[240:243], a[164:167], v[76:79], v[240:243]
    v_exp_f32 v42, v42
    v_mfma_f32_16x16x32_bf16 v[244:247], a[168:171], v[72:75], v[244:247]
    ds_read_b64_tr_b16 a[134:135], v100 offset:52224
    v_cvt_pk_bf16_f32 v83, v38, v39
    v_mfma_f32_16x16x32_bf16 v[244:247], a[172:175], v[76:79], v[244:247]
    ds_read_b64_tr_b16 a[136:137], v101 offset:49152
    v_cvt_pk_bf16_f32 v84, v40, v41
    v_mfma_f32_16x16x32_bf16 v[248:251], a[176:179], v[72:75], v[248:251]
    ds_read_b64_tr_b16 a[138:139], v101 offset:50176
    v_mov_b32 v95, 0
    v_mfma_f32_16x16x32_bf16 v[248:251], a[180:183], v[76:79], v[248:251]
    ds_read_b64_tr_b16 a[140:141], v101 offset:51200
    ds_read_b64_tr_b16 a[142:143], v101 offset:52224
    v_mfma_f32_16x16x32_bf16 v[252:255], a[184:187], v[72:75], v[252:255]
    v_exp_f32 v43, v43
    v_mfma_f32_16x16x32_bf16 v[252:255], a[188:191], v[76:79], v[252:255]
    ds_read_b64_tr_b16 a[144:145], v102 offset:49152
    v_cvt_pk_bf16_f32 v85, v42, v43
    v_smfmac_f32_16x16x64_bf16 a[204:207], a[208:211], v[72:79], v114
    ds_read_b64_tr_b16 a[146:147], v102 offset:50176
    ds_read_b64_tr_b16 a[148:149], v102 offset:51200
    v_mfma_f32_16x16x32_bf16 v[48:51], a[64:67], a[48:51], 0
    ds_read_b64_tr_b16 a[150:151], v102 offset:52224
    v_mfma_f32_16x16x32_bf16 v[48:51], a[68:71], a[52:55], v[48:51]
    ds_read_b64_tr_b16 a[152:153], v103 offset:49152
    ds_read_b64_tr_b16 a[154:155], v103 offset:50176
    v_mfma_f32_16x16x32_bf16 v[48:51], a[72:75], a[56:59], v[48:51]
    ds_read_b64_tr_b16 a[156:157], v103 offset:51200
    v_mfma_f32_16x16x32_bf16 v[48:51], a[76:79], a[60:63], v[48:51]
    ds_read_b64_tr_b16 a[158:159], v103 offset:52224
    ds_read_b64_tr_b16 a[160:161], v104 offset:49152
    v_mfma_f32_16x16x32_bf16 v[52:55], a[92:95], a[60:63], 0
    ds_read_b64_tr_b16 a[162:163], v104 offset:50176
    v_mfma_f32_16x16x32_bf16 v[52:55], a[88:91], a[56:59], v[52:55]
    ds_read_b64_tr_b16 a[164:165], v104 offset:51200
    ds_read_b64_tr_b16 a[166:167], v104 offset:52224
    v_mfma_f32_16x16x32_bf16 v[52:55], a[84:87], a[52:55], v[52:55]
    ds_read_b64_tr_b16 a[168:169], v105 offset:49152
    v_mfma_f32_16x16x32_bf16 v[52:55], a[80:83], a[48:51], v[52:55]
    ds_read_b64_tr_b16 a[170:171], v105 offset:50176
    ds_read_b64_tr_b16 a[172:173], v105 offset:51200
    v_mfma_f32_16x16x32_bf16 v[56:59], a[96:99], a[48:51], v[116:119]
    v_exp_f32 v48, v48
    v_mfma_f32_16x16x32_bf16 v[56:59], a[100:103], a[52:55], v[56:59]
    v_exp_f32 v49, v49
    v_mfma_f32_16x16x32_bf16 v[56:59], a[104:107], a[56:59], v[56:59]
    v_exp_f32 v50, v50
    v_mfma_f32_16x16x32_bf16 v[56:59], a[108:111], a[60:63], v[56:59]
    v_exp_f32 v51, v51
    v_smfmac_f32_16x16x64_bf16 a[200:203], a[208:211], v[80:87], v114
    s_waitcnt lgkmcnt(5)
    v_exp_f32 v52, v52
    v_mfma_f32_16x16x32_bf16 v[192:195], a[128:131], v[80:83], v[192:195]
    v_exp_f32 v53, v53
    v_mfma_f32_16x16x32_bf16 v[192:195], a[132:135], v[84:87], v[192:195]
    v_exp_f32 v54, v54
    v_mfma_f32_16x16x32_bf16 v[196:199], a[136:139], v[80:83], v[196:199]
    ds_read_b64_tr_b16 a[174:175], v105 offset:52224
    ds_read_b64_tr_b16 a[176:177], v106 offset:49152
    v_mfma_f32_16x16x32_bf16 v[196:199], a[140:143], v[84:87], v[196:199]
    v_exp_f32 v55, v55
    v_mfma_f32_16x16x32_bf16 v[200:203], a[144:147], v[80:83], v[200:203]
    ds_read_b64_tr_b16 a[178:179], v106 offset:50176
    ds_read_b64_tr_b16 a[180:181], v106 offset:51200
    v_mfma_f32_16x16x32_bf16 v[200:203], a[148:151], v[84:87], v[200:203]
    ds_read_b64_tr_b16 a[182:183], v106 offset:52224
    ds_read_b64_tr_b16 a[184:185], v107 offset:49152
    v_mfma_f32_16x16x32_bf16 v[204:207], a[152:155], v[80:83], v[204:207]
    ds_read_b64_tr_b16 a[186:187], v107 offset:50176
    ds_read_b64_tr_b16 a[188:189], v107 offset:51200
    v_exp_f32 v56, v56
    v_mfma_f32_16x16x32_bf16 v[204:207], a[156:159], v[84:87], v[204:207]
    ds_read_b64_tr_b16 a[190:191], v107 offset:52224
    v_cvt_pk_bf16_f32 v88, v48, v49
    v_mfma_f32_16x16x32_bf16 v[208:211], a[160:163], v[80:83], v[208:211]
    s_waitcnt lgkmcnt(9)
    v_exp_f32 v57, v57
    v_mfma_f32_16x16x32_bf16 v[208:211], a[164:167], v[84:87], v[208:211]
    v_cvt_pk_bf16_f32 v89, v50, v51
    v_cvt_pk_bf16_f32 v90, v52, v53
    v_mfma_f32_16x16x32_bf16 v[212:215], a[168:171], v[80:83], v[212:215]
    s_waitcnt lgkmcnt(7)
    v_exp_f32 v58, v58
    v_mfma_f32_16x16x32_bf16 v[212:215], a[172:175], v[84:87], v[212:215]
    s_waitcnt lgkmcnt(6)
    v_cvt_pk_bf16_f32 v91, v54, v55
    v_cvt_pk_bf16_f32 v92, v56, v57
    v_mfma_f32_16x16x32_bf16 v[216:219], a[176:179], v[80:83], v[216:219]
    s_waitcnt lgkmcnt(4)
    v_exp_f32 v59, v59
    v_mfma_f32_16x16x32_bf16 v[216:219], a[180:183], v[84:87], v[216:219]
    s_waitcnt lgkmcnt(2)
    v_cvt_pk_bf16_f32 v93, v58, v59
    v_accvgpr_read_b32 v120, a200
    v_mfma_f32_16x16x32_bf16 v[220:223], a[184:187], v[80:83], v[220:223]
    s_waitcnt lgkmcnt(0)
    v_accvgpr_read_b32 v121, a201
    v_add_f32 v120, v120, v121
    v_mfma_f32_16x16x32_bf16 v[220:223], a[188:191], v[84:87], v[220:223]
    v_rcp_f32 v121, v120
    v_smfmac_f32_16x16x64_bf16 a[204:207], a[208:211], v[88:95], v114
    v_subrev_u32 v120, 0x2b800000, v120
    v_max_u32 v124, v124, v120
    v_mfma_f32_16x16x32_bf16 v[224:227], a[128:131], v[88:91], v[224:227]
    v_mul_f32 v192, v121, v192
    v_mul_f32 v193, v121, v193
    v_mfma_f32_16x16x32_bf16 v[224:227], a[132:135], v[92:95], v[224:227]
    v_mul_f32 v194, v121, v194
    v_mul_f32 v195, v121, v195
    v_mfma_f32_16x16x32_bf16 v[228:231], a[136:139], v[88:91], v[228:231]
    v_mul_f32 v196, v121, v196
    v_mul_f32 v197, v121, v197
    v_mfma_f32_16x16x32_bf16 v[228:231], a[140:143], v[92:95], v[228:231]
    v_mul_f32 v198, v121, v198
    v_mul_f32 v199, v121, v199
    v_cvt_pk_bf16_f32 v192, v192, v193
    v_cvt_pk_bf16_f32 v193, v194, v195
    v_cvt_pk_bf16_f32 v194, v196, v197
    v_cvt_pk_bf16_f32 v195, v198, v199
    ds_write_b64 v125, v[192:193] offset:0
    ds_write_b64 v125, v[194:195] offset:32
    v_pk_mul_f32 v[200:201], v[200:201], v[120:121] op_sel:[0,1] op_sel_hi:[1,1]
    v_pk_mul_f32 v[202:203], v[202:203], v[120:121] op_sel:[0,1] op_sel_hi:[1,1]
    v_pk_mul_f32 v[204:205], v[204:205], v[120:121] op_sel:[0,1] op_sel_hi:[1,1]
    v_pk_mul_f32 v[206:207], v[206:207], v[120:121] op_sel:[0,1] op_sel_hi:[1,1]
    v_cvt_pk_bf16_f32 v200, v200, v201
    v_cvt_pk_bf16_f32 v201, v202, v203
    v_cvt_pk_bf16_f32 v202, v204, v205
    v_cvt_pk_bf16_f32 v203, v206, v207
    ds_write_b64 v125, v[200:201] offset:64
    ds_write_b64 v125, v[202:203] offset:96
    ds_read_b128 v[196:199], v126 offset:0
    ds_read_b128 v[204:207], v126 offset:3200
    v_pk_mul_f32 v[208:209], v[208:209], v[120:121] op_sel:[0,1] op_sel_hi:[1,1]
    v_pk_mul_f32 v[210:211], v[210:211], v[120:121] op_sel:[0,1] op_sel_hi:[1,1]
    v_pk_mul_f32 v[212:213], v[212:213], v[120:121] op_sel:[0,1] op_sel_hi:[1,1]
    v_pk_mul_f32 v[214:215], v[214:215], v[120:121] op_sel:[0,1] op_sel_hi:[1,1]
    v_cvt_pk_bf16_f32 v208, v208, v209
    v_cvt_pk_bf16_f32 v209, v210, v211
    v_cvt_pk_bf16_f32 v210, v212, v213
    v_cvt_pk_bf16_f32 v211, v214, v215
    s_waitcnt lgkmcnt(1)
    buffer_store_dwordx4 v[196:199], v127, s[16:19], s73 offen offset:0 sc1
    ds_write_b64 v125, v[208:209] offset:128
    ds_write_b64 v125, v[210:211] offset:160
    v_pk_mul_f32 v[216:217], v[216:217], v[120:121] op_sel:[0,1] op_sel_hi:[1,1]
    v_pk_mul_f32 v[218:219], v[218:219], v[120:121] op_sel:[0,1] op_sel_hi:[1,1]
    v_pk_mul_f32 v[220:221], v[220:221], v[120:121] op_sel:[0,1] op_sel_hi:[1,1]
    v_pk_mul_f32 v[222:223], v[222:223], v[120:121] op_sel:[0,1] op_sel_hi:[1,1]
    s_waitcnt lgkmcnt(2)
    buffer_store_dwordx4 v[204:207], v127, s[16:19], s73 offen offset:2048 sc1
    v_cvt_pk_bf16_f32 v216, v216, v217
    v_cvt_pk_bf16_f32 v217, v218, v219
    v_cvt_pk_bf16_f32 v218, v220, v221
    v_cvt_pk_bf16_f32 v219, v222, v223
    ds_write_b64 v125, v[216:217] offset:192
    ds_write_b64 v125, v[218:219] offset:224
    ds_read_b128 v[212:215], v126 offset:128
    ds_read_b128 v[220:223], v126 offset:3328
    v_mfma_f32_16x16x32_bf16 v[232:235], a[144:147], v[88:91], v[232:235]
    v_accvgpr_read_b32 v122, a204
    v_accvgpr_read_b32 v123, a205
    v_mfma_f32_16x16x32_bf16 v[232:235], a[148:151], v[92:95], v[232:235]
    v_add_f32 v122, v122, v123
    v_mfma_f32_16x16x32_bf16 v[236:239], a[152:155], v[88:91], v[236:239]
    v_rcp_f32 v123, v122
    v_mfma_f32_16x16x32_bf16 v[236:239], a[156:159], v[92:95], v[236:239]
    v_subrev_u32 v122, 0x2b800000, v122
    v_max_u32 v124, v124, v122
    v_mfma_f32_16x16x32_bf16 v[240:243], a[160:163], v[88:91], v[240:243]
    v_mul_f32 v224, v123, v224
    v_mul_f32 v225, v123, v225
    v_mfma_f32_16x16x32_bf16 v[240:243], a[164:167], v[92:95], v[240:243]
    v_mul_f32 v226, v123, v226
    v_mul_f32 v227, v123, v227
    v_mfma_f32_16x16x32_bf16 v[244:247], a[168:171], v[88:91], v[244:247]
    v_mul_f32 v228, v123, v228
    v_mul_f32 v229, v123, v229
    v_mfma_f32_16x16x32_bf16 v[244:247], a[172:175], v[92:95], v[244:247]
    v_mul_f32 v230, v123, v230
    v_mul_f32 v231, v123, v231
    s_waitcnt lgkmcnt(1)
    buffer_store_dwordx4 v[212:215], v127, s[16:19], s73 offen offset:128 sc1
    s_waitcnt lgkmcnt(0)
    buffer_store_dwordx4 v[220:223], v127, s[16:19], s73 offen offset:2176 sc1
    v_mfma_f32_16x16x32_bf16 v[248:251], a[176:179], v[88:91], v[248:251]
    v_cvt_pk_bf16_f32 v224, v224, v225
    v_cvt_pk_bf16_f32 v225, v226, v227
    v_mfma_f32_16x16x32_bf16 v[248:251], a[180:183], v[92:95], v[248:251]
    v_cvt_pk_bf16_f32 v226, v228, v229
    v_cvt_pk_bf16_f32 v227, v230, v231
    v_mfma_f32_16x16x32_bf16 v[252:255], a[184:187], v[88:91], v[252:255]
    ds_write_b64 v125, v[224:225] offset:0
    ds_write_b64 v125, v[226:227] offset:32
    v_mfma_f32_16x16x32_bf16 v[252:255], a[188:191], v[92:95], v[252:255]
    v_mul_f32 v232, v123, v232
    v_mul_f32 v233, v123, v233
    v_pk_mul_f32 v[234:235], v[234:235], v[122:123] op_sel:[0,1] op_sel_hi:[1,1]
    v_pk_mul_f32 v[236:237], v[236:237], v[122:123] op_sel:[0,1] op_sel_hi:[1,1]
    v_pk_mul_f32 v[238:239], v[238:239], v[122:123] op_sel:[0,1] op_sel_hi:[1,1]
    v_cvt_pk_bf16_f32 v232, v232, v233
    v_cvt_pk_bf16_f32 v233, v234, v235
    v_cvt_pk_bf16_f32 v234, v236, v237
    v_cvt_pk_bf16_f32 v235, v238, v239
    ds_write_b64 v125, v[232:233] offset:64
    ds_write_b64 v125, v[234:235] offset:96
    ds_read_b128 v[228:231], v126 offset:0
    ds_read_b128 v[236:239], v126 offset:3200
    v_pk_mul_f32 v[240:241], v[240:241], v[122:123] op_sel:[0,1] op_sel_hi:[1,1]
    v_pk_mul_f32 v[242:243], v[242:243], v[122:123] op_sel:[0,1] op_sel_hi:[1,1]
    v_pk_mul_f32 v[244:245], v[244:245], v[122:123] op_sel:[0,1] op_sel_hi:[1,1]
    v_pk_mul_f32 v[246:247], v[246:247], v[122:123] op_sel:[0,1] op_sel_hi:[1,1]
    v_cvt_pk_bf16_f32 v240, v240, v241
    v_cvt_pk_bf16_f32 v241, v242, v243
    v_cvt_pk_bf16_f32 v242, v244, v245
    v_cvt_pk_bf16_f32 v243, v246, v247
    s_waitcnt lgkmcnt(1)
    buffer_store_dwordx4 v[228:231], v127, s[16:19], s74 offen offset:0 sc1
    ds_write_b64 v125, v[240:241] offset:128
    ds_write_b64 v125, v[242:243] offset:160
    v_pk_mul_f32 v[248:249], v[248:249], v[122:123] op_sel:[0,1] op_sel_hi:[1,1]
    v_pk_mul_f32 v[250:251], v[250:251], v[122:123] op_sel:[0,1] op_sel_hi:[1,1]
    v_pk_mul_f32 v[252:253], v[252:253], v[122:123] op_sel:[0,1] op_sel_hi:[1,1]
    v_pk_mul_f32 v[254:255], v[254:255], v[122:123] op_sel:[0,1] op_sel_hi:[1,1]
    s_waitcnt lgkmcnt(2)
    buffer_store_dwordx4 v[236:239], v127, s[16:19], s74 offen offset:2048 sc1
    v_cvt_pk_bf16_f32 v248, v248, v249
    v_cvt_pk_bf16_f32 v249, v250, v251
    v_cvt_pk_bf16_f32 v250, v252, v253
    v_cvt_pk_bf16_f32 v251, v254, v255
    ds_write_b64 v125, v[248:249] offset:192
    ds_write_b64 v125, v[250:251] offset:224
    ds_read_b128 v[244:247], v126 offset:128
    ds_read_b128 v[252:255], v126 offset:3328
    s_waitcnt lgkmcnt(1)
    buffer_store_dwordx4 v[244:247], v127, s[16:19], s74 offen offset:128 sc1
    s_waitcnt lgkmcnt(0)
    buffer_store_dwordx4 v[252:255], v127, s[16:19], s74 offen offset:2176 sc1
    v_cmp_lt_u32 vcc, 0x28000000, v124
    s_cmp_lg_u32 s70, 0
    s_cbranch_scc1 L_slow
    s_nop 3
    s_cbranch_vccnz L_slow
    s_endpgm
L_tail4:
    v_mfma_f32_16x16x32_bf16 v[0:3], a[64:67], a[0:3], 0
    s_waitcnt vmcnt(8)
    v_exp_f32 v58, v58
    v_mfma_f32_16x16x32_bf16 v[0:3], a[68:71], a[4:7], v[0:3]
    s_barrier
    v_mfma_f32_16x16x32_bf16 v[0:3], a[72:75], a[8:11], v[0:3]
    v_exp_f32 v59, v59
    v_mfma_f32_16x16x32_bf16 v[0:3], a[76:79], a[12:15], v[0:3]
    v_exp_f32 v60, v60
    v_mfma_f32_16x16x32_bf16 v[4:7], a[92:95], a[12:15], 0
    v_exp_f32 v61, v61
    v_mfma_f32_16x16x32_bf16 v[4:7], a[88:91], a[8:11], v[4:7]
    v_exp_f32 v62, v62
    v_mfma_f32_16x16x32_bf16 v[4:7], a[84:87], a[4:7], v[4:7]
    v_cvt_pk_bf16_f32 v93, v58, v59
    v_cvt_pk_bf16_f32 v94, v60, v61
    v_mfma_f32_16x16x32_bf16 v[4:7], a[80:83], a[0:3], v[4:7]
    v_exp_f32 v63, v63
    v_mfma_f32_16x16x32_bf16 v[8:11], a[96:99], a[0:3], 0
    s_add_u32 m0, s65, 49152
    v_exp_f32 v0, v0
    v_mfma_f32_16x16x32_bf16 v[8:11], a[100:103], a[4:7], v[8:11]
    v_exp_f32 v1, v1
    v_mfma_f32_16x16x32_bf16 v[8:11], a[104:107], a[8:11], v[8:11]
    s_nop 0
    buffer_load_dwordx4 v113, s[12:15], s60 offen offset:0 sc1 lds
    v_mfma_f32_16x16x32_bf16 v[8:11], a[108:111], a[12:15], v[8:11]
    s_waitcnt lgkmcnt(0)
    v_cvt_pk_bf16_f32 v95, v62, v63
    v_cvt_pk_bf16_f32 v64, v0, v1
    v_mfma_f32_16x16x32_bf16 v[12:15], a[124:127], a[12:15], 0
    v_exp_f32 v2, v2
    v_mfma_f32_16x16x32_bf16 v[12:15], a[120:123], a[8:11], v[12:15]
    v_exp_f32 v3, v3
    v_mfma_f32_16x16x32_bf16 v[12:15], a[116:119], a[4:7], v[12:15]
    s_nop 0
    buffer_load_dwordx4 v113, s[12:15], s61 offen offset:1024 sc1 lds
    v_mfma_f32_16x16x32_bf16 v[12:15], a[112:115], a[0:3], v[12:15]
    v_exp_f32 v4, v4
    v_mfma_f32_16x16x32_bf16 v[192:195], a[128:131], v[80:83], v[192:195]
    v_exp_f32 v5, v5
    v_mfma_f32_16x16x32_bf16 v[192:195], a[132:135], v[84:87], v[192:195]
    v_exp_f32 v6, v6
    v_mfma_f32_16x16x32_bf16 v[196:199], a[136:139], v[80:83], v[196:199]
    s_nop 0
    buffer_load_dwordx4 v113, s[12:15], s62 offen offset:2048 sc1 lds
    v_mfma_f32_16x16x32_bf16 v[196:199], a[140:143], v[84:87], v[196:199]
    v_exp_f32 v7, v7
    v_mfma_f32_16x16x32_bf16 v[200:203], a[144:147], v[80:83], v[200:203]
    v_exp_f32 v8, v8
    v_mfma_f32_16x16x32_bf16 v[200:203], a[148:151], v[84:87], v[200:203]
    v_exp_f32 v9, v9
    v_mfma_f32_16x16x32_bf16 v[204:207], a[152:155], v[80:83], v[204:207]
    s_nop 0
    buffer_load_dwordx4 v113, s[12:15], s63 offen offset:3072 sc1 lds
    v_mfma_f32_16x16x32_bf16 v[204:207], a[156:159], v[84:87], v[204:207]
    v_exp_f32 v10, v10
    v_mfma_f32_16x16x32_bf16 v[208:211], a[160:163], v[80:83], v[208:211]
    v_exp_f32 v11, v11
    v_mfma_f32_16x16x32_bf16 v[208:211], a[164:167], v[84:87], v[208:211]
    v_exp_f32 v12, v12
    v_mfma_f32_16x16x32_bf16 v[212:215], a[168:171], v[80:83], v[212:215]
    v_cvt_pk_bf16_f32 v65, v2, v3
    v_cvt_pk_bf16_f32 v66, v4, v5
    v_mfma_f32_16x16x32_bf16 v[212:215], a[172:175], v[84:87], v[212:215]
    v_exp_f32 v13, v13
    v_mfma_f32_16x16x32_bf16 v[216:219], a[176:179], v[80:83], v[216:219]
    v_cvt_pk_bf16_f32 v67, v6, v7
    v_cvt_pk_bf16_f32 v68, v8, v9
    v_mfma_f32_16x16x32_bf16 v[216:219], a[180:183], v[84:87], v[216:219]
    v_exp_f32 v14, v14
    v_mfma_f32_16x16x32_bf16 v[220:223], a[184:187], v[80:83], v[220:223]
    v_cvt_pk_bf16_f32 v69, v10, v11
    v_cvt_pk_bf16_f32 v70, v12, v13
    v_mfma_f32_16x16x32_bf16 v[220:223], a[188:191], v[84:87], v[220:223]
    v_exp_f32 v15, v15
    v_smfmac_f32_16x16x64_bf16 a[200:203], a[208:211], v[80:87], v114
    v_cvt_pk_bf16_f32 v71, v14, v15
    v_mbcnt_lo_u32_b32 v120, -1, 0
    v_mfma_f32_16x16x32_bf16 v[16:19], a[64:67], a[16:19], 0
    v_mbcnt_hi_u32_b32 v120, -1, v120
    v_and_b32 v121, 15, v120
    v_mfma_f32_16x16x32_bf16 v[16:19], a[68:71], a[20:23], v[16:19]
    ds_read_b128 a[64:67], v96 offset:32768
    v_lshrrev_b32 v122, 4, v120
    v_mfma_f32_16x16x32_bf16 v[16:19], a[72:75], a[24:27], v[16:19]
    ds_read_b128 a[68:71], v97 offset:32768
    v_mul_u32_u24 v125, 400, v121
    v_mfma_f32_16x16x32_bf16 v[16:19], a[76:79], a[28:31], v[16:19]
    ds_read_b128 a[72:75], v98 offset:32768
    v_lshl_add_u32 v125, v122, 3, v125
    v_mfma_f32_16x16x32_bf16 v[20:23], a[92:95], a[28:31], 0
    ds_read_b128 a[76:79], v99 offset:32768
    v_lshrrev_b32 v121, 3, v120
    v_mfma_f32_16x16x32_bf16 v[20:23], a[88:91], a[24:27], v[20:23]
    ds_read_b128 a[92:95], v99 offset:33792
    v_and_b32 v122, 7, v120
    v_mfma_f32_16x16x32_bf16 v[20:23], a[84:87], a[20:23], v[20:23]
    ds_read_b128 a[88:91], v98 offset:33792
    v_mul_u32_u24 v126, 400, v121
    v_mfma_f32_16x16x32_bf16 v[20:23], a[80:83], a[16:19], v[20:23]
    ds_read_b128 a[84:87], v97 offset:33792
    v_lshl_add_u32 v126, v122, 4, v126
    v_mfma_f32_16x16x32_bf16 v[24:27], a[96:99], a[16:19], 0
    ds_read_b128 a[80:83], v96 offset:33792
    v_add_u32 v125, s81, v125
    v_mfma_f32_16x16x32_bf16 v[24:27], a[100:103], a[20:23], v[24:27]
    ds_read_b128 a[96:99], v96 offset:34816
    v_add_u32 v126, s81, v126
    v_mfma_f32_16x16x32_bf16 v[24:27], a[104:107], a[24:27], v[24:27]
    ds_read_b128 a[100:103], v97 offset:34816
    v_lshlrev_b32 v127, 8, v121
    v_mfma_f32_16x16x32_bf16 v[24:27], a[108:111], a[28:31], v[24:27]
    ds_read_b128 a[104:107], v98 offset:34816
    v_lshl_add_u32 v127, v122, 4, v127
    v_mfma_f32_16x16x32_bf16 v[28:31], a[124:127], a[28:31], 0
    ds_read_b128 a[108:111], v99 offset:34816
    v_add_u32 v127, s82, v127
    v_mfma_f32_16x16x32_bf16 v[28:31], a[120:123], a[24:27], v[28:31]
    v_exp_f32 v16, v16
    v_mfma_f32_16x16x32_bf16 v[28:31], a[116:119], a[20:23], v[28:31]
    v_exp_f32 v17, v17
    v_mfma_f32_16x16x32_bf16 v[28:31], a[112:115], a[16:19], v[28:31]
    ds_read_b128 a[124:127], v99 offset:35840
    v_cvt_pk_bf16_f32 v72, v16, v17
    v_mfma_f32_16x16x32_bf16 v[224:227], a[128:131], v[88:91], v[224:227]
    v_exp_f32 v18, v18
    v_mfma_f32_16x16x32_bf16 v[224:227], a[132:135], v[92:95], v[224:227]
    ds_read_b128 a[120:123], v98 offset:35840
    ds_read_b64_tr_b16 a[128:129], v100 offset:16384
    v_mfma_f32_16x16x32_bf16 v[228:231], a[136:139], v[88:91], v[228:231]
    ds_read_b128 a[116:119], v97 offset:35840
    v_mfma_f32_16x16x32_bf16 v[228:231], a[140:143], v[92:95], v[228:231]
    ds_read_b128 a[112:115], v96 offset:35840
    ds_read_b64_tr_b16 a[130:131], v100 offset:17408
    v_mfma_f32_16x16x32_bf16 v[232:235], a[144:147], v[88:91], v[232:235]
    v_exp_f32 v19, v19
    v_mfma_f32_16x16x32_bf16 v[232:235], a[148:151], v[92:95], v[232:235]
    v_exp_f32 v20, v20
    v_mfma_f32_16x16x32_bf16 v[236:239], a[152:155], v[88:91], v[236:239]
    ds_read_b64_tr_b16 a[132:133], v100 offset:18432
    v_cvt_pk_bf16_f32 v73, v18, v19
    v_mfma_f32_16x16x32_bf16 v[236:239], a[156:159], v[92:95], v[236:239]
    v_exp_f32 v21, v21
    v_mfma_f32_16x16x32_bf16 v[240:243], a[160:163], v[88:91], v[240:243]
    ds_read_b64_tr_b16 a[134:135], v100 offset:19456
    v_cvt_pk_bf16_f32 v74, v20, v21
    v_mfma_f32_16x16x32_bf16 v[240:243], a[164:167], v[92:95], v[240:243]
    ds_read_b64_tr_b16 a[136:137], v101 offset:16384
    ds_read_b64_tr_b16 a[138:139], v101 offset:17408
    v_mfma_f32_16x16x32_bf16 v[244:247], a[168:171], v[88:91], v[244:247]
    ds_read_b64_tr_b16 a[140:141], v101 offset:18432
    v_mfma_f32_16x16x32_bf16 v[244:247], a[172:175], v[92:95], v[244:247]
    v_exp_f32 v22, v22
    v_mfma_f32_16x16x32_bf16 v[248:251], a[176:179], v[88:91], v[248:251]
    ds_read_b64_tr_b16 a[142:143], v101 offset:19456
    ds_read_b64_tr_b16 a[144:145], v102 offset:16384
    v_mfma_f32_16x16x32_bf16 v[248:251], a[180:183], v[92:95], v[248:251]
    ds_read_b64_tr_b16 a[146:147], v102 offset:17408
    v_mfma_f32_16x16x32_bf16 v[252:255], a[184:187], v[88:91], v[252:255]
    ds_read_b64_tr_b16 a[148:149], v102 offset:18432
    ds_read_b64_tr_b16 a[150:151], v102 offset:19456
    v_mfma_f32_16x16x32_bf16 v[252:255], a[188:191], v[92:95], v[252:255]
    v_exp_f32 v23, v23
    v_smfmac_f32_16x16x64_bf16 a[204:207], a[208:211], v[88:95], v114
    s_waitcnt lgkmcnt(8)
    ds_read_b64_tr_b16 a[152:153], v103 offset:16384
    v_cvt_pk_bf16_f32 v75, v22, v23
    v_mfma_f32_16x16x32_bf16 v[32:35], a[64:67], a[0:3], 0
    ds_read_b64_tr_b16 a[154:155], v103 offset:17408
    ds_read_b64_tr_b16 a[156:157], v103 offset:18432
    v_mfma_f32_16x16x32_bf16 v[32:35], a[68:71], a[4:7], v[32:35]
    v_exp_f32 v24, v24
    v_mfma_f32_16x16x32_bf16 v[32:35], a[72:75], a[8:11], v[32:35]
    ds_read_b64_tr_b16 a[158:159], v103 offset:19456
    ds_read_b64_tr_b16 a[160:161], v104 offset:16384
    v_mfma_f32_16x16x32_bf16 v[32:35], a[76:79], a[12:15], v[32:35]
    ds_read_b64_tr_b16 a[162:163], v104 offset:17408
    v_mfma_f32_16x16x32_bf16 v[36:39], a[92:95], a[12:15], 0
    ds_read_b64_tr_b16 a[164:165], v104 offset:18432
    ds_read_b64_tr_b16 a[166:167], v104 offset:19456
    v_mfma_f32_16x16x32_bf16 v[36:39], a[88:91], a[8:11], v[36:39]
    v_exp_f32 v25, v25
    v_mfma_f32_16x16x32_bf16 v[36:39], a[84:87], a[4:7], v[36:39]
    ds_read_b64_tr_b16 a[168:169], v105 offset:16384
    v_cvt_pk_bf16_f32 v76, v24, v25
    v_mfma_f32_16x16x32_bf16 v[36:39], a[80:83], a[0:3], v[36:39]
    ds_read_b64_tr_b16 a[170:171], v105 offset:17408
    ds_read_b64_tr_b16 a[172:173], v105 offset:18432
    v_mfma_f32_16x16x32_bf16 v[40:43], a[96:99], a[0:3], 0
    v_exp_f32 v26, v26
    v_mfma_f32_16x16x32_bf16 v[40:43], a[100:103], a[4:7], v[40:43]
    ds_read_b64_tr_b16 a[174:175], v105 offset:19456
    ds_read_b64_tr_b16 a[176:177], v106 offset:16384
    v_mfma_f32_16x16x32_bf16 v[40:43], a[104:107], a[8:11], v[40:43]
    ds_read_b64_tr_b16 a[178:179], v106 offset:17408
    v_mfma_f32_16x16x32_bf16 v[40:43], a[108:111], a[12:15], v[40:43]
    ds_read_b64_tr_b16 a[180:181], v106 offset:18432
    ds_read_b64_tr_b16 a[182:183], v106 offset:19456
    v_mfma_f32_16x16x32_bf16 v[44:47], a[124:127], a[12:15], 0
    v_exp_f32 v27, v27
    v_mfma_f32_16x16x32_bf16 v[44:47], a[120:123], a[8:11], v[44:47]
    ds_read_b64_tr_b16 a[184:185], v107 offset:16384
    v_cvt_pk_bf16_f32 v77, v26, v27
    v_mfma_f32_16x16x32_bf16 v[44:47], a[116:119], a[4:7], v[44:47]
    ds_read_b64_tr_b16 a[186:187], v107 offset:17408
    ds_read_b64_tr_b16 a[188:189], v107 offset:18432
    v_mfma_f32_16x16x32_bf16 v[44:47], a[112:115], a[0:3], v[44:47]
    v_exp_f32 v28, v28
    v_mfma_f32_16x16x32_bf16 v[48:51], a[64:67], a[16:19], 0
    v_exp_f32 v29, v29
    v_mfma_f32_16x16x32_bf16 v[48:51], a[68:71], a[20:23], v[48:51]
    ds_read_b64_tr_b16 a[190:191], v107 offset:19456
    v_cvt_pk_bf16_f32 v78, v28, v29
    v_mfma_f32_16x16x32_bf16 v[48:51], a[72:75], a[24:27], v[48:51]
    v_exp_f32 v30, v30
    v_mfma_f32_16x16x32_bf16 v[48:51], a[76:79], a[28:31], v[48:51]
    v_exp_f32 v31, v31
    v_mfma_f32_16x16x32_bf16 v[52:55], a[92:95], a[28:31], 0
    v_exp_f32 v32, v32
    v_mfma_f32_16x16x32_bf16 v[52:55], a[88:91], a[24:27], v[52:55]
    v_exp_f32 v33, v33
    v_mfma_f32_16x16x32_bf16 v[52:55], a[84:87], a[20:23], v[52:55]
    v_cvt_pk_bf16_f32 v79, v30, v31
    v_cvt_pk_bf16_f32 v80, v32, v33
    v_mfma_f32_16x16x32_bf16 v[52:55], a[80:83], a[16:19], v[52:55]
    v_exp_f32 v34, v34
    v_mfma_f32_16x16x32_bf16 v[56:59], a[96:99], a[16:19], 0
    v_exp_f32 v35, v35
    v_mfma_f32_16x16x32_bf16 v[56:59], a[100:103], a[20:23], v[56:59]
    s_waitcnt vmcnt(0)
    v_exp_f32 v36, v36
    v_mfma_f32_16x16x32_bf16 v[56:59], a[104:107], a[24:27], v[56:59]
    s_barrier
    v_mfma_f32_16x16x32_bf16 v[56:59], a[108:111], a[28:31], v[56:59]
    ds_read_b128 a[64:67], v96 offset:49152
    v_cvt_pk_bf16_f32 v81, v34, v35
    v_mfma_f32_16x16x32_bf16 v[60:63], a[124:127], a[28:31], 0
    v_exp_f32 v37, v37
    v_mfma_f32_16x16x32_bf16 v[60:63], a[120:123], a[24:27], v[60:63]
    ds_read_b128 a[68:71], v97 offset:49152
    v_cvt_pk_bf16_f32 v82, v36, v37
    v_mfma_f32_16x16x32_bf16 v[60:63], a[116:119], a[20:23], v[60:63]
    v_exp_f32 v38, v38
    v_mfma_f32_16x16x32_bf16 v[60:63], a[112:115], a[16:19], v[60:63]
    v_exp_f32 v39, v39
    v_mfma_f32_16x16x32_bf16 v[128:131], a[128:131], v[64:67], v[128:131]
    ds_read_b128 a[72:75], v98 offset:49152
    v_cvt_pk_bf16_f32 v83, v38, v39
    v_mfma_f32_16x16x32_bf16 v[128:131], a[132:135], v[68:71], v[128:131]
    s_waitcnt lgkmcnt(3)
    v_exp_f32 v40, v40
    v_mfma_f32_16x16x32_bf16 v[132:135], a[136:139], v[64:67], v[132:135]
    v_exp_f32 v48, v48
    v_mfma_f32_16x16x32_bf16 v[132:135], a[140:143], v[68:71], v[132:135]
    v_exp_f32 v41, v41
    v_mfma_f32_16x16x32_bf16 v[136:139], a[144:147], v[64:67], v[136:139]
    ds_read_b128 a[76:79], v99 offset:49152
    v_cvt_pk_bf16_f32 v84, v40, v41
    v_mfma_f32_16x16x32_bf16 v[136:139], a[148:151], v[68:71], v[136:139]
    v_exp_f32 v49, v49
    v_mfma_f32_16x16x32_bf16 v[140:143], a[152:155], v[64:67], v[140:143]
    ds_read_b128 a[92:95], v99 offset:50176
    v_cvt_pk_bf16_f32 v88, v48, v49
    v_mfma_f32_16x16x32_bf16 v[140:143], a[156:159], v[68:71], v[140:143]
    v_exp_f32 v42, v42
    v_mfma_f32_16x16x32_bf16 v[144:147], a[160:163], v[64:67], v[144:147]
    v_exp_f32 v50, v50
    v_mfma_f32_16x16x32_bf16 v[144:147], a[164:167], v[68:71], v[144:147]
    v_exp_f32 v43, v43
    v_mfma_f32_16x16x32_bf16 v[148:151], a[168:171], v[64:67], v[148:151]
    ds_read_b128 a[88:91], v98 offset:50176
    v_cvt_pk_bf16_f32 v85, v42, v43
    v_mfma_f32_16x16x32_bf16 v[148:151], a[172:175], v[68:71], v[148:151]
    v_exp_f32 v51, v51
    v_mfma_f32_16x16x32_bf16 v[152:155], a[176:179], v[64:67], v[152:155]
    ds_read_b128 a[84:87], v97 offset:50176
    v_cvt_pk_bf16_f32 v89, v50, v51
    v_mfma_f32_16x16x32_bf16 v[152:155], a[180:183], v[68:71], v[152:155]
    v_exp_f32 v44, v44
    v_mfma_f32_16x16x32_bf16 v[156:159], a[184:187], v[64:67], v[156:159]
    v_exp_f32 v52, v52
    v_mfma_f32_16x16x32_bf16 v[156:159], a[188:191], v[68:71], v[156:159]
    v_exp_f32 v45, v45
    v_smfmac_f32_16x16x64_bf16 a[192:195], a[208:211], v[64:71], v114
    ds_read_b128 a[80:83], v96 offset:50176
    v_cvt_pk_bf16_f32 v86, v44, v45
    v_mfma_f32_16x16x32_bf16 v[160:163], a[128:131], v[72:75], v[160:163]
    v_exp_f32 v53, v53
    v_mfma_f32_16x16x32_bf16 v[160:163], a[132:135], v[76:79], v[160:163]
    ds_read_b128 a[96:99], v96 offset:51200
    v_cvt_pk_bf16_f32 v90, v52, v53
    v_mfma_f32_16x16x32_bf16 v[164:167], a[136:139], v[72:75], v[164:167]
    ds_read_b128 a[100:103], v97 offset:51200
    ds_read_b64_tr_b16 a[128:129], v100 offset:32768
    v_mfma_f32_16x16x32_bf16 v[164:167], a[140:143], v[76:79], v[164:167]
    ds_read_b128 a[104:107], v98 offset:51200
    v_mfma_f32_16x16x32_bf16 v[168:171], a[144:147], v[72:75], v[168:171]
    ds_read_b128 a[108:111], v99 offset:51200
    ds_read_b64_tr_b16 a[130:131], v100 offset:33792
    v_mfma_f32_16x16x32_bf16 v[168:171], a[148:151], v[76:79], v[168:171]
    ds_read_b128 a[124:127], v99 offset:52224
    v_mfma_f32_16x16x32_bf16 v[172:175], a[152:155], v[72:75], v[172:175]
    ds_read_b128 a[120:123], v98 offset:52224
    ds_read_b64_tr_b16 a[132:133], v100 offset:34816
    v_mfma_f32_16x16x32_bf16 v[172:175], a[156:159], v[76:79], v[172:175]
    ds_read_b128 a[116:119], v97 offset:52224
    v_mfma_f32_16x16x32_bf16 v[176:179], a[160:163], v[72:75], v[176:179]
    ds_read_b128 a[112:115], v96 offset:52224
    ds_read_b64_tr_b16 a[134:135], v100 offset:35840
    v_mfma_f32_16x16x32_bf16 v[176:179], a[164:167], v[76:79], v[176:179]
    ds_read_b64_tr_b16 a[136:137], v101 offset:32768
    v_mfma_f32_16x16x32_bf16 v[180:183], a[168:171], v[72:75], v[180:183]
    v_exp_f32 v46, v46
    v_mfma_f32_16x16x32_bf16 v[180:183], a[172:175], v[76:79], v[180:183]
    ds_read_b64_tr_b16 a[138:139], v101 offset:33792
    ds_read_b64_tr_b16 a[140:141], v101 offset:34816
    v_mfma_f32_16x16x32_bf16 v[184:187], a[176:179], v[72:75], v[184:187]
    v_exp_f32 v54, v54
    v_mfma_f32_16x16x32_bf16 v[184:187], a[180:183], v[76:79], v[184:187]
    ds_read_b64_tr_b16 a[142:143], v101 offset:35840
    ds_read_b64_tr_b16 a[144:145], v102 offset:32768
    v_mfma_f32_16x16x32_bf16 v[188:191], a[184:187], v[72:75], v[188:191]
    v_exp_f32 v47, v47
    v_mfma_f32_16x16x32_bf16 v[188:191], a[188:191], v[76:79], v[188:191]
    ds_read_b64_tr_b16 a[146:147], v102 offset:33792
    v_cvt_pk_bf16_f32 v87, v46, v47
    v_smfmac_f32_16x16x64_bf16 a[196:199], a[208:211], v[72:79], v114
    s_waitcnt lgkmcnt(6)
    ds_read_b64_tr_b16 a[148:149], v102 offset:34816
    ds_read_b64_tr_b16 a[150:151], v102 offset:35840
    v_mfma_f32_16x16x32_bf16 v[0:3], a[64:67], a[0:3], 0
    v_exp_f32 v55, v55
    v_mfma_f32_16x16x32_bf16 v[0:3], a[68:71], a[4:7], v[0:3]
    ds_read_b64_tr_b16 a[152:153], v103 offset:32768
    v_cvt_pk_bf16_f32 v91, v54, v55
    v_mfma_f32_16x16x32_bf16 v[0:3], a[72:75], a[8:11], v[0:3]
    ds_read_b64_tr_b16 a[154:155], v103 offset:33792
    ds_read_b64_tr_b16 a[156:157], v103 offset:34816
    v_mfma_f32_16x16x32_bf16 v[0:3], a[76:79], a[12:15], v[0:3]
    v_exp_f32 v56, v56
    v_mfma_f32_16x16x32_bf16 v[4:7], a[92:95], a[12:15], 0
    ds_read_b64_tr_b16 a[158:159], v103 offset:35840
    ds_read_b64_tr_b16 a[160:161], v104 offset:32768
    v_mfma_f32_16x16x32_bf16 v[4:7], a[88:91], a[8:11], v[4:7]
    ds_read_b64_tr_b16 a[162:163], v104 offset:33792
    v_mfma_f32_16x16x32_bf16 v[4:7], a[84:87], a[4:7], v[4:7]
    ds_read_b64_tr_b16 a[164:165], v104 offset:34816
    ds_read_b64_tr_b16 a[166:167], v104 offset:35840
    v_mfma_f32_16x16x32_bf16 v[4:7], a[80:83], a[0:3], v[4:7]
    v_exp_f32 v57, v57
    v_mfma_f32_16x16x32_bf16 v[8:11], a[96:99], a[0:3], 0
    ds_read_b64_tr_b16 a[168:169], v105 offset:32768
    v_cvt_pk_bf16_f32 v92, v56, v57
    v_mfma_f32_16x16x32_bf16 v[8:11], a[100:103], a[4:7], v[8:11]
    ds_read_b64_tr_b16 a[170:171], v105 offset:33792
    ds_read_b64_tr_b16 a[172:173], v105 offset:34816
    v_mfma_f32_16x16x32_bf16 v[8:11], a[104:107], a[8:11], v[8:11]
    v_exp_f32 v58, v58
    v_mfma_f32_16x16x32_bf16 v[8:11], a[108:111], a[12:15], v[8:11]
    ds_read_b64_tr_b16 a[174:175], v105 offset:35840
    ds_read_b64_tr_b16 a[176:177], v106 offset:32768
    v_mfma_f32_16x16x32_bf16 v[12:15], a[124:127], a[12:15], v[116:119]
    ds_read_b64_tr_b16 a[178:179], v106 offset:33792
    v_mfma_f32_16x16x32_bf16 v[12:15], a[120:123], a[8:11], v[12:15]
    ds_read_b64_tr_b16 a[180:181], v106 offset:34816
    ds_read_b64_tr_b16 a[182:183], v106 offset:35840
    v_mfma_f32_16x16x32_bf16 v[12:15], a[116:119], a[4:7], v[12:15]
    v_exp_f32 v59, v59
    v_mfma_f32_16x16x32_bf16 v[12:15], a[112:115], a[0:3], v[12:15]
    ds_read_b64_tr_b16 a[184:185], v107 offset:32768
    v_cvt_pk_bf16_f32 v93, v58, v59
    v_mfma_f32_16x16x32_bf16 v[16:19], a[64:67], a[16:19], 0
    ds_read_b64_tr_b16 a[186:187], v107 offset:33792
    ds_read_b64_tr_b16 a[188:189], v107 offset:34816
    v_mfma_f32_16x16x32_bf16 v[16:19], a[68:71], a[20:23], v[16:19]
    v_exp_f32 v60, v60
    v_mfma_f32_16x16x32_bf16 v[16:19], a[72:75], a[24:27], v[16:19]
    ds_read_b64_tr_b16 a[190:191], v107 offset:35840
    ds_read_b128 a[64:67], v96 offset:16384
    v_mfma_f32_16x16x32_bf16 v[16:19], a[76:79], a[28:31], v[16:19]
    v_exp_f32 v61, v61
    v_mfma_f32_16x16x32_bf16 v[20:23], a[92:95], a[28:31], 0
    v_exp_f32 v62, v62
    v_mfma_f32_16x16x32_bf16 v[20:23], a[88:91], a[24:27], v[20:23]
    v_exp_f32 v63, v63
    v_mfma_f32_16x16x32_bf16 v[20:23], a[84:87], a[20:23], v[20:23]
    v_cvt_pk_bf16_f32 v94, v60, v61
    v_cvt_pk_bf16_f32 v95, v62, v63
    v_mfma_f32_16x16x32_bf16 v[20:23], a[80:83], a[16:19], v[20:23]
    v_exp_f32 v0, v0
    v_mfma_f32_16x16x32_bf16 v[24:27], a[96:99], a[16:19], 0
    v_exp_f32 v1, v1
    v_mfma_f32_16x16x32_bf16 v[24:27], a[100:103], a[20:23], v[24:27]
    v_exp_f32 v2, v2
    v_mfma_f32_16x16x32_bf16 v[24:27], a[104:107], a[24:27], v[24:27]
    v_exp_f32 v3, v3
    v_mfma_f32_16x16x32_bf16 v[24:27], a[108:111], a[28:31], v[24:27]
    v_exp_f32 v4, v4
    v_mfma_f32_16x16x32_bf16 v[28:31], a[124:127], a[28:31], v[116:119]
    v_exp_f32 v5, v5
    v_mfma_f32_16x16x32_bf16 v[28:31], a[120:123], a[24:27], v[28:31]
    ds_read_b128 a[68:71], v97 offset:16384
    v_cvt_pk_bf16_f32 v64, v0, v1
    v_mfma_f32_16x16x32_bf16 v[28:31], a[116:119], a[20:23], v[28:31]
    v_exp_f32 v6, v6
    v_mfma_f32_16x16x32_bf16 v[28:31], a[112:115], a[16:19], v[28:31]
    ds_read_b128 a[72:75], v98 offset:16384
    v_cvt_pk_bf16_f32 v65, v2, v3
    v_mfma_f32_16x16x32_bf16 v[128:131], a[128:131], v[80:83], v[128:131]
    ds_read_b128 a[76:79], v99 offset:16384
    v_cvt_pk_bf16_f32 v66, v4, v5
    v_mfma_f32_16x16x32_bf16 v[128:131], a[132:135], v[84:87], v[128:131]
    s_waitcnt lgkmcnt(3)
    v_exp_f32 v7, v7
    v_mfma_f32_16x16x32_bf16 v[132:135], a[136:139], v[80:83], v[132:135]
    ds_read_b128 a[92:95], v99 offset:17408
    v_cvt_pk_bf16_f32 v67, v6, v7
    v_mfma_f32_16x16x32_bf16 v[132:135], a[140:143], v[84:87], v[132:135]
    v_exp_f32 v8, v8
    v_mfma_f32_16x16x32_bf16 v[136:139], a[144:147], v[80:83], v[136:139]
    v_exp_f32 v16, v16
    v_mfma_f32_16x16x32_bf16 v[136:139], a[148:151], v[84:87], v[136:139]
    v_exp_f32 v9, v9
    v_mfma_f32_16x16x32_bf16 v[140:143], a[152:155], v[80:83], v[140:143]
    ds_read_b128 a[88:91], v98 offset:17408
    v_cvt_pk_bf16_f32 v68, v8, v9
    v_mfma_f32_16x16x32_bf16 v[140:143], a[156:159], v[84:87], v[140:143]
    v_exp_f32 v17, v17
    v_mfma_f32_16x16x32_bf16 v[144:147], a[160:163], v[80:83], v[144:147]
    ds_read_b128 a[84:87], v97 offset:17408
    v_cvt_pk_bf16_f32 v72, v16, v17
    v_mfma_f32_16x16x32_bf16 v[144:147], a[164:167], v[84:87], v[144:147]
    v_exp_f32 v10, v10
    v_mfma_f32_16x16x32_bf16 v[148:151], a[168:171], v[80:83], v[148:151]
    v_exp_f32 v18, v18
    v_mfma_f32_16x16x32_bf16 v[148:151], a[172:175], v[84:87], v[148:151]
    v_exp_f32 v11, v11
    v_mfma_f32_16x16x32_bf16 v[152:155], a[176:179], v[80:83], v[152:155]
    ds_read_b128 a[80:83], v96 offset:17408
    v_cvt_pk_bf16_f32 v69, v10, v11
    v_mfma_f32_16x16x32_bf16 v[152:155], a[180:183], v[84:87], v[152:155]
    v_exp_f32 v19, v19
    v_mfma_f32_16x16x32_bf16 v[156:159], a[184:187], v[80:83], v[156:159]
    ds_read_b128 a[96:99], v96 offset:18432
    v_cvt_pk_bf16_f32 v73, v18, v19
    v_mfma_f32_16x16x32_bf16 v[156:159], a[188:191], v[84:87], v[156:159]
    v_exp_f32 v12, v12
    v_smfmac_f32_16x16x64_bf16 a[192:195], a[208:211], v[80:87], v114
    v_exp_f32 v20, v20
    v_mfma_f32_16x16x32_bf16 v[160:163], a[128:131], v[88:91], v[160:163]
    v_exp_f32 v13, v13
    v_mfma_f32_16x16x32_bf16 v[160:163], a[132:135], v[92:95], v[160:163]
    ds_read_b128 a[100:103], v97 offset:18432
    v_cvt_pk_bf16_f32 v70, v12, v13
    v_mfma_f32_16x16x32_bf16 v[164:167], a[136:139], v[88:91], v[164:167]
    ds_read_b128 a[104:107], v98 offset:18432
    ds_read_b64_tr_b16 a[128:129], v100 offset:49152
    v_mfma_f32_16x16x32_bf16 v[164:167], a[140:143], v[92:95], v[164:167]
    ds_read_b128 a[108:111], v99 offset:18432
    v_mfma_f32_16x16x32_bf16 v[168:171], a[144:147], v[88:91], v[168:171]
    ds_read_b128 a[124:127], v99 offset:19456
    ds_read_b64_tr_b16 a[130:131], v100 offset:50176
    v_mfma_f32_16x16x32_bf16 v[168:171], a[148:151], v[92:95], v[168:171]
    ds_read_b128 a[120:123], v98 offset:19456
    v_mfma_f32_16x16x32_bf16 v[172:175], a[152:155], v[88:91], v[172:175]
    ds_read_b128 a[116:119], v97 offset:19456
    ds_read_b64_tr_b16 a[132:133], v100 offset:51200
    v_mfma_f32_16x16x32_bf16 v[172:175], a[156:159], v[92:95], v[172:175]
    ds_read_b128 a[112:115], v96 offset:19456
    v_mfma_f32_16x16x32_bf16 v[176:179], a[160:163], v[88:91], v[176:179]
    v_exp_f32 v21, v21
    v_mfma_f32_16x16x32_bf16 v[176:179], a[164:167], v[92:95], v[176:179]
    v_exp_f32 v14, v14
    v_mfma_f32_16x16x32_bf16 v[180:183], a[168:171], v[88:91], v[180:183]
    ds_read_b64_tr_b16 a[134:135], v100 offset:52224
    v_cvt_pk_bf16_f32 v74, v20, v21
    v_mfma_f32_16x16x32_bf16 v[180:183], a[172:175], v[92:95], v[180:183]
    ds_read_b64_tr_b16 a[136:137], v101 offset:49152
    ds_read_b64_tr_b16 a[138:139], v101 offset:50176
    v_mfma_f32_16x16x32_bf16 v[184:187], a[176:179], v[88:91], v[184:187]
    v_exp_f32 v22, v22
    v_mfma_f32_16x16x32_bf16 v[184:187], a[180:183], v[92:95], v[184:187]
    ds_read_b64_tr_b16 a[140:141], v101 offset:51200
    ds_read_b64_tr_b16 a[142:143], v101 offset:52224
    v_mfma_f32_16x16x32_bf16 v[188:191], a[184:187], v[88:91], v[188:191]
    v_exp_f32 v15, v15
    v_mfma_f32_16x16x32_bf16 v[188:191], a[188:191], v[92:95], v[188:191]
    ds_read_b64_tr_b16 a[144:145], v102 offset:49152
    v_cvt_pk_bf16_f32 v71, v14, v15
    v_smfmac_f32_16x16x64_bf16 a[196:199], a[208:211], v[88:95], v114
    v_exp_f32 v23, v23
    v_mfma_f32_16x16x32_bf16 v[32:35], a[64:67], a[32:35], 0
    s_waitcnt lgkmcnt(6)
    ds_read_b64_tr_b16 a[146:147], v102 offset:50176
    v_cvt_pk_bf16_f32 v75, v22, v23
    v_mfma_f32_16x16x32_bf16 v[32:35], a[68:71], a[36:39], v[32:35]
    ds_read_b64_tr_b16 a[148:149], v102 offset:51200
    ds_read_b64_tr_b16 a[150:151], v102 offset:52224
    v_mfma_f32_16x16x32_bf16 v[32:35], a[72:75], a[40:43], v[32:35]
    ds_read_b64_tr_b16 a[152:153], v103 offset:49152
    v_mfma_f32_16x16x32_bf16 v[32:35], a[76:79], a[44:47], v[32:35]
    v_exp_f32 v24, v24
    v_mfma_f32_16x16x32_bf16 v[36:39], a[92:95], a[44:47], 0
    ds_read_b64_tr_b16 a[154:155], v103 offset:50176
    ds_read_b64_tr_b16 a[156:157], v103 offset:51200
    v_mfma_f32_16x16x32_bf16 v[36:39], a[88:91], a[40:43], v[36:39]
    ds_read_b64_tr_b16 a[158:159], v103 offset:52224
    v_mfma_f32_16x16x32_bf16 v[36:39], a[84:87], a[36:39], v[36:39]
    ds_read_b64_tr_b16 a[160:161], v104 offset:49152
    ds_read_b64_tr_b16 a[162:163], v104 offset:50176
    v_mfma_f32_16x16x32_bf16 v[36:39], a[80:83], a[32:35], v[36:39]
    v_exp_f32 v25, v25
    v_mfma_f32_16x16x32_bf16 v[40:43], a[96:99], a[32:35], 0
    ds_read_b64_tr_b16 a[164:165], v104 offset:51200
    v_cvt_pk_bf16_f32 v76, v24, v25
    v_mfma_f32_16x16x32_bf16 v[40:43], a[100:103], a[36:39], v[40:43]
    ds_read_b64_tr_b16 a[166:167], v104 offset:52224
    ds_read_b64_tr_b16 a[168:169], v105 offset:49152
    v_mfma_f32_16x16x32_bf16 v[40:43], a[104:107], a[40:43], v[40:43]
    v_exp_f32 v26, v26
    v_mfma_f32_16x16x32_bf16 v[40:43], a[108:111], a[44:47], v[40:43]
    ds_read_b64_tr_b16 a[170:171], v105 offset:50176
    ds_read_b64_tr_b16 a[172:173], v105 offset:51200
    v_mfma_f32_16x16x32_bf16 v[44:47], a[124:127], a[44:47], 0
    ds_read_b64_tr_b16 a[174:175], v105 offset:52224
    v_mfma_f32_16x16x32_bf16 v[44:47], a[120:123], a[40:43], v[44:47]
    ds_read_b64_tr_b16 a[176:177], v106 offset:49152
    ds_read_b64_tr_b16 a[178:179], v106 offset:50176
    v_mfma_f32_16x16x32_bf16 v[44:47], a[116:119], a[36:39], v[44:47]
    v_exp_f32 v27, v27
    v_mfma_f32_16x16x32_bf16 v[44:47], a[112:115], a[32:35], v[44:47]
    ds_read_b64_tr_b16 a[180:181], v106 offset:51200
    ds_read_b64_tr_b16 a[182:183], v106 offset:52224
    v_smfmac_f32_16x16x64_bf16 a[192:195], a[208:211], v[64:71], v114
    ds_read_b64_tr_b16 a[184:185], v107 offset:49152
    v_cvt_pk_bf16_f32 v77, v26, v27
    v_mfma_f32_16x16x32_bf16 v[128:131], a[128:131], v[64:67], v[128:131]
    s_waitcnt lgkmcnt(8)
    v_exp_f32 v28, v28
    v_mfma_f32_16x16x32_bf16 v[128:131], a[132:135], v[68:71], v[128:131]
    ds_read_b64_tr_b16 a[186:187], v107 offset:50176
    ds_read_b64_tr_b16 a[188:189], v107 offset:51200
    v_mfma_f32_16x16x32_bf16 v[132:135], a[136:139], v[64:67], v[132:135]
    ds_read_b64_tr_b16 a[190:191], v107 offset:52224
    v_mfma_f32_16x16x32_bf16 v[132:135], a[140:143], v[68:71], v[132:135]
    v_exp_f32 v29, v29
    v_mfma_f32_16x16x32_bf16 v[136:139], a[144:147], v[64:67], v[136:139]
    v_exp_f32 v30, v30
    v_mfma_f32_16x16x32_bf16 v[136:139], a[148:151], v[68:71], v[136:139]
    v_exp_f32 v31, v31
    v_mfma_f32_16x16x32_bf16 v[140:143], a[152:155], v[64:67], v[140:143]
    v_cvt_pk_bf16_f32 v78, v28, v29
    v_cvt_pk_bf16_f32 v79, v30, v31
    v_mfma_f32_16x16x32_bf16 v[140:143], a[156:159], v[68:71], v[140:143]
    v_accvgpr_read_b32 v120, a192
    v_accvgpr_read_b32 v121, a193
    v_mfma_f32_16x16x32_bf16 v[144:147], a[160:163], v[64:67], v[144:147]
    v_add_f32 v120, v120, v121
    v_mfma_f32_16x16x32_bf16 v[144:147], a[164:167], v[68:71], v[144:147]
    s_waitcnt lgkmcnt(1)
    v_rcp_f32 v121, v120
    v_mfma_f32_16x16x32_bf16 v[148:151], a[168:171], v[64:67], v[148:151]
    v_subrev_u32 v120, 0x2b800000, v120
    v_mov_b32 v124, v120
    v_mfma_f32_16x16x32_bf16 v[148:151], a[172:175], v[68:71], v[148:151]
    v_mul_f32 v128, v121, v128
    v_mul_f32 v129, v121, v129
    v_mfma_f32_16x16x32_bf16 v[152:155], a[176:179], v[64:67], v[152:155]
    v_mul_f32 v130, v121, v130
    v_mul_f32 v131, v121, v131
    v_mfma_f32_16x16x32_bf16 v[152:155], a[180:183], v[68:71], v[152:155]
    v_mul_f32 v132, v121, v132
    v_mul_f32 v133, v121, v133
    v_mfma_f32_16x16x32_bf16 v[156:159], a[184:187], v[64:67], v[156:159]
    s_waitcnt lgkmcnt(0)
    v_mul_f32 v134, v121, v134
    v_mul_f32 v135, v121, v135
    v_mfma_f32_16x16x32_bf16 v[156:159], a[188:191], v[68:71], v[156:159]
    v_cvt_pk_bf16_f32 v128, v128, v129
    v_cvt_pk_bf16_f32 v129, v130, v131
    v_smfmac_f32_16x16x64_bf16 a[196:199], a[208:211], v[72:79], v114
    v_cvt_pk_bf16_f32 v130, v132, v133
    v_cvt_pk_bf16_f32 v131, v134, v135
    v_mfma_f32_16x16x32_bf16 v[160:163], a[128:131], v[72:75], v[160:163]
    ds_write_b64 v125, v[128:129] offset:0
    ds_write_b64 v125, v[130:131] offset:32
    v_mfma_f32_16x16x32_bf16 v[160:163], a[132:135], v[76:79], v[160:163]
    v_exp_f32 v32, v32
    v_mfma_f32_16x16x32_bf16 v[164:167], a[136:139], v[72:75], v[164:167]
    v_exp_f32 v33, v33
    v_mfma_f32_16x16x32_bf16 v[164:167], a[140:143], v[76:79], v[164:167]
    v_mul_f32 v136, v121, v136
    v_mul_f32 v137, v121, v137
    v_pk_mul_f32 v[138:139], v[138:139], v[120:121] op_sel:[0,1] op_sel_hi:[1,1]
    v_pk_mul_f32 v[140:141], v[140:141], v[120:121] op_sel:[0,1] op_sel_hi:[1,1]
    v_pk_mul_f32 v[142:143], v[142:143], v[120:121] op_sel:[0,1] op_sel_hi:[1,1]
    v_cvt_pk_bf16_f32 v136, v136, v137
    v_cvt_pk_bf16_f32 v137, v138, v139
    v_cvt_pk_bf16_f32 v138, v140, v141
    v_cvt_pk_bf16_f32 v139, v142, v143
    ds_write_b64 v125, v[136:137] offset:64
    ds_write_b64 v125, v[138:139] offset:96
    ds_read_b128 v[132:135], v126 offset:0
    ds_read_b128 v[140:143], v126 offset:3200
    v_pk_mul_f32 v[144:145], v[144:145], v[120:121] op_sel:[0,1] op_sel_hi:[1,1]
    v_pk_mul_f32 v[146:147], v[146:147], v[120:121] op_sel:[0,1] op_sel_hi:[1,1]
    v_pk_mul_f32 v[148:149], v[148:149], v[120:121] op_sel:[0,1] op_sel_hi:[1,1]
    v_pk_mul_f32 v[150:151], v[150:151], v[120:121] op_sel:[0,1] op_sel_hi:[1,1]
    v_cvt_pk_bf16_f32 v144, v144, v145
    v_cvt_pk_bf16_f32 v145, v146, v147
    v_cvt_pk_bf16_f32 v146, v148, v149
    v_cvt_pk_bf16_f32 v147, v150, v151
    s_waitcnt lgkmcnt(1)
    buffer_store_dwordx4 v[132:135], v127, s[16:19], s77 offen offset:0 sc1
    ds_write_b64 v125, v[144:145] offset:128
    ds_write_b64 v125, v[146:147] offset:160
    v_pk_mul_f32 v[152:153], v[152:153], v[120:121] op_sel:[0,1] op_sel_hi:[1,1]
    v_pk_mul_f32 v[154:155], v[154:155], v[120:121] op_sel:[0,1] op_sel_hi:[1,1]
    v_pk_mul_f32 v[156:157], v[156:157], v[120:121] op_sel:[0,1] op_sel_hi:[1,1]
    v_pk_mul_f32 v[158:159], v[158:159], v[120:121] op_sel:[0,1] op_sel_hi:[1,1]
    s_waitcnt lgkmcnt(2)
    buffer_store_dwordx4 v[140:143], v127, s[16:19], s77 offen offset:2048 sc1
    v_cvt_pk_bf16_f32 v152, v152, v153
    v_cvt_pk_bf16_f32 v153, v154, v155
    v_cvt_pk_bf16_f32 v154, v156, v157
    v_cvt_pk_bf16_f32 v155, v158, v159
    ds_write_b64 v125, v[152:153] offset:192
    ds_write_b64 v125, v[154:155] offset:224
    ds_read_b128 v[148:151], v126 offset:128
    ds_read_b128 v[156:159], v126 offset:3328
    v_mfma_f32_16x16x32_bf16 v[168:171], a[144:147], v[72:75], v[168:171]
    v_accvgpr_read_b32 v122, a196
    v_accvgpr_read_b32 v123, a197
    v_mfma_f32_16x16x32_bf16 v[168:171], a[148:151], v[76:79], v[168:171]
    v_add_f32 v122, v122, v123
    v_cvt_pk_bf16_f32 v80, v32, v33
    v_mfma_f32_16x16x32_bf16 v[172:175], a[152:155], v[72:75], v[172:175]
    v_rcp_f32 v123, v122
    v_mfma_f32_16x16x32_bf16 v[172:175], a[156:159], v[76:79], v[172:175]
    v_exp_f32 v34, v34
    v_mfma_f32_16x16x32_bf16 v[176:179], a[160:163], v[72:75], v[176:179]
    v_subrev_u32 v122, 0x2b800000, v122
    v_max_u32 v124, v124, v122
    v_mfma_f32_16x16x32_bf16 v[176:179], a[164:167], v[76:79], v[176:179]
    v_exp_f32 v35, v35
    v_mfma_f32_16x16x32_bf16 v[180:183], a[168:171], v[72:75], v[180:183]
    v_exp_f32 v36, v36
    v_mfma_f32_16x16x32_bf16 v[180:183], a[172:175], v[76:79], v[180:183]
    v_mul_f32 v160, v123, v160
    v_mul_f32 v161, v123, v161
    s_waitcnt lgkmcnt(1)
    buffer_store_dwordx4 v[148:151], v127, s[16:19], s77 offen offset:128 sc1
    s_waitcnt lgkmcnt(0)
    buffer_store_dwordx4 v[156:159], v127, s[16:19], s77 offen offset:2176 sc1
    v_mfma_f32_16x16x32_bf16 v[184:187], a[176:179], v[72:75], v[184:187]
    v_exp_f32 v37, v37
    v_mfma_f32_16x16x32_bf16 v[184:187], a[180:183], v[76:79], v[184:187]
    v_mul_f32 v162, v123, v162
    v_mul_f32 v163, v123, v163
    v_mfma_f32_16x16x32_bf16 v[188:191], a[184:187], v[72:75], v[188:191]
    v_mul_f32 v164, v123, v164
    v_mul_f32 v165, v123, v165
    v_mfma_f32_16x16x32_bf16 v[188:191], a[188:191], v[76:79], v[188:191]
    v_exp_f32 v38, v38
    v_mfma_f32_16x16x32_bf16 v[48:51], a[64:67], a[48:51], 0
    v_mul_f32 v166, v123, v166
    v_mul_f32 v167, v123, v167
    v_mfma_f32_16x16x32_bf16 v[48:51], a[68:71], a[52:55], v[48:51]
    ds_read_b128 a[64:67], v96 offset:32768
    v_cvt_pk_bf16_f32 v160, v160, v161
    v_mfma_f32_16x16x32_bf16 v[48:51], a[72:75], a[56:59], v[48:51]
    ds_read_b128 a[68:71], v97 offset:32768
    v_cvt_pk_bf16_f32 v161, v162, v163
    v_mfma_f32_16x16x32_bf16 v[48:51], a[76:79], a[60:63], v[48:51]
    ds_read_b128 a[72:75], v98 offset:32768
    v_cvt_pk_bf16_f32 v162, v164, v165
    v_mfma_f32_16x16x32_bf16 v[52:55], a[92:95], a[60:63], 0
    ds_read_b128 a[76:79], v99 offset:32768
    v_cvt_pk_bf16_f32 v163, v166, v167
    ds_write_b64 v125, v[160:161] offset:0
    ds_write_b64 v125, v[162:163] offset:32
    v_pk_mul_f32 v[168:169], v[168:169], v[122:123] op_sel:[0,1] op_sel_hi:[1,1]
    v_pk_mul_f32 v[170:171], v[170:171], v[122:123] op_sel:[0,1] op_sel_hi:[1,1]
    v_pk_mul_f32 v[172:173], v[172:173], v[122:123] op_sel:[0,1] op_sel_hi:[1,1]
    v_pk_mul_f32 v[174:175], v[174:175], v[122:123] op_sel:[0,1] op_sel_hi:[1,1]
    v_cvt_pk_bf16_f32 v168, v168, v169
    v_cvt_pk_bf16_f32 v169, v170, v171
    v_cvt_pk_bf16_f32 v170, v172, v173
    v_cvt_pk_bf16_f32 v171, v174, v175
    ds_write_b64 v125, v[168:169] offset:64
    ds_write_b64 v125, v[170:171] offset:96
    ds_read_b128 v[164:167], v126 offset:0
    ds_read_b128 v[172:175], v126 offset:3200
    v_pk_mul_f32 v[176:177], v[176:177], v[122:123] op_sel:[0,1] op_sel_hi:[1,1]
    v_pk_mul_f32 v[178:179], v[178:179], v[122:123] op_sel:[0,1] op_sel_hi:[1,1]
    v_pk_mul_f32 v[180:181], v[180:181], v[122:123] op_sel:[0,1] op_sel_hi:[1,1]
    v_pk_mul_f32 v[182:183], v[182:183], v[122:123] op_sel:[0,1] op_sel_hi:[1,1]
    v_cvt_pk_bf16_f32 v176, v176, v177
    v_cvt_pk_bf16_f32 v177, v178, v179
    v_cvt_pk_bf16_f32 v178, v180, v181
    v_cvt_pk_bf16_f32 v179, v182, v183
    s_waitcnt lgkmcnt(1)
    buffer_store_dwordx4 v[164:167], v127, s[16:19], s72 offen offset:0 sc1
    ds_write_b64 v125, v[176:177] offset:128
    ds_write_b64 v125, v[178:179] offset:160
    v_pk_mul_f32 v[184:185], v[184:185], v[122:123] op_sel:[0,1] op_sel_hi:[1,1]
    v_pk_mul_f32 v[186:187], v[186:187], v[122:123] op_sel:[0,1] op_sel_hi:[1,1]
    v_pk_mul_f32 v[188:189], v[188:189], v[122:123] op_sel:[0,1] op_sel_hi:[1,1]
    v_pk_mul_f32 v[190:191], v[190:191], v[122:123] op_sel:[0,1] op_sel_hi:[1,1]
    s_waitcnt lgkmcnt(2)
    buffer_store_dwordx4 v[172:175], v127, s[16:19], s72 offen offset:2048 sc1
    v_cvt_pk_bf16_f32 v184, v184, v185
    v_cvt_pk_bf16_f32 v185, v186, v187
    v_cvt_pk_bf16_f32 v186, v188, v189
    v_cvt_pk_bf16_f32 v187, v190, v191
    ds_write_b64 v125, v[184:185] offset:192
    ds_write_b64 v125, v[186:187] offset:224
    ds_read_b128 v[180:183], v126 offset:128
    ds_read_b128 v[188:191], v126 offset:3328
    v_mfma_f32_16x16x32_bf16 v[52:55], a[88:91], a[56:59], v[52:55]
    v_exp_f32 v39, v39
    v_mfma_f32_16x16x32_bf16 v[52:55], a[84:87], a[52:55], v[52:55]
    ds_read_b128 a[92:95], v99 offset:33792
    v_cvt_pk_bf16_f32 v81, v34, v35
    v_mfma_f32_16x16x32_bf16 v[52:55], a[80:83], a[48:51], v[52:55]
    ds_read_b128 a[88:91], v98 offset:33792
    v_cvt_pk_bf16_f32 v82, v36, v37
    v_mfma_f32_16x16x32_bf16 v[56:59], a[96:99], a[48:51], 0
    v_exp_f32 v40, v40
    v_mfma_f32_16x16x32_bf16 v[56:59], a[100:103], a[52:55], v[56:59]
    ds_read_b128 a[84:87], v97 offset:33792
    v_cvt_pk_bf16_f32 v83, v38, v39
    v_mfma_f32_16x16x32_bf16 v[56:59], a[104:107], a[56:59], v[56:59]
    v_exp_f32 v48, v48
    v_mfma_f32_16x16x32_bf16 v[56:59], a[108:111], a[60:63], v[56:59]
    ds_read_b128 a[80:83], v96 offset:33792
    ds_read_b64_tr_b16 a[128:129], v100 offset:16384
    v_mfma_f32_16x16x32_bf16 v[60:63], a[124:127], a[60:63], 0
    v_exp_f32 v41, v41
    s_waitcnt lgkmcnt(6)
    buffer_store_dwordx4 v[180:183], v127, s[16:19], s72 offen offset:128 sc1
    s_waitcnt lgkmcnt(5)
    buffer_store_dwordx4 v[188:191], v127, s[16:19], s72 offen offset:2176 sc1
    v_mfma_f32_16x16x32_bf16 v[60:63], a[120:123], a[56:59], v[60:63]
    ds_read_b128 a[96:99], v96 offset:34816
    v_cvt_pk_bf16_f32 v84, v40, v41
    v_mfma_f32_16x16x32_bf16 v[60:63], a[116:119], a[52:55], v[60:63]
    v_exp_f32 v49, v49
    v_mfma_f32_16x16x32_bf16 v[60:63], a[112:115], a[48:51], v[60:63]
    ds_read_b128 a[100:103], v97 offset:34816
    v_cvt_pk_bf16_f32 v88, v48, v49
    v_mfma_f32_16x16x32_bf16 v[0:3], a[64:67], a[32:35], 0
    v_exp_f32 v42, v42
    v_mfma_f32_16x16x32_bf16 v[0:3], a[68:71], a[36:39], v[0:3]
    ds_read_b128 a[104:107], v98 offset:34816
    ds_read_b64_tr_b16 a[130:131], v100 offset:17408
    v_mfma_f32_16x16x32_bf16 v[0:3], a[72:75], a[40:43], v[0:3]
    v_exp_f32 v50, v50
    v_mfma_f32_16x16x32_bf16 v[0:3], a[76:79], a[44:47], v[0:3]
    s_waitcnt lgkmcnt(4)
    ds_read_b128 a[108:111], v99 offset:34816
    ds_read_b64_tr_b16 a[132:133], v100 offset:18432
    v_mfma_f32_16x16x32_bf16 v[4:7], a[92:95], a[44:47], 0
    ds_read_b128 a[124:127], v99 offset:35840
    v_exp_f32 v43, v43
    v_mfma_f32_16x16x32_bf16 v[4:7], a[88:91], a[40:43], v[4:7]
    ds_read_b128 a[120:123], v98 offset:35840
    v_exp_f32 v51, v51
    v_mfma_f32_16x16x32_bf16 v[4:7], a[84:87], a[36:39], v[4:7]
    ds_read_b128 a[116:119], v97 offset:35840
    v_exp_f32 v44, v44
    v_mfma_f32_16x16x32_bf16 v[4:7], a[80:83], a[32:35], v[4:7]
    s_waitcnt lgkmcnt(7)
    ds_read_b128 a[112:115], v96 offset:35840
    v_exp_f32 v52, v52
    v_mfma_f32_16x16x32_bf16 v[8:11], a[96:99], a[32:35], 0
    v_exp_f32 v45, v45
    v_mfma_f32_16x16x32_bf16 v[8:11], a[100:103], a[36:39], v[8:11]
    s_waitcnt lgkmcnt(6)
    ds_read_b64_tr_b16 a[134:135], v100 offset:19456
    ds_read_b64_tr_b16 a[136:137], v101 offset:16384
    v_exp_f32 v53, v53
    v_mfma_f32_16x16x32_bf16 v[8:11], a[104:107], a[40:43], v[8:11]
    s_waitcnt lgkmcnt(7)
    ds_read_b64_tr_b16 a[138:139], v101 offset:17408
    ds_read_b64_tr_b16 a[140:141], v101 offset:18432
    v_exp_f32 v46, v46
    v_mfma_f32_16x16x32_bf16 v[8:11], a[108:111], a[44:47], v[8:11]
    s_waitcnt lgkmcnt(7)
    ds_read_b64_tr_b16 a[142:143], v101 offset:19456
    ds_read_b64_tr_b16 a[144:145], v102 offset:16384
    v_cvt_pk_bf16_f32 v85, v42, v43
    v_exp_f32 v54, v54
    v_mfma_f32_16x16x32_bf16 v[12:15], a[124:127], a[44:47], 0
    s_waitcnt lgkmcnt(8)
    ds_read_b64_tr_b16 a[146:147], v102 offset:17408
    ds_read_b64_tr_b16 a[148:149], v102 offset:18432
    v_exp_f32 v47, v47
    v_cvt_pk_bf16_f32 v86, v44, v45
    v_mfma_f32_16x16x32_bf16 v[12:15], a[120:123], a[40:43], v[12:15]
    s_waitcnt lgkmcnt(9)
    ds_read_b64_tr_b16 a[150:151], v102 offset:19456
    ds_read_b64_tr_b16 a[152:153], v103 offset:16384
    v_cvt_pk_bf16_f32 v87, v46, v47
    v_exp_f32 v55, v55
    v_mfma_f32_16x16x32_bf16 v[12:15], a[116:119], a[36:39], v[12:15]
    s_waitcnt lgkmcnt(10)
    ds_read_b64_tr_b16 a[154:155], v103 offset:17408
    ds_read_b64_tr_b16 a[156:157], v103 offset:18432
    v_mfma_f32_16x16x32_bf16 v[12:15], a[112:115], a[32:35], v[12:15]
    ds_read_b64_tr_b16 a[158:159], v103 offset:19456
    ds_read_b64_tr_b16 a[160:161], v104 offset:16384
    v_exp_f32 v56, v56
    v_mfma_f32_16x16x32_bf16 v[192:195], a[128:131], v[80:83], v[192:195]
    s_waitcnt lgkmcnt(13)
    ds_read_b64_tr_b16 a[162:163], v104 offset:17408
    ds_read_b64_tr_b16 a[164:165], v104 offset:18432
    v_mfma_f32_16x16x32_bf16 v[192:195], a[132:135], v[84:87], v[192:195]
    s_waitcnt lgkmcnt(13)
    ds_read_b64_tr_b16 a[166:167], v104 offset:19456
    ds_read_b64_tr_b16 a[168:169], v105 offset:16384
    v_exp_f32 v57, v57
    v_mfma_f32_16x16x32_bf16 v[196:199], a[136:139], v[80:83], v[196:199]
    s_waitcnt lgkmcnt(13)
    ds_read_b64_tr_b16 a[170:171], v105 offset:17408
    ds_read_b64_tr_b16 a[172:173], v105 offset:18432
    v_mfma_f32_16x16x32_bf16 v[196:199], a[140:143], v[84:87], v[196:199]
    s_waitcnt lgkmcnt(13)
    ds_read_b64_tr_b16 a[174:175], v105 offset:19456
    ds_read_b64_tr_b16 a[176:177], v106 offset:16384
    v_exp_f32 v58, v58
    v_mfma_f32_16x16x32_bf16 v[200:203], a[144:147], v[80:83], v[200:203]
    s_waitcnt lgkmcnt(13)
    ds_read_b64_tr_b16 a[178:179], v106 offset:17408
    ds_read_b64_tr_b16 a[180:181], v106 offset:18432
    v_mfma_f32_16x16x32_bf16 v[200:203], a[148:151], v[84:87], v[200:203]
    s_waitcnt lgkmcnt(13)
    ds_read_b64_tr_b16 a[182:183], v106 offset:19456
    ds_read_b64_tr_b16 a[184:185], v107 offset:16384
    v_exp_f32 v59, v59
    v_mfma_f32_16x16x32_bf16 v[204:207], a[152:155], v[80:83], v[204:207]
    s_waitcnt lgkmcnt(13)
    ds_read_b64_tr_b16 a[186:187], v107 offset:17408
    ds_read_b64_tr_b16 a[188:189], v107 offset:18432
    v_mfma_f32_16x16x32_bf16 v[204:207], a[156:159], v[84:87], v[204:207]
    s_waitcnt lgkmcnt(13)
    ds_read_b64_tr_b16 a[190:191], v107 offset:19456
    v_exp_f32 v60, v60
    v_mfma_f32_16x16x32_bf16 v[208:211], a[160:163], v[80:83], v[208:211]
    s_waitcnt lgkmcnt(12)
    v_cvt_pk_bf16_f32 v89, v50, v51
    v_cvt_pk_bf16_f32 v90, v52, v53
    v_mfma_f32_16x16x32_bf16 v[208:211], a[164:167], v[84:87], v[208:211]
    s_waitcnt lgkmcnt(10)
    v_exp_f32 v61, v61
    v_mfma_f32_16x16x32_bf16 v[212:215], a[168:171], v[80:83], v[212:215]
    s_waitcnt lgkmcnt(8)
    v_cvt_pk_bf16_f32 v91, v54, v55
    v_cvt_pk_bf16_f32 v92, v56, v57
    v_mfma_f32_16x16x32_bf16 v[212:215], a[172:175], v[84:87], v[212:215]
    s_waitcnt lgkmcnt(6)
    v_exp_f32 v62, v62
    v_mfma_f32_16x16x32_bf16 v[216:219], a[176:179], v[80:83], v[216:219]
    s_waitcnt lgkmcnt(4)
    v_cvt_pk_bf16_f32 v93, v58, v59
    v_cvt_pk_bf16_f32 v94, v60, v61
    v_mfma_f32_16x16x32_bf16 v[216:219], a[180:183], v[84:87], v[216:219]
    s_waitcnt lgkmcnt(2)
    v_exp_f32 v63, v63
    v_mfma_f32_16x16x32_bf16 v[220:223], a[184:187], v[80:83], v[220:223]
    s_waitcnt lgkmcnt(0)
    v_cvt_pk_bf16_f32 v95, v62, v63
    v_mfma_f32_16x16x32_bf16 v[220:223], a[188:191], v[84:87], v[220:223]
    v_exp_f32 v0, v0
    v_smfmac_f32_16x16x64_bf16 a[200:203], a[208:211], v[80:87], v114
    v_exp_f32 v1, v1
    v_mfma_f32_16x16x32_bf16 v[224:227], a[128:131], v[88:91], v[224:227]
    v_exp_f32 v2, v2
    v_mfma_f32_16x16x32_bf16 v[224:227], a[132:135], v[92:95], v[224:227]
    v_exp_f32 v3, v3
    v_mfma_f32_16x16x32_bf16 v[228:231], a[136:139], v[88:91], v[228:231]
    v_exp_f32 v4, v4
    v_mfma_f32_16x16x32_bf16 v[228:231], a[140:143], v[92:95], v[228:231]
    v_exp_f32 v5, v5
    v_mfma_f32_16x16x32_bf16 v[232:235], a[144:147], v[88:91], v[232:235]
    v_exp_f32 v6, v6
    v_mfma_f32_16x16x32_bf16 v[232:235], a[148:151], v[92:95], v[232:235]
    v_exp_f32 v7, v7
    v_mfma_f32_16x16x32_bf16 v[236:239], a[152:155], v[88:91], v[236:239]
    v_exp_f32 v8, v8
    v_mfma_f32_16x16x32_bf16 v[236:239], a[156:159], v[92:95], v[236:239]
    v_exp_f32 v9, v9
    v_mfma_f32_16x16x32_bf16 v[240:243], a[160:163], v[88:91], v[240:243]
    v_exp_f32 v10, v10
    v_mfma_f32_16x16x32_bf16 v[240:243], a[164:167], v[92:95], v[240:243]
    v_exp_f32 v11, v11
    v_mfma_f32_16x16x32_bf16 v[244:247], a[168:171], v[88:91], v[244:247]
    v_exp_f32 v12, v12
    v_mfma_f32_16x16x32_bf16 v[244:247], a[172:175], v[92:95], v[244:247]
    v_cvt_pk_bf16_f32 v64, v0, v1
    v_cvt_pk_bf16_f32 v65, v2, v3
    v_mfma_f32_16x16x32_bf16 v[248:251], a[176:179], v[88:91], v[248:251]
    ds_read_b64_tr_b16 a[128:129], v100 offset:32768
    v_cvt_pk_bf16_f32 v66, v4, v5
    v_mfma_f32_16x16x32_bf16 v[248:251], a[180:183], v[92:95], v[248:251]
    v_exp_f32 v13, v13
    v_mfma_f32_16x16x32_bf16 v[252:255], a[184:187], v[88:91], v[252:255]
    ds_read_b64_tr_b16 a[130:131], v100 offset:33792
    v_cvt_pk_bf16_f32 v67, v6, v7
    v_mfma_f32_16x16x32_bf16 v[252:255], a[188:191], v[92:95], v[252:255]
    ds_read_b64_tr_b16 a[132:133], v100 offset:34816
    v_cvt_pk_bf16_f32 v68, v8, v9
    v_smfmac_f32_16x16x64_bf16 a[204:207], a[208:211], v[88:95], v114
    ds_read_b64_tr_b16 a[134:135], v100 offset:35840
    v_cvt_pk_bf16_f32 v69, v10, v11
    v_mfma_f32_16x16x32_bf16 v[16:19], a[64:67], a[48:51], 0
    ds_read_b64_tr_b16 a[136:137], v101 offset:32768
    v_cvt_pk_bf16_f32 v70, v12, v13
    v_mfma_f32_16x16x32_bf16 v[16:19], a[68:71], a[52:55], v[16:19]
    v_exp_f32 v14, v14
    v_mfma_f32_16x16x32_bf16 v[16:19], a[72:75], a[56:59], v[16:19]
    ds_read_b64_tr_b16 a[138:139], v101 offset:33792
    ds_read_b64_tr_b16 a[140:141], v101 offset:34816
    v_mfma_f32_16x16x32_bf16 v[16:19], a[76:79], a[60:63], v[16:19]
    ds_read_b64_tr_b16 a[142:143], v101 offset:35840
    v_mfma_f32_16x16x32_bf16 v[20:23], a[92:95], a[60:63], 0
    ds_read_b64_tr_b16 a[144:145], v102 offset:32768
    ds_read_b64_tr_b16 a[146:147], v102 offset:33792
    v_mfma_f32_16x16x32_bf16 v[20:23], a[88:91], a[56:59], v[20:23]
    v_exp_f32 v15, v15
    v_mfma_f32_16x16x32_bf16 v[20:23], a[84:87], a[52:55], v[20:23]
    ds_read_b64_tr_b16 a[148:149], v102 offset:34816
    v_cvt_pk_bf16_f32 v71, v14, v15
    v_mfma_f32_16x16x32_bf16 v[20:23], a[80:83], a[48:51], v[20:23]
    ds_read_b64_tr_b16 a[150:151], v102 offset:35840
    ds_read_b64_tr_b16 a[152:153], v103 offset:32768
    v_mfma_f32_16x16x32_bf16 v[24:27], a[96:99], a[48:51], 0
    ds_read_b64_tr_b16 a[154:155], v103 offset:33792
    v_mfma_f32_16x16x32_bf16 v[24:27], a[100:103], a[52:55], v[24:27]
    ds_read_b64_tr_b16 a[156:157], v103 offset:34816
    ds_read_b64_tr_b16 a[158:159], v103 offset:35840
    v_mfma_f32_16x16x32_bf16 v[24:27], a[104:107], a[56:59], v[24:27]
    v_exp_f32 v16, v16
    v_mfma_f32_16x16x32_bf16 v[24:27], a[108:111], a[60:63], v[24:27]
    ds_read_b64_tr_b16 a[160:161], v104 offset:32768
    ds_read_b64_tr_b16 a[162:163], v104 offset:33792
    v_mfma_f32_16x16x32_bf16 v[28:31], a[124:127], a[60:63], 0
    ds_read_b64_tr_b16 a[164:165], v104 offset:34816
    v_mfma_f32_16x16x32_bf16 v[28:31], a[120:123], a[56:59], v[28:31]
    v_exp_f32 v17, v17
    v_mfma_f32_16x16x32_bf16 v[28:31], a[116:119], a[52:55], v[28:31]
    ds_read_b64_tr_b16 a[166:167], v104 offset:35840
    ds_read_b64_tr_b16 a[168:169], v105 offset:32768
    v_mfma_f32_16x16x32_bf16 v[28:31], a[112:115], a[48:51], v[28:31]
    s_waitcnt lgkmcnt(8)
    ds_read_b64_tr_b16 a[170:171], v105 offset:33792
    v_cvt_pk_bf16_f32 v72, v16, v17
    v_mfma_f32_16x16x32_bf16 v[192:195], a[128:131], v[64:67], v[192:195]
    ds_read_b64_tr_b16 a[172:173], v105 offset:34816
    ds_read_b64_tr_b16 a[174:175], v105 offset:35840
    v_mfma_f32_16x16x32_bf16 v[192:195], a[132:135], v[68:71], v[192:195]
    v_exp_f32 v18, v18
    v_mfma_f32_16x16x32_bf16 v[196:199], a[136:139], v[64:67], v[196:199]
    ds_read_b64_tr_b16 a[176:177], v106 offset:32768
    ds_read_b64_tr_b16 a[178:179], v106 offset:33792
    v_mfma_f32_16x16x32_bf16 v[196:199], a[140:143], v[68:71], v[196:199]
    ds_read_b64_tr_b16 a[180:181], v106 offset:34816
    ds_read_b64_tr_b16 a[182:183], v106 offset:35840
    v_mfma_f32_16x16x32_bf16 v[200:203], a[144:147], v[64:67], v[200:203]
    v_exp_f32 v19, v19
    v_mfma_f32_16x16x32_bf16 v[200:203], a[148:151], v[68:71], v[200:203]
    s_waitcnt lgkmcnt(9)
    ds_read_b64_tr_b16 a[184:185], v107 offset:32768
    ds_read_b64_tr_b16 a[186:187], v107 offset:33792
    v_mfma_f32_16x16x32_bf16 v[204:207], a[152:155], v[64:67], v[204:207]
    ds_read_b64_tr_b16 a[188:189], v107 offset:34816
    ds_read_b64_tr_b16 a[190:191], v107 offset:35840
    v_mfma_f32_16x16x32_bf16 v[204:207], a[156:159], v[68:71], v[204:207]
    v_exp_f32 v20, v20
    v_mfma_f32_16x16x32_bf16 v[208:211], a[160:163], v[64:67], v[208:211]
    s_waitcnt lgkmcnt(8)
    v_exp_f32 v21, v21
    v_mfma_f32_16x16x32_bf16 v[208:211], a[164:167], v[68:71], v[208:211]
    ds_read_b128 a[64:67], v96 offset:49152
    v_cvt_pk_bf16_f32 v73, v18, v19
    v_mfma_f32_16x16x32_bf16 v[212:215], a[168:171], v[64:67], v[212:215]
    ds_read_b128 a[68:71], v97 offset:49152
    v_cvt_pk_bf16_f32 v74, v20, v21
    v_mfma_f32_16x16x32_bf16 v[212:215], a[172:175], v[68:71], v[212:215]
    s_waitcnt lgkmcnt(6)
    ds_read_b128 a[72:75], v98 offset:49152
    v_exp_f32 v22, v22
    v_mfma_f32_16x16x32_bf16 v[216:219], a[176:179], v[64:67], v[216:219]
    ds_read_b128 a[76:79], v99 offset:49152
    v_mfma_f32_16x16x32_bf16 v[216:219], a[180:183], v[68:71], v[216:219]
    s_waitcnt lgkmcnt(6)
    ds_read_b128 a[92:95], v99 offset:50176
    v_exp_f32 v23, v23
    v_mfma_f32_16x16x32_bf16 v[220:223], a[184:187], v[64:67], v[220:223]
    s_waitcnt lgkmcnt(5)
    ds_read_b128 a[88:91], v98 offset:50176
    v_cvt_pk_bf16_f32 v75, v22, v23
    v_mfma_f32_16x16x32_bf16 v[220:223], a[188:191], v[68:71], v[220:223]
    ds_read_b128 a[84:87], v97 offset:50176
    v_exp_f32 v24, v24
    v_smfmac_f32_16x16x64_bf16 a[200:203], a[208:211], v[64:71], v114
    s_waitcnt lgkmcnt(6)
    ds_read_b128 a[80:83], v96 offset:50176
    v_mfma_f32_16x16x32_bf16 v[32:35], a[64:67], a[32:35], 0
    s_waitcnt lgkmcnt(6)
    ds_read_b128 a[96:99], v96 offset:51200
    v_exp_f32 v25, v25
    v_mfma_f32_16x16x32_bf16 v[32:35], a[68:71], a[36:39], v[32:35]
    s_waitcnt lgkmcnt(6)
    ds_read_b128 a[100:103], v97 offset:51200
    v_cvt_pk_bf16_f32 v76, v24, v25
    v_mfma_f32_16x16x32_bf16 v[32:35], a[72:75], a[40:43], v[32:35]
    s_waitcnt lgkmcnt(6)
    ds_read_b128 a[104:107], v98 offset:51200
    v_exp_f32 v26, v26
    v_mfma_f32_16x16x32_bf16 v[32:35], a[76:79], a[44:47], v[32:35]
    s_waitcnt lgkmcnt(6)
    ds_read_b128 a[108:111], v99 offset:51200
    v_mfma_f32_16x16x32_bf16 v[36:39], a[92:95], a[44:47], 0
    s_waitcnt lgkmcnt(6)
    ds_read_b128 a[124:127], v99 offset:52224
    v_exp_f32 v27, v27
    v_mfma_f32_16x16x32_bf16 v[36:39], a[88:91], a[40:43], v[36:39]
    s_waitcnt lgkmcnt(6)
    ds_read_b128 a[120:123], v98 offset:52224
    v_cvt_pk_bf16_f32 v77, v26, v27
    v_mfma_f32_16x16x32_bf16 v[36:39], a[84:87], a[36:39], v[36:39]
    s_waitcnt lgkmcnt(6)
    ds_read_b128 a[116:119], v97 offset:52224
    v_exp_f32 v28, v28
    v_mfma_f32_16x16x32_bf16 v[36:39], a[80:83], a[32:35], v[36:39]
    s_waitcnt lgkmcnt(6)
    ds_read_b128 a[112:115], v96 offset:52224
    v_mfma_f32_16x16x32_bf16 v[40:43], a[96:99], a[32:35], 0
    s_waitcnt lgkmcnt(6)
    v_exp_f32 v29, v29
    v_mfma_f32_16x16x32_bf16 v[40:43], a[100:103], a[36:39], v[40:43]
    s_waitcnt lgkmcnt(5)
    v_exp_f32 v30, v30
    v_mfma_f32_16x16x32_bf16 v[40:43], a[104:107], a[40:43], v[40:43]
    s_waitcnt lgkmcnt(4)
    v_exp_f32 v31, v31
    v_mfma_f32_16x16x32_bf16 v[40:43], a[108:111], a[44:47], v[40:43]
    s_waitcnt lgkmcnt(3)
    v_cvt_pk_bf16_f32 v78, v28, v29
    v_cvt_pk_bf16_f32 v79, v30, v31
    v_mfma_f32_16x16x32_bf16 v[44:47], a[124:127], a[44:47], v[116:119]
    s_waitcnt lgkmcnt(2)
    v_exp_f32 v32, v32
    v_mfma_f32_16x16x32_bf16 v[44:47], a[120:123], a[40:43], v[44:47]
    s_waitcnt lgkmcnt(1)
    v_exp_f32 v33, v33
    v_mfma_f32_16x16x32_bf16 v[44:47], a[116:119], a[36:39], v[44:47]
    s_waitcnt lgkmcnt(0)
    v_exp_f32 v34, v34
    v_mfma_f32_16x16x32_bf16 v[44:47], a[112:115], a[32:35], v[44:47]
    v_exp_f32 v35, v35
    v_mfma_f32_16x16x32_bf16 v[224:227], a[128:131], v[72:75], v[224:227]
    v_exp_f32 v36, v36
    v_mfma_f32_16x16x32_bf16 v[224:227], a[132:135], v[76:79], v[224:227]
    v_exp_f32 v37, v37
    v_mfma_f32_16x16x32_bf16 v[228:231], a[136:139], v[72:75], v[228:231]
    v_exp_f32 v38, v38
    v_mfma_f32_16x16x32_bf16 v[228:231], a[140:143], v[76:79], v[228:231]
    v_exp_f32 v39, v39
    v_mfma_f32_16x16x32_bf16 v[232:235], a[144:147], v[72:75], v[232:235]
    v_exp_f32 v40, v40
    v_mfma_f32_16x16x32_bf16 v[232:235], a[148:151], v[76:79], v[232:235]
    v_exp_f32 v41, v41
    v_mfma_f32_16x16x32_bf16 v[236:239], a[152:155], v[72:75], v[236:239]
    v_exp_f32 v42, v42
    v_mfma_f32_16x16x32_bf16 v[236:239], a[156:159], v[76:79], v[236:239]
    v_exp_f32 v43, v43
    v_mfma_f32_16x16x32_bf16 v[240:243], a[160:163], v[72:75], v[240:243]
    v_exp_f32 v44, v44
    v_mfma_f32_16x16x32_bf16 v[240:243], a[164:167], v[76:79], v[240:243]
    v_cvt_pk_bf16_f32 v80, v32, v33
    v_cvt_pk_bf16_f32 v81, v34, v35
    v_mfma_f32_16x16x32_bf16 v[244:247], a[168:171], v[72:75], v[244:247]
    v_exp_f32 v45, v45
    v_mfma_f32_16x16x32_bf16 v[244:247], a[172:175], v[76:79], v[244:247]
    ds_read_b64_tr_b16 a[128:129], v100 offset:49152
    v_cvt_pk_bf16_f32 v82, v36, v37
    v_mfma_f32_16x16x32_bf16 v[248:251], a[176:179], v[72:75], v[248:251]
    ds_read_b64_tr_b16 a[130:131], v100 offset:50176
    v_cvt_pk_bf16_f32 v83, v38, v39
    v_mfma_f32_16x16x32_bf16 v[248:251], a[180:183], v[76:79], v[248:251]
    ds_read_b64_tr_b16 a[132:133], v100 offset:51200
    v_cvt_pk_bf16_f32 v84, v40, v41
    v_mfma_f32_16x16x32_bf16 v[252:255], a[184:187], v[72:75], v[252:255]
    v_exp_f32 v46, v46
    v_mfma_f32_16x16x32_bf16 v[252:255], a[188:191], v[76:79], v[252:255]
    ds_read_b64_tr_b16 a[134:135], v100 offset:52224
    v_cvt_pk_bf16_f32 v85, v42, v43
    v_smfmac_f32_16x16x64_bf16 a[204:207], a[208:211], v[72:79], v114
    ds_read_b64_tr_b16 a[136:137], v101 offset:49152
    v_cvt_pk_bf16_f32 v86, v44, v45
    v_mfma_f32_16x16x32_bf16 v[48:51], a[64:67], a[48:51], 0
    ds_read_b64_tr_b16 a[138:139], v101 offset:50176
    ds_read_b64_tr_b16 a[140:141], v101 offset:51200
    v_mfma_f32_16x16x32_bf16 v[48:51], a[68:71], a[52:55], v[48:51]
    v_exp_f32 v47, v47
    v_mfma_f32_16x16x32_bf16 v[48:51], a[72:75], a[56:59], v[48:51]
    ds_read_b64_tr_b16 a[142:143], v101 offset:52224
    v_cvt_pk_bf16_f32 v87, v46, v47
    v_mfma_f32_16x16x32_bf16 v[48:51], a[76:79], a[60:63], v[48:51]
    ds_read_b64_tr_b16 a[144:145], v102 offset:49152
    ds_read_b64_tr_b16 a[146:147], v102 offset:50176
    v_mfma_f32_16x16x32_bf16 v[52:55], a[92:95], a[60:63], 0
    ds_read_b64_tr_b16 a[148:149], v102 offset:51200
    v_mfma_f32_16x16x32_bf16 v[52:55], a[88:91], a[56:59], v[52:55]
    ds_read_b64_tr_b16 a[150:151], v102 offset:52224
    ds_read_b64_tr_b16 a[152:153], v103 offset:49152
    v_mfma_f32_16x16x32_bf16 v[52:55], a[84:87], a[52:55], v[52:55]
    ds_read_b64_tr_b16 a[154:155], v103 offset:50176
    v_mfma_f32_16x16x32_bf16 v[52:55], a[80:83], a[48:51], v[52:55]
    ds_read_b64_tr_b16 a[156:157], v103 offset:51200
    ds_read_b64_tr_b16 a[158:159], v103 offset:52224
    v_mfma_f32_16x16x32_bf16 v[56:59], a[96:99], a[48:51], 0
    v_exp_f32 v48, v48
    v_mfma_f32_16x16x32_bf16 v[56:59], a[100:103], a[52:55], v[56:59]
    v_exp_f32 v49, v49
    v_mfma_f32_16x16x32_bf16 v[56:59], a[104:107], a[56:59], v[56:59]
    v_exp_f32 v50, v50
    v_mfma_f32_16x16x32_bf16 v[56:59], a[108:111], a[60:63], v[56:59]
    v_exp_f32 v51, v51
    v_mfma_f32_16x16x32_bf16 v[60:63], a[124:127], a[60:63], v[116:119]
    v_exp_f32 v52, v52
    v_mfma_f32_16x16x32_bf16 v[60:63], a[120:123], a[56:59], v[60:63]
    v_exp_f32 v53, v53
    v_mfma_f32_16x16x32_bf16 v[60:63], a[116:119], a[52:55], v[60:63]
    v_exp_f32 v54, v54
    v_mfma_f32_16x16x32_bf16 v[60:63], a[112:115], a[48:51], v[60:63]
    v_exp_f32 v55, v55
    v_smfmac_f32_16x16x64_bf16 a[200:203], a[208:211], v[80:87], v114
    s_waitcnt lgkmcnt(0)
    ds_read_b64_tr_b16 a[160:161], v104 offset:49152
    v_exp_f32 v56, v56
    v_mfma_f32_16x16x32_bf16 v[192:195], a[128:131], v[80:83], v[192:195]
    ds_read_b64_tr_b16 a[162:163], v104 offset:50176
    ds_read_b64_tr_b16 a[164:165], v104 offset:51200
    v_exp_f32 v57, v57
    v_mfma_f32_16x16x32_bf16 v[192:195], a[132:135], v[84:87], v[192:195]
    ds_read_b64_tr_b16 a[166:167], v104 offset:52224
    ds_read_b64_tr_b16 a[168:169], v105 offset:49152
    v_mfma_f32_16x16x32_bf16 v[196:199], a[136:139], v[80:83], v[196:199]
    ds_read_b64_tr_b16 a[170:171], v105 offset:50176
    ds_read_b64_tr_b16 a[172:173], v105 offset:51200
    v_exp_f32 v58, v58
    v_mfma_f32_16x16x32_bf16 v[196:199], a[140:143], v[84:87], v[196:199]
    ds_read_b64_tr_b16 a[174:175], v105 offset:52224
    ds_read_b64_tr_b16 a[176:177], v106 offset:49152
    v_mfma_f32_16x16x32_bf16 v[200:203], a[144:147], v[80:83], v[200:203]
    ds_read_b64_tr_b16 a[178:179], v106 offset:50176
    ds_read_b64_tr_b16 a[180:181], v106 offset:51200
    v_exp_f32 v59, v59
    v_mfma_f32_16x16x32_bf16 v[200:203], a[148:151], v[84:87], v[200:203]
    ds_read_b64_tr_b16 a[182:183], v106 offset:52224
    ds_read_b64_tr_b16 a[184:185], v107 offset:49152
    v_mfma_f32_16x16x32_bf16 v[204:207], a[152:155], v[80:83], v[204:207]
    ds_read_b64_tr_b16 a[186:187], v107 offset:50176
    ds_read_b64_tr_b16 a[188:189], v107 offset:51200
    v_exp_f32 v60, v60
    v_cvt_pk_bf16_f32 v88, v48, v49
    v_mfma_f32_16x16x32_bf16 v[204:207], a[156:159], v[84:87], v[204:207]
    s_waitcnt lgkmcnt(13)
    ds_read_b64_tr_b16 a[190:191], v107 offset:52224
    v_cvt_pk_bf16_f32 v89, v50, v51
    v_mfma_f32_16x16x32_bf16 v[208:211], a[160:163], v[80:83], v[208:211]
    s_waitcnt lgkmcnt(12)
    v_exp_f32 v61, v61
    v_cvt_pk_bf16_f32 v90, v52, v53
    v_mfma_f32_16x16x32_bf16 v[208:211], a[164:167], v[84:87], v[208:211]
    s_waitcnt lgkmcnt(10)
    v_cvt_pk_bf16_f32 v91, v54, v55
    v_cvt_pk_bf16_f32 v92, v56, v57
    v_mfma_f32_16x16x32_bf16 v[212:215], a[168:171], v[80:83], v[212:215]
    s_waitcnt lgkmcnt(8)
    v_exp_f32 v62, v62
    v_mfma_f32_16x16x32_bf16 v[212:215], a[172:175], v[84:87], v[212:215]
    s_waitcnt lgkmcnt(6)
    v_cvt_pk_bf16_f32 v93, v58, v59
    v_cvt_pk_bf16_f32 v94, v60, v61
    v_mfma_f32_16x16x32_bf16 v[216:219], a[176:179], v[80:83], v[216:219]
    s_waitcnt lgkmcnt(4)
    v_exp_f32 v63, v63
    v_mfma_f32_16x16x32_bf16 v[216:219], a[180:183], v[84:87], v[216:219]
    s_waitcnt lgkmcnt(2)
    v_cvt_pk_bf16_f32 v95, v62, v63
    v_accvgpr_read_b32 v120, a200
    v_mfma_f32_16x16x32_bf16 v[220:223], a[184:187], v[80:83], v[220:223]
    s_waitcnt lgkmcnt(0)
    v_accvgpr_read_b32 v121, a201
    v_add_f32 v120, v120, v121
    v_mfma_f32_16x16x32_bf16 v[220:223], a[188:191], v[84:87], v[220:223]
    v_rcp_f32 v121, v120
    v_smfmac_f32_16x16x64_bf16 a[204:207], a[208:211], v[88:95], v114
    v_subrev_u32 v120, 0x2b800000, v120
    v_max_u32 v124, v124, v120
    v_mfma_f32_16x16x32_bf16 v[224:227], a[128:131], v[88:91], v[224:227]
    v_mul_f32 v192, v121, v192
    v_mul_f32 v193, v121, v193
    v_mfma_f32_16x16x32_bf16 v[224:227], a[132:135], v[92:95], v[224:227]
    v_mul_f32 v194, v121, v194
    v_mul_f32 v195, v121, v195
    v_mfma_f32_16x16x32_bf16 v[228:231], a[136:139], v[88:91], v[228:231]
    v_mul_f32 v196, v121, v196
    v_mul_f32 v197, v121, v197
    v_mfma_f32_16x16x32_bf16 v[228:231], a[140:143], v[92:95], v[228:231]
    v_mul_f32 v198, v121, v198
    v_mul_f32 v199, v121, v199
    v_cvt_pk_bf16_f32 v192, v192, v193
    v_cvt_pk_bf16_f32 v193, v194, v195
    v_cvt_pk_bf16_f32 v194, v196, v197
    v_cvt_pk_bf16_f32 v195, v198, v199
    ds_write_b64 v125, v[192:193] offset:0
    ds_write_b64 v125, v[194:195] offset:32
    v_pk_mul_f32 v[200:201], v[200:201], v[120:121] op_sel:[0,1] op_sel_hi:[1,1]
    v_pk_mul_f32 v[202:203], v[202:203], v[120:121] op_sel:[0,1] op_sel_hi:[1,1]
    v_pk_mul_f32 v[204:205], v[204:205], v[120:121] op_sel:[0,1] op_sel_hi:[1,1]
    v_pk_mul_f32 v[206:207], v[206:207], v[120:121] op_sel:[0,1] op_sel_hi:[1,1]
    v_cvt_pk_bf16_f32 v200, v200, v201
    v_cvt_pk_bf16_f32 v201, v202, v203
    v_cvt_pk_bf16_f32 v202, v204, v205
    v_cvt_pk_bf16_f32 v203, v206, v207
    ds_write_b64 v125, v[200:201] offset:64
    ds_write_b64 v125, v[202:203] offset:96
    ds_read_b128 v[196:199], v126 offset:0
    ds_read_b128 v[204:207], v126 offset:3200
    v_pk_mul_f32 v[208:209], v[208:209], v[120:121] op_sel:[0,1] op_sel_hi:[1,1]
    v_pk_mul_f32 v[210:211], v[210:211], v[120:121] op_sel:[0,1] op_sel_hi:[1,1]
    v_pk_mul_f32 v[212:213], v[212:213], v[120:121] op_sel:[0,1] op_sel_hi:[1,1]
    v_pk_mul_f32 v[214:215], v[214:215], v[120:121] op_sel:[0,1] op_sel_hi:[1,1]
    v_cvt_pk_bf16_f32 v208, v208, v209
    v_cvt_pk_bf16_f32 v209, v210, v211
    v_cvt_pk_bf16_f32 v210, v212, v213
    v_cvt_pk_bf16_f32 v211, v214, v215
    s_waitcnt lgkmcnt(1)
    buffer_store_dwordx4 v[196:199], v127, s[16:19], s73 offen offset:0 sc1
    ds_write_b64 v125, v[208:209] offset:128
    ds_write_b64 v125, v[210:211] offset:160
    v_pk_mul_f32 v[216:217], v[216:217], v[120:121] op_sel:[0,1] op_sel_hi:[1,1]
    v_pk_mul_f32 v[218:219], v[218:219], v[120:121] op_sel:[0,1] op_sel_hi:[1,1]
    v_pk_mul_f32 v[220:221], v[220:221], v[120:121] op_sel:[0,1] op_sel_hi:[1,1]
    v_pk_mul_f32 v[222:223], v[222:223], v[120:121] op_sel:[0,1] op_sel_hi:[1,1]
    s_waitcnt lgkmcnt(2)
    buffer_store_dwordx4 v[204:207], v127, s[16:19], s73 offen offset:2048 sc1
    v_cvt_pk_bf16_f32 v216, v216, v217
    v_cvt_pk_bf16_f32 v217, v218, v219
    v_cvt_pk_bf16_f32 v218, v220, v221
    v_cvt_pk_bf16_f32 v219, v222, v223
    ds_write_b64 v125, v[216:217] offset:192
    ds_write_b64 v125, v[218:219] offset:224
    ds_read_b128 v[212:215], v126 offset:128
    ds_read_b128 v[220:223], v126 offset:3328
    v_mfma_f32_16x16x32_bf16 v[232:235], a[144:147], v[88:91], v[232:235]
    v_accvgpr_read_b32 v122, a204
    v_accvgpr_read_b32 v123, a205
    v_mfma_f32_16x16x32_bf16 v[232:235], a[148:151], v[92:95], v[232:235]
    v_add_f32 v122, v122, v123
    v_mfma_f32_16x16x32_bf16 v[236:239], a[152:155], v[88:91], v[236:239]
    v_rcp_f32 v123, v122
    v_mfma_f32_16x16x32_bf16 v[236:239], a[156:159], v[92:95], v[236:239]
    v_subrev_u32 v122, 0x2b800000, v122
    v_max_u32 v124, v124, v122
    v_mfma_f32_16x16x32_bf16 v[240:243], a[160:163], v[88:91], v[240:243]
    v_mul_f32 v224, v123, v224
    v_mul_f32 v225, v123, v225
    v_mfma_f32_16x16x32_bf16 v[240:243], a[164:167], v[92:95], v[240:243]
    v_mul_f32 v226, v123, v226
    v_mul_f32 v227, v123, v227
    v_mfma_f32_16x16x32_bf16 v[244:247], a[168:171], v[88:91], v[244:247]
    v_mul_f32 v228, v123, v228
    v_mul_f32 v229, v123, v229
    v_mfma_f32_16x16x32_bf16 v[244:247], a[172:175], v[92:95], v[244:247]
    v_mul_f32 v230, v123, v230
    v_mul_f32 v231, v123, v231
    s_waitcnt lgkmcnt(1)
    buffer_store_dwordx4 v[212:215], v127, s[16:19], s73 offen offset:128 sc1
    s_waitcnt lgkmcnt(0)
    buffer_store_dwordx4 v[220:223], v127, s[16:19], s73 offen offset:2176 sc1
    v_mfma_f32_16x16x32_bf16 v[248:251], a[176:179], v[88:91], v[248:251]
    v_cvt_pk_bf16_f32 v224, v224, v225
    v_cvt_pk_bf16_f32 v225, v226, v227
    v_mfma_f32_16x16x32_bf16 v[248:251], a[180:183], v[92:95], v[248:251]
    v_cvt_pk_bf16_f32 v226, v228, v229
    v_cvt_pk_bf16_f32 v227, v230, v231
    v_mfma_f32_16x16x32_bf16 v[252:255], a[184:187], v[88:91], v[252:255]
    ds_write_b64 v125, v[224:225] offset:0
    ds_write_b64 v125, v[226:227] offset:32
    v_mfma_f32_16x16x32_bf16 v[252:255], a[188:191], v[92:95], v[252:255]
    v_mul_f32 v232, v123, v232
    v_mul_f32 v233, v123, v233
    v_pk_mul_f32 v[234:235], v[234:235], v[122:123] op_sel:[0,1] op_sel_hi:[1,1]
    v_pk_mul_f32 v[236:237], v[236:237], v[122:123] op_sel:[0,1] op_sel_hi:[1,1]
    v_pk_mul_f32 v[238:239], v[238:239], v[122:123] op_sel:[0,1] op_sel_hi:[1,1]
    v_cvt_pk_bf16_f32 v232, v232, v233
    v_cvt_pk_bf16_f32 v233, v234, v235
    v_cvt_pk_bf16_f32 v234, v236, v237
    v_cvt_pk_bf16_f32 v235, v238, v239
    ds_write_b64 v125, v[232:233] offset:64
    ds_write_b64 v125, v[234:235] offset:96
    ds_read_b128 v[228:231], v126 offset:0
    ds_read_b128 v[236:239], v126 offset:3200
    v_pk_mul_f32 v[240:241], v[240:241], v[122:123] op_sel:[0,1] op_sel_hi:[1,1]
    v_pk_mul_f32 v[242:243], v[242:243], v[122:123] op_sel:[0,1] op_sel_hi:[1,1]
    v_pk_mul_f32 v[244:245], v[244:245], v[122:123] op_sel:[0,1] op_sel_hi:[1,1]
    v_pk_mul_f32 v[246:247], v[246:247], v[122:123] op_sel:[0,1] op_sel_hi:[1,1]
    v_cvt_pk_bf16_f32 v240, v240, v241
    v_cvt_pk_bf16_f32 v241, v242, v243
    v_cvt_pk_bf16_f32 v242, v244, v245
    v_cvt_pk_bf16_f32 v243, v246, v247
    s_waitcnt lgkmcnt(1)
    buffer_store_dwordx4 v[228:231], v127, s[16:19], s74 offen offset:0 sc1
    ds_write_b64 v125, v[240:241] offset:128
    ds_write_b64 v125, v[242:243] offset:160
    v_pk_mul_f32 v[248:249], v[248:249], v[122:123] op_sel:[0,1] op_sel_hi:[1,1]
    v_pk_mul_f32 v[250:251], v[250:251], v[122:123] op_sel:[0,1] op_sel_hi:[1,1]
    v_pk_mul_f32 v[252:253], v[252:253], v[122:123] op_sel:[0,1] op_sel_hi:[1,1]
    v_pk_mul_f32 v[254:255], v[254:255], v[122:123] op_sel:[0,1] op_sel_hi:[1,1]
    s_waitcnt lgkmcnt(2)
    buffer_store_dwordx4 v[236:239], v127, s[16:19], s74 offen offset:2048 sc1
    v_cvt_pk_bf16_f32 v248, v248, v249
    v_cvt_pk_bf16_f32 v249, v250, v251
    v_cvt_pk_bf16_f32 v250, v252, v253
    v_cvt_pk_bf16_f32 v251, v254, v255
    ds_write_b64 v125, v[248:249] offset:192
    ds_write_b64 v125, v[250:251] offset:224
    ds_read_b128 v[244:247], v126 offset:128
    ds_read_b128 v[252:255], v126 offset:3328
    s_waitcnt lgkmcnt(1)
    buffer_store_dwordx4 v[244:247], v127, s[16:19], s74 offen offset:128 sc1
    s_waitcnt lgkmcnt(0)
    buffer_store_dwordx4 v[252:255], v127, s[16:19], s74 offen offset:2176 sc1
    v_cmp_lt_u32 vcc, 0x28000000, v124
    s_cmp_lg_u32 s70, 0
    s_cbranch_scc1 L_slow
    s_nop 3
    s_cbranch_vccnz L_slow
    s_endpgm
L_slow:
    s_waitcnt vmcnt(0) lgkmcnt(0)
    v_mbcnt_lo_u32_b32 v121, -1, 0
    v_mbcnt_hi_u32_b32 v121, -1, v121
    v_and_b32 v122, 15, v121
    v_lshrrev_b32 v123, 4, v121
    s_lshl_b32 s78, s3, 12
    v_lshlrev_b32 v124, 8, v122
    v_lshl_add_u32 v124, v123, 4, v124
    v_add_u32 v124, s78, v124
    buffer_load_dwordx4 v[0:3], v124, s[4:7], s77 offen offset:0
    buffer_load_dwordx4 v[4:7], v124, s[4:7], s77 offen offset:64
    buffer_load_dwordx4 v[8:11], v124, s[4:7], s77 offen offset:128
    buffer_load_dwordx4 v[12:15], v124, s[4:7], s77 offen offset:192
    buffer_load_dwordx4 v[16:19], v124, s[4:7], s72 offen offset:0
    buffer_load_dwordx4 v[20:23], v124, s[4:7], s72 offen offset:64
    buffer_load_dwordx4 v[24:27], v124, s[4:7], s72 offen offset:128
    buffer_load_dwordx4 v[28:31], v124, s[4:7], s72 offen offset:192
    v_lshlrev_b32 v124, 12, v122
    v_lshl_add_u32 v112, v123, 4, v124
    v_add_u32 v112, 3072, v112
    v_lshlrev_b32 v124, 1, v123
    v_xor_b32 v124, v122, v124
    v_lshlrev_b32 v124, 4, v124
    v_lshl_add_u32 v113, v123, 12, v124
    v_add_u32 v113, 3072, v113
    v_xor_b32 v124, 0x80, v124
    v_lshl_add_u32 v114, v123, 12, v124
    v_add_u32 v114, 19456, v114
    s_lshl_b32 s65, s3, 13
    s_add_u32 s65, s65, 0x20000
    v_bfe_u32 v125, v121, 2, 2
    v_lshl_add_u32 v125, v123, 2, v125
    v_lshlrev_b32 v124, 8, v125
    v_and_b32 v126, 3, v121
    v_lshl_add_u32 v124, v126, 3, v124
    v_add_u32 v124, s65, v124
    v_and_b32 v125, 7, v125
    v_xor_b32 v100, 0, v125
    v_lshl_add_u32 v100, v100, 5, v124
    v_xor_b32 v101, 1, v125
    v_lshl_add_u32 v101, v101, 5, v124
    v_xor_b32 v102, 2, v125
    v_lshl_add_u32 v102, v102, 5, v124
    v_xor_b32 v103, 3, v125
    v_lshl_add_u32 v103, v103, 5, v124
    v_xor_b32 v104, 4, v125
    v_lshl_add_u32 v104, v104, 5, v124
    v_xor_b32 v105, 5, v125
    v_lshl_add_u32 v105, v105, 5, v124
    v_xor_b32 v106, 6, v125
    v_lshl_add_u32 v106, v106, 5, v124
    v_xor_b32 v107, 7, v125
    v_lshl_add_u32 v107, v107, 5, v124
    v_lshlrev_b32 v116, 2, v123
    v_mov_b32 v117, 0xf149f2ca
    v_mov_b32 v128, 0
    v_mov_b32 v129, 0
    v_mov_b32 v130, 0
    v_mov_b32 v131, 0
    v_mov_b32 v132, 0
    v_mov_b32 v133, 0
    v_mov_b32 v134, 0
    v_mov_b32 v135, 0
    v_mov_b32 v136, 0
    v_mov_b32 v137, 0
    v_mov_b32 v138, 0
    v_mov_b32 v139, 0
    v_mov_b32 v140, 0
    v_mov_b32 v141, 0
    v_mov_b32 v142, 0
    v_mov_b32 v143, 0
    v_mov_b32 v144, 0
    v_mov_b32 v145, 0
    v_mov_b32 v146, 0
    v_mov_b32 v147, 0
    v_mov_b32 v148, 0
    v_mov_b32 v149, 0
    v_mov_b32 v150, 0
    v_mov_b32 v151, 0
    v_mov_b32 v152, 0
    v_mov_b32 v153, 0
    v_mov_b32 v154, 0
    v_mov_b32 v155, 0
    v_mov_b32 v156, 0
    v_mov_b32 v157, 0
    v_mov_b32 v158, 0
    v_mov_b32 v159, 0
    v_mov_b32 v160, 0
    v_mov_b32 v161, 0
    v_mov_b32 v162, 0
    v_mov_b32 v163, 0
    v_mov_b32 v164, 0
    v_mov_b32 v165, 0
    v_mov_b32 v166, 0
    v_mov_b32 v167, 0
    v_mov_b32 v168, 0
    v_mov_b32 v169, 0
    v_mov_b32 v170, 0
    v_mov_b32 v171, 0
    v_mov_b32 v172, 0
    v_mov_b32 v173, 0
    v_mov_b32 v174, 0
    v_mov_b32 v175, 0
    v_mov_b32 v176, 0
    v_mov_b32 v177, 0
    v_mov_b32 v178, 0
    v_mov_b32 v179, 0
    v_mov_b32 v180, 0
    v_mov_b32 v181, 0
    v_mov_b32 v182, 0
    v_mov_b32 v183, 0
    v_mov_b32 v184, 0
    v_mov_b32 v185, 0
    v_mov_b32 v186, 0
    v_mov_b32 v187, 0
    v_mov_b32 v188, 0
    v_mov_b32 v189, 0
    v_mov_b32 v190, 0
    v_mov_b32 v191, 0
    v_mov_b32 v192, 0
    v_mov_b32 v193, 0
    v_mov_b32 v194, 0
    v_mov_b32 v195, 0
    v_mov_b32 v196, 0
    v_mov_b32 v197, 0
    v_mov_b32 v198, 0
    v_mov_b32 v199, 0
    v_mov_b32 v200, 0
    v_mov_b32 v201, 0
    v_mov_b32 v202, 0
    v_mov_b32 v203, 0
    v_mov_b32 v204, 0
    v_mov_b32 v205, 0
    v_mov_b32 v206, 0
    v_mov_b32 v207, 0
    v_mov_b32 v208, 0
    v_mov_b32 v209, 0
    v_mov_b32 v210, 0
    v_mov_b32 v211, 0
    v_mov_b32 v212, 0
    v_mov_b32 v213, 0
    v_mov_b32 v214, 0
    v_mov_b32 v215, 0
    v_mov_b32 v216, 0
    v_mov_b32 v217, 0
    v_mov_b32 v218, 0
    v_mov_b32 v219, 0
    v_mov_b32 v220, 0
    v_mov_b32 v221, 0
    v_mov_b32 v222, 0
    v_mov_b32 v223, 0
    v_mov_b32 v224, 0
    v_mov_b32 v225, 0
    v_mov_b32 v226, 0
    v_mov_b32 v227, 0
    v_mov_b32 v228, 0
    v_mov_b32 v229, 0
    v_mov_b32 v230, 0
    v_mov_b32 v231, 0
    v_mov_b32 v232, 0
    v_mov_b32 v233, 0
    v_mov_b32 v234, 0
    v_mov_b32 v235, 0
    v_mov_b32 v236, 0
    v_mov_b32 v237, 0
    v_mov_b32 v238, 0
    v_mov_b32 v239, 0
    v_mov_b32 v240, 0
    v_mov_b32 v241, 0
    v_mov_b32 v242, 0
    v_mov_b32 v243, 0
    v_mov_b32 v244, 0
    v_mov_b32 v245, 0
    v_mov_b32 v246, 0
    v_mov_b32 v247, 0
    v_mov_b32 v248, 0
    v_mov_b32 v249, 0
    v_mov_b32 v250, 0
    v_mov_b32 v251, 0
    v_mov_b32 v252, 0
    v_mov_b32 v253, 0
    v_mov_b32 v254, 0
    v_mov_b32 v255, 0
    v_mov_b32 v96, 0xff7fffff
    v_mov_b32 v97, 0xff7fffff
    v_mov_b32 v98, 0xff7fffff
    v_mov_b32 v99, 0xff7fffff
    v_mov_b32 v108, 0
    v_mov_b32 v109, 0
    v_mov_b32 v110, 0
    v_mov_b32 v111, 0
    s_waitcnt vmcnt(0)
    v_lshlrev_b32 v120, 16, v0
    v_and_b32 v121, 0xffff0000, v0
    v_lshlrev_b32 v122, 16, v1
    v_and_b32 v123, 0xffff0000, v1
    v_lshlrev_b32 v124, 16, v2
    v_and_b32 v125, 0xffff0000, v2
    v_lshlrev_b32 v126, 16, v3
    v_and_b32 v127, 0xffff0000, v3
    v_pk_mul_f32 v[120:121], v[120:121], s[66:67]
    v_pk_mul_f32 v[122:123], v[122:123], s[66:67]
    v_pk_mul_f32 v[124:125], v[124:125], s[66:67]
    v_pk_mul_f32 v[126:127], v[126:127], s[66:67]
    v_cvt_pk_bf16_f32 v0, v120, v121
    v_cvt_pk_bf16_f32 v1, v122, v123
    v_cvt_pk_bf16_f32 v2, v124, v125
    v_cvt_pk_bf16_f32 v3, v126, v127
    v_accvgpr_write_b32 a0, v0
    v_accvgpr_write_b32 a1, v1
    v_accvgpr_write_b32 a2, v2
    v_accvgpr_write_b32 a3, v3
    v_lshlrev_b32 v120, 16, v4
    v_and_b32 v121, 0xffff0000, v4
    v_lshlrev_b32 v122, 16, v5
    v_and_b32 v123, 0xffff0000, v5
    v_lshlrev_b32 v124, 16, v6
    v_and_b32 v125, 0xffff0000, v6
    v_lshlrev_b32 v126, 16, v7
    v_and_b32 v127, 0xffff0000, v7
    v_pk_mul_f32 v[120:121], v[120:121], s[66:67]
    v_pk_mul_f32 v[122:123], v[122:123], s[66:67]
    v_pk_mul_f32 v[124:125], v[124:125], s[66:67]
    v_pk_mul_f32 v[126:127], v[126:127], s[66:67]
    v_cvt_pk_bf16_f32 v4, v120, v121
    v_cvt_pk_bf16_f32 v5, v122, v123
    v_cvt_pk_bf16_f32 v6, v124, v125
    v_cvt_pk_bf16_f32 v7, v126, v127
    v_accvgpr_write_b32 a4, v4
    v_accvgpr_write_b32 a5, v5
    v_accvgpr_write_b32 a6, v6
    v_accvgpr_write_b32 a7, v7
    v_lshlrev_b32 v120, 16, v8
    v_and_b32 v121, 0xffff0000, v8
    v_lshlrev_b32 v122, 16, v9
    v_and_b32 v123, 0xffff0000, v9
    v_lshlrev_b32 v124, 16, v10
    v_and_b32 v125, 0xffff0000, v10
    v_lshlrev_b32 v126, 16, v11
    v_and_b32 v127, 0xffff0000, v11
    v_pk_mul_f32 v[120:121], v[120:121], s[66:67]
    v_pk_mul_f32 v[122:123], v[122:123], s[66:67]
    v_pk_mul_f32 v[124:125], v[124:125], s[66:67]
    v_pk_mul_f32 v[126:127], v[126:127], s[66:67]
    v_cvt_pk_bf16_f32 v8, v120, v121
    v_cvt_pk_bf16_f32 v9, v122, v123
    v_cvt_pk_bf16_f32 v10, v124, v125
    v_cvt_pk_bf16_f32 v11, v126, v127
    v_accvgpr_write_b32 a8, v8
    v_accvgpr_write_b32 a9, v9
    v_accvgpr_write_b32 a10, v10
    v_accvgpr_write_b32 a11, v11
    v_lshlrev_b32 v120, 16, v12
    v_and_b32 v121, 0xffff0000, v12
    v_lshlrev_b32 v122, 16, v13
    v_and_b32 v123, 0xffff0000, v13
    v_lshlrev_b32 v124, 16, v14
    v_and_b32 v125, 0xffff0000, v14
    v_lshlrev_b32 v126, 16, v15
    v_and_b32 v127, 0xffff0000, v15
    v_pk_mul_f32 v[120:121], v[120:121], s[66:67]
    v_pk_mul_f32 v[122:123], v[122:123], s[66:67]
    v_pk_mul_f32 v[124:125], v[124:125], s[66:67]
    v_pk_mul_f32 v[126:127], v[126:127], s[66:67]
    v_cvt_pk_bf16_f32 v12, v120, v121
    v_cvt_pk_bf16_f32 v13, v122, v123
    v_cvt_pk_bf16_f32 v14, v124, v125
    v_cvt_pk_bf16_f32 v15, v126, v127
    v_accvgpr_write_b32 a12, v12
    v_accvgpr_write_b32 a13, v13
    v_accvgpr_write_b32 a14, v14
    v_accvgpr_write_b32 a15, v15
    v_lshlrev_b32 v120, 16, v16
    v_and_b32 v121, 0xffff0000, v16
    v_lshlrev_b32 v122, 16, v17
    v_and_b32 v123, 0xffff0000, v17
    v_lshlrev_b32 v124, 16, v18
    v_and_b32 v125, 0xffff0000, v18
    v_lshlrev_b32 v126, 16, v19
    v_and_b32 v127, 0xffff0000, v19
    v_pk_mul_f32 v[120:121], v[120:121], s[66:67]
    v_pk_mul_f32 v[122:123], v[122:123], s[66:67]
    v_pk_mul_f32 v[124:125], v[124:125], s[66:67]
    v_pk_mul_f32 v[126:127], v[126:127], s[66:67]
    v_cvt_pk_bf16_f32 v16, v120, v121
    v_cvt_pk_bf16_f32 v17, v122, v123
    v_cvt_pk_bf16_f32 v18, v124, v125
    v_cvt_pk_bf16_f32 v19, v126, v127
    v_accvgpr_write_b32 a16, v16
    v_accvgpr_write_b32 a17, v17
    v_accvgpr_write_b32 a18, v18
    v_accvgpr_write_b32 a19, v19
    v_lshlrev_b32 v120, 16, v20
    v_and_b32 v121, 0xffff0000, v20
    v_lshlrev_b32 v122, 16, v21
    v_and_b32 v123, 0xffff0000, v21
    v_lshlrev_b32 v124, 16, v22
    v_and_b32 v125, 0xffff0000, v22
    v_lshlrev_b32 v126, 16, v23
    v_and_b32 v127, 0xffff0000, v23
    v_pk_mul_f32 v[120:121], v[120:121], s[66:67]
    v_pk_mul_f32 v[122:123], v[122:123], s[66:67]
    v_pk_mul_f32 v[124:125], v[124:125], s[66:67]
    v_pk_mul_f32 v[126:127], v[126:127], s[66:67]
    v_cvt_pk_bf16_f32 v20, v120, v121
    v_cvt_pk_bf16_f32 v21, v122, v123
    v_cvt_pk_bf16_f32 v22, v124, v125
    v_cvt_pk_bf16_f32 v23, v126, v127
    v_accvgpr_write_b32 a20, v20
    v_accvgpr_write_b32 a21, v21
    v_accvgpr_write_b32 a22, v22
    v_accvgpr_write_b32 a23, v23
    v_lshlrev_b32 v120, 16, v24
    v_and_b32 v121, 0xffff0000, v24
    v_lshlrev_b32 v122, 16, v25
    v_and_b32 v123, 0xffff0000, v25
    v_lshlrev_b32 v124, 16, v26
    v_and_b32 v125, 0xffff0000, v26
    v_lshlrev_b32 v126, 16, v27
    v_and_b32 v127, 0xffff0000, v27
    v_pk_mul_f32 v[120:121], v[120:121], s[66:67]
    v_pk_mul_f32 v[122:123], v[122:123], s[66:67]
    v_pk_mul_f32 v[124:125], v[124:125], s[66:67]
    v_pk_mul_f32 v[126:127], v[126:127], s[66:67]
    v_cvt_pk_bf16_f32 v24, v120, v121
    v_cvt_pk_bf16_f32 v25, v122, v123
    v_cvt_pk_bf16_f32 v26, v124, v125
    v_cvt_pk_bf16_f32 v27, v126, v127
    v_accvgpr_write_b32 a24, v24
    v_accvgpr_write_b32 a25, v25
    v_accvgpr_write_b32 a26, v26
    v_accvgpr_write_b32 a27, v27
    v_lshlrev_b32 v120, 16, v28
    v_and_b32 v121, 0xffff0000, v28
    v_lshlrev_b32 v122, 16, v29
    v_and_b32 v123, 0xffff0000, v29
    v_lshlrev_b32 v124, 16, v30
    v_and_b32 v125, 0xffff0000, v30
    v_lshlrev_b32 v126, 16, v31
    v_and_b32 v127, 0xffff0000, v31
    v_pk_mul_f32 v[120:121], v[120:121], s[66:67]
    v_pk_mul_f32 v[122:123], v[122:123], s[66:67]
    v_pk_mul_f32 v[124:125], v[124:125], s[66:67]
    v_pk_mul_f32 v[126:127], v[126:127], s[66:67]
    v_cvt_pk_bf16_f32 v28, v120, v121
    v_cvt_pk_bf16_f32 v29, v122, v123
    v_cvt_pk_bf16_f32 v30, v124, v125
    v_cvt_pk_bf16_f32 v31, v126, v127
    v_accvgpr_write_b32 a28, v28
    v_accvgpr_write_b32 a29, v29
    v_accvgpr_write_b32 a30, v30
    v_accvgpr_write_b32 a31, v31
    s_mov_b32 s38, 0
L_slow_loop:
    s_lshr_b32 s78, s38, 2
    s_load_dwordx2 s[40:41], s[30:31], s78
    s_waitcnt lgkmcnt(0)
    s_min_u32 s40, s40, 131
    s_min_u32 s41, s41, 131
    s_lshl_b32 s40, s40, 16
    s_lshl_b32 s41, s41, 16
    buffer_load_dwordx4 a[64:67], v112, s[8:11], s40 offen offset:0
    buffer_load_dwordx4 a[68:71], v112, s[8:11], s40 offen offset:64
    buffer_load_dwordx4 a[72:75], v112, s[8:11], s40 offen offset:128
    buffer_load_dwordx4 a[76:79], v112, s[8:11], s40 offen offset:192
    buffer_load_dwordx4 a[80:83], v112, s[8:11], s41 offen offset:0
    buffer_load_dwordx4 a[84:87], v112, s[8:11], s41 offen offset:64
    buffer_load_dwordx4 a[88:91], v112, s[8:11], s41 offen offset:128
    buffer_load_dwordx4 a[92:95], v112, s[8:11], s41 offen offset:192
    s_add_u32 m0, s65, 0
    s_add_u32 s42, s40, 0
    buffer_load_dwordx4 v113, s[12:15], s42 offen lds
    s_add_u32 m0, s65, 1024
    s_add_u32 s42, s40, 0
    buffer_load_dwordx4 v114, s[12:15], s42 offen lds
    s_add_u32 m0, s65, 2048
    s_add_u32 s42, s40, 32768
    buffer_load_dwordx4 v113, s[12:15], s42 offen lds
    s_add_u32 m0, s65, 3072
    s_add_u32 s42, s40, 32768
    buffer_load_dwordx4 v114, s[12:15], s42 offen lds
    s_add_u32 m0, s65, 4096
    s_add_u32 s42, s41, 0
    buffer_load_dwordx4 v113, s[12:15], s42 offen lds
    s_add_u32 m0, s65, 5120
    s_add_u32 s42, s41, 0
    buffer_load_dwordx4 v114, s[12:15], s42 offen lds
    s_add_u32 m0, s65, 6144
    s_add_u32 s42, s41, 32768
    buffer_load_dwordx4 v113, s[12:15], s42 offen lds
    s_add_u32 m0, s65, 7168
    s_add_u32 s42, s41, 32768
    buffer_load_dwordx4 v114, s[12:15], s42 offen lds
    s_waitcnt vmcnt(0)
    ds_read_b64_tr_b16 a[128:129], v100 offset:0
    ds_read_b64_tr_b16 a[130:131], v100 offset:4096
    ds_read_b64_tr_b16 a[136:137], v101 offset:0
    ds_read_b64_tr_b16 a[138:139], v101 offset:4096
    ds_read_b64_tr_b16 a[144:145], v102 offset:0
    ds_read_b64_tr_b16 a[146:147], v102 offset:4096
    ds_read_b64_tr_b16 a[152:153], v103 offset:0
    ds_read_b64_tr_b16 a[154:155], v103 offset:4096
    ds_read_b64_tr_b16 a[160:161], v104 offset:0
    ds_read_b64_tr_b16 a[162:163], v104 offset:4096
    ds_read_b64_tr_b16 a[168:169], v105 offset:0
    ds_read_b64_tr_b16 a[170:171], v105 offset:4096
    ds_read_b64_tr_b16 a[176:177], v106 offset:0
    ds_read_b64_tr_b16 a[178:179], v106 offset:4096
    ds_read_b64_tr_b16 a[184:185], v107 offset:0
    ds_read_b64_tr_b16 a[186:187], v107 offset:4096
    s_sub_u32 s78, s71, s38
    s_waitcnt lgkmcnt(0)
    v_mfma_f32_16x16x32_bf16 v[0:3], a[64:67], a[0:3], 0
    v_mfma_f32_16x16x32_bf16 v[0:3], a[68:71], a[4:7], v[0:3]
    v_mfma_f32_16x16x32_bf16 v[0:3], a[72:75], a[8:11], v[0:3]
    v_mfma_f32_16x16x32_bf16 v[0:3], a[76:79], a[12:15], v[0:3]
    v_mfma_f32_16x16x32_bf16 v[4:7], a[92:95], a[12:15], 0
    v_mfma_f32_16x16x32_bf16 v[4:7], a[88:91], a[8:11], v[4:7]
    v_mfma_f32_16x16x32_bf16 v[4:7], a[84:87], a[4:7], v[4:7]
    v_mfma_f32_16x16x32_bf16 v[4:7], a[80:83], a[0:3], v[4:7]
    s_nop 7
    v_add_u32 v120, 0, v116
    v_cmp_gt_u32 vcc, s78, v120
    s_nop 1
    v_cndmask_b32 v0, v117, v0, vcc
    v_add_u32 v120, 1, v116
    v_cmp_gt_u32 vcc, s78, v120
    s_nop 1
    v_cndmask_b32 v1, v117, v1, vcc
    v_add_u32 v120, 2, v116
    v_cmp_gt_u32 vcc, s78, v120
    s_nop 1
    v_cndmask_b32 v2, v117, v2, vcc
    v_add_u32 v120, 3, v116
    v_cmp_gt_u32 vcc, s78, v120
    s_nop 1
    v_cndmask_b32 v3, v117, v3, vcc
    v_add_u32 v120, 16, v116
    v_cmp_gt_u32 vcc, s78, v120
    s_nop 1
    v_cndmask_b32 v4, v117, v4, vcc
    v_add_u32 v120, 17, v116
    v_cmp_gt_u32 vcc, s78, v120
    s_nop 1
    v_cndmask_b32 v5, v117, v5, vcc
    v_add_u32 v120, 18, v116
    v_cmp_gt_u32 vcc, s78, v120
    s_nop 1
    v_cndmask_b32 v6, v117, v6, vcc
    v_add_u32 v120, 19, v116
    v_cmp_gt_u32 vcc, s78, v120
    s_nop 1
    v_cndmask_b32 v7, v117, v7, vcc
    v_max3_f32 v120, v0, v1, v2
    v_max3_f32 v120, v120, v3, v4
    v_max3_f32 v120, v120, v5, v6
    v_max3_f32 v120, v120, v7, v96
    v_mov_b32 v121, v120
    s_nop 1
    v_permlane16_swap_b32 v120, v121
    v_max_f32 v120, v120, v121
    v_mov_b32 v121, v120
    s_nop 1
    v_permlane32_swap_b32 v120, v121
    v_max_f32 v120, v120, v121
    v_sub_f32 v121, v96, v120
    v_exp_f32 v121, v121
    v_mov_b32 v96, v120
    v_sub_f32 v0, v0, v120
    v_sub_f32 v1, v1, v120
    v_sub_f32 v2, v2, v120
    v_sub_f32 v3, v3, v120
    v_sub_f32 v4, v4, v120
    v_sub_f32 v5, v5, v120
    v_sub_f32 v6, v6, v120
    v_sub_f32 v7, v7, v120
    v_exp_f32 v0, v0
    v_exp_f32 v1, v1
    v_exp_f32 v2, v2
    v_exp_f32 v3, v3
    v_exp_f32 v4, v4
    v_exp_f32 v5, v5
    v_exp_f32 v6, v6
    v_exp_f32 v7, v7
    v_mul_f32 v108, v108, v121
    v_mul_f32 v128, v128, v121
    v_mul_f32 v129, v129, v121
    v_mul_f32 v130, v130, v121
    v_mul_f32 v131, v131, v121
    v_mul_f32 v132, v132, v121
    v_mul_f32 v133, v133, v121
    v_mul_f32 v134, v134, v121
    v_mul_f32 v135, v135, v121
    v_mul_f32 v136, v136, v121
    v_mul_f32 v137, v137, v121
    v_mul_f32 v138, v138, v121
    v_mul_f32 v139, v139, v121
    v_mul_f32 v140, v140, v121
    v_mul_f32 v141, v141, v121
    v_mul_f32 v142, v142, v121
    v_mul_f32 v143, v143, v121
    v_mul_f32 v144, v144, v121
    v_mul_f32 v145, v145, v121
    v_mul_f32 v146, v146, v121
    v_mul_f32 v147, v147, v121
    v_mul_f32 v148, v148, v121
    v_mul_f32 v149, v149, v121
    v_mul_f32 v150, v150, v121
    v_mul_f32 v151, v151, v121
    v_mul_f32 v152, v152, v121
    v_mul_f32 v153, v153, v121
    v_mul_f32 v154, v154, v121
    v_mul_f32 v155, v155, v121
    v_mul_f32 v156, v156, v121
    v_mul_f32 v157, v157, v121
    v_mul_f32 v158, v158, v121
    v_mul_f32 v159, v159, v121
    v_cvt_pk_bf16_f32 v64, v0, v1
    v_cvt_pk_bf16_f32 v65, v2, v3
    v_cvt_pk_bf16_f32 v66, v4, v5
    v_cvt_pk_bf16_f32 v67, v6, v7
    v_lshlrev_b32 v120, 16, v64
    v_and_b32 v121, 0xffff0000, v64
    v_add_f32 v108, v108, v120
    v_add_f32 v108, v108, v121
    v_lshlrev_b32 v120, 16, v65
    v_and_b32 v121, 0xffff0000, v65
    v_add_f32 v108, v108, v120
    v_add_f32 v108, v108, v121
    v_lshlrev_b32 v120, 16, v66
    v_and_b32 v121, 0xffff0000, v66
    v_add_f32 v108, v108, v120
    v_add_f32 v108, v108, v121
    v_lshlrev_b32 v120, 16, v67
    v_and_b32 v121, 0xffff0000, v67
    v_add_f32 v108, v108, v120
    v_add_f32 v108, v108, v121
    v_mfma_f32_16x16x32_bf16 v[128:131], a[128:131], v[64:67], v[128:131]
    v_mfma_f32_16x16x32_bf16 v[132:135], a[136:139], v[64:67], v[132:135]
    v_mfma_f32_16x16x32_bf16 v[136:139], a[144:147], v[64:67], v[136:139]
    v_mfma_f32_16x16x32_bf16 v[140:143], a[152:155], v[64:67], v[140:143]
    v_mfma_f32_16x16x32_bf16 v[144:147], a[160:163], v[64:67], v[144:147]
    v_mfma_f32_16x16x32_bf16 v[148:151], a[168:171], v[64:67], v[148:151]
    v_mfma_f32_16x16x32_bf16 v[152:155], a[176:179], v[64:67], v[152:155]
    v_mfma_f32_16x16x32_bf16 v[156:159], a[184:187], v[64:67], v[156:159]
    v_mfma_f32_16x16x32_bf16 v[16:19], a[64:67], a[16:19], 0
    v_mfma_f32_16x16x32_bf16 v[16:19], a[68:71], a[20:23], v[16:19]
    v_mfma_f32_16x16x32_bf16 v[16:19], a[72:75], a[24:27], v[16:19]
    v_mfma_f32_16x16x32_bf16 v[16:19], a[76:79], a[28:31], v[16:19]
    v_mfma_f32_16x16x32_bf16 v[20:23], a[92:95], a[28:31], 0
    v_mfma_f32_16x16x32_bf16 v[20:23], a[88:91], a[24:27], v[20:23]
    v_mfma_f32_16x16x32_bf16 v[20:23], a[84:87], a[20:23], v[20:23]
    v_mfma_f32_16x16x32_bf16 v[20:23], a[80:83], a[16:19], v[20:23]
    s_nop 7
    v_add_u32 v120, 0, v116
    v_cmp_gt_u32 vcc, s78, v120
    s_nop 1
    v_cndmask_b32 v16, v117, v16, vcc
    v_add_u32 v120, 1, v116
    v_cmp_gt_u32 vcc, s78, v120
    s_nop 1
    v_cndmask_b32 v17, v117, v17, vcc
    v_add_u32 v120, 2, v116
    v_cmp_gt_u32 vcc, s78, v120
    s_nop 1
    v_cndmask_b32 v18, v117, v18, vcc
    v_add_u32 v120, 3, v116
    v_cmp_gt_u32 vcc, s78, v120
    s_nop 1
    v_cndmask_b32 v19, v117, v19, vcc
    v_add_u32 v120, 16, v116
    v_cmp_gt_u32 vcc, s78, v120
    s_nop 1
    v_cndmask_b32 v20, v117, v20, vcc
    v_add_u32 v120, 17, v116
    v_cmp_gt_u32 vcc, s78, v120
    s_nop 1
    v_cndmask_b32 v21, v117, v21, vcc
    v_add_u32 v120, 18, v116
    v_cmp_gt_u32 vcc, s78, v120
    s_nop 1
    v_cndmask_b32 v22, v117, v22, vcc
    v_add_u32 v120, 19, v116
    v_cmp_gt_u32 vcc, s78, v120
    s_nop 1
    v_cndmask_b32 v23, v117, v23, vcc
    v_max3_f32 v120, v16, v17, v18
    v_max3_f32 v120, v120, v19, v20
    v_max3_f32 v120, v120, v21, v22
    v_max3_f32 v120, v120, v23, v97
    v_mov_b32 v121, v120
    s_nop 1
    v_permlane16_swap_b32 v120, v121
    v_max_f32 v120, v120, v121
    v_mov_b32 v121, v120
    s_nop 1
    v_permlane32_swap_b32 v120, v121
    v_max_f32 v120, v120, v121
    v_sub_f32 v121, v97, v120
    v_exp_f32 v121, v121
    v_mov_b32 v97, v120
    v_sub_f32 v16, v16, v120
    v_sub_f32 v17, v17, v120
    v_sub_f32 v18, v18, v120
    v_sub_f32 v19, v19, v120
    v_sub_f32 v20, v20, v120
    v_sub_f32 v21, v21, v120
    v_sub_f32 v22, v22, v120
    v_sub_f32 v23, v23, v120
    v_exp_f32 v16, v16
    v_exp_f32 v17, v17
    v_exp_f32 v18, v18
    v_exp_f32 v19, v19
    v_exp_f32 v20, v20
    v_exp_f32 v21, v21
    v_exp_f32 v22, v22
    v_exp_f32 v23, v23
    v_mul_f32 v109, v109, v121
    v_mul_f32 v160, v160, v121
    v_mul_f32 v161, v161, v121
    v_mul_f32 v162, v162, v121
    v_mul_f32 v163, v163, v121
    v_mul_f32 v164, v164, v121
    v_mul_f32 v165, v165, v121
    v_mul_f32 v166, v166, v121
    v_mul_f32 v167, v167, v121
    v_mul_f32 v168, v168, v121
    v_mul_f32 v169, v169, v121
    v_mul_f32 v170, v170, v121
    v_mul_f32 v171, v171, v121
    v_mul_f32 v172, v172, v121
    v_mul_f32 v173, v173, v121
    v_mul_f32 v174, v174, v121
    v_mul_f32 v175, v175, v121
    v_mul_f32 v176, v176, v121
    v_mul_f32 v177, v177, v121
    v_mul_f32 v178, v178, v121
    v_mul_f32 v179, v179, v121
    v_mul_f32 v180, v180, v121
    v_mul_f32 v181, v181, v121
    v_mul_f32 v182, v182, v121
    v_mul_f32 v183, v183, v121
    v_mul_f32 v184, v184, v121
    v_mul_f32 v185, v185, v121
    v_mul_f32 v186, v186, v121
    v_mul_f32 v187, v187, v121
    v_mul_f32 v188, v188, v121
    v_mul_f32 v189, v189, v121
    v_mul_f32 v190, v190, v121
    v_mul_f32 v191, v191, v121
    v_cvt_pk_bf16_f32 v72, v16, v17
    v_cvt_pk_bf16_f32 v73, v18, v19
    v_cvt_pk_bf16_f32 v74, v20, v21
    v_cvt_pk_bf16_f32 v75, v22, v23
    v_lshlrev_b32 v120, 16, v72
    v_and_b32 v121, 0xffff0000, v72
    v_add_f32 v109, v109, v120
    v_add_f32 v109, v109, v121
    v_lshlrev_b32 v120, 16, v73
    v_and_b32 v121, 0xffff0000, v73
    v_add_f32 v109, v109, v120
    v_add_f32 v109, v109, v121
    v_lshlrev_b32 v120, 16, v74
    v_and_b32 v121, 0xffff0000, v74
    v_add_f32 v109, v109, v120
    v_add_f32 v109, v109, v121
    v_lshlrev_b32 v120, 16, v75
    v_and_b32 v121, 0xffff0000, v75
    v_add_f32 v109, v109, v120
    v_add_f32 v109, v109, v121
    v_mfma_f32_16x16x32_bf16 v[160:163], a[128:131], v[72:75], v[160:163]
    v_mfma_f32_16x16x32_bf16 v[164:167], a[136:139], v[72:75], v[164:167]
    v_mfma_f32_16x16x32_bf16 v[168:171], a[144:147], v[72:75], v[168:171]
    v_mfma_f32_16x16x32_bf16 v[172:175], a[152:155], v[72:75], v[172:175]
    v_mfma_f32_16x16x32_bf16 v[176:179], a[160:163], v[72:75], v[176:179]
    v_mfma_f32_16x16x32_bf16 v[180:183], a[168:171], v[72:75], v[180:183]
    v_mfma_f32_16x16x32_bf16 v[184:187], a[176:179], v[72:75], v[184:187]
    v_mfma_f32_16x16x32_bf16 v[188:191], a[184:187], v[72:75], v[188:191]
    v_mfma_f32_16x16x32_bf16 v[32:35], a[64:67], a[32:35], 0
    v_mfma_f32_16x16x32_bf16 v[32:35], a[68:71], a[36:39], v[32:35]
    v_mfma_f32_16x16x32_bf16 v[32:35], a[72:75], a[40:43], v[32:35]
    v_mfma_f32_16x16x32_bf16 v[32:35], a[76:79], a[44:47], v[32:35]
    v_mfma_f32_16x16x32_bf16 v[36:39], a[92:95], a[44:47], 0
    v_mfma_f32_16x16x32_bf16 v[36:39], a[88:91], a[40:43], v[36:39]
    v_mfma_f32_16x16x32_bf16 v[36:39], a[84:87], a[36:39], v[36:39]
    v_mfma_f32_16x16x32_bf16 v[36:39], a[80:83], a[32:35], v[36:39]
    s_nop 7
    v_add_u32 v120, 0, v116
    v_cmp_gt_u32 vcc, s78, v120
    s_nop 1
    v_cndmask_b32 v32, v117, v32, vcc
    v_add_u32 v120, 1, v116
    v_cmp_gt_u32 vcc, s78, v120
    s_nop 1
    v_cndmask_b32 v33, v117, v33, vcc
    v_add_u32 v120, 2, v116
    v_cmp_gt_u32 vcc, s78, v120
    s_nop 1
    v_cndmask_b32 v34, v117, v34, vcc
    v_add_u32 v120, 3, v116
    v_cmp_gt_u32 vcc, s78, v120
    s_nop 1
    v_cndmask_b32 v35, v117, v35, vcc
    v_add_u32 v120, 16, v116
    v_cmp_gt_u32 vcc, s78, v120
    s_nop 1
    v_cndmask_b32 v36, v117, v36, vcc
    v_add_u32 v120, 17, v116
    v_cmp_gt_u32 vcc, s78, v120
    s_nop 1
    v_cndmask_b32 v37, v117, v37, vcc
    v_add_u32 v120, 18, v116
    v_cmp_gt_u32 vcc, s78, v120
    s_nop 1
    v_cndmask_b32 v38, v117, v38, vcc
    v_add_u32 v120, 19, v116
    v_cmp_gt_u32 vcc, s78, v120
    s_nop 1
    v_cndmask_b32 v39, v117, v39, vcc
    v_max3_f32 v120, v32, v33, v34
    v_max3_f32 v120, v120, v35, v36
    v_max3_f32 v120, v120, v37, v38
    v_max3_f32 v120, v120, v39, v98
    v_mov_b32 v121, v120
    s_nop 1
    v_permlane16_swap_b32 v120, v121
    v_max_f32 v120, v120, v121
    v_mov_b32 v121, v120
    s_nop 1
    v_permlane32_swap_b32 v120, v121
    v_max_f32 v120, v120, v121
    v_sub_f32 v121, v98, v120
    v_exp_f32 v121, v121
    v_mov_b32 v98, v120
    v_sub_f32 v32, v32, v120
    v_sub_f32 v33, v33, v120
    v_sub_f32 v34, v34, v120
    v_sub_f32 v35, v35, v120
    v_sub_f32 v36, v36, v120
    v_sub_f32 v37, v37, v120
    v_sub_f32 v38, v38, v120
    v_sub_f32 v39, v39, v120
    v_exp_f32 v32, v32
    v_exp_f32 v33, v33
    v_exp_f32 v34, v34
    v_exp_f32 v35, v35
    v_exp_f32 v36, v36
    v_exp_f32 v37, v37
    v_exp_f32 v38, v38
    v_exp_f32 v39, v39
    v_mul_f32 v110, v110, v121
    v_mul_f32 v192, v192, v121
    v_mul_f32 v193, v193, v121
    v_mul_f32 v194, v194, v121
    v_mul_f32 v195, v195, v121
    v_mul_f32 v196, v196, v121
    v_mul_f32 v197, v197, v121
    v_mul_f32 v198, v198, v121
    v_mul_f32 v199, v199, v121
    v_mul_f32 v200, v200, v121
    v_mul_f32 v201, v201, v121
    v_mul_f32 v202, v202, v121
    v_mul_f32 v203, v203, v121
    v_mul_f32 v204, v204, v121
    v_mul_f32 v205, v205, v121
    v_mul_f32 v206, v206, v121
    v_mul_f32 v207, v207, v121
    v_mul_f32 v208, v208, v121
    v_mul_f32 v209, v209, v121
    v_mul_f32 v210, v210, v121
    v_mul_f32 v211, v211, v121
    v_mul_f32 v212, v212, v121
    v_mul_f32 v213, v213, v121
    v_mul_f32 v214, v214, v121
    v_mul_f32 v215, v215, v121
    v_mul_f32 v216, v216, v121
    v_mul_f32 v217, v217, v121
    v_mul_f32 v218, v218, v121
    v_mul_f32 v219, v219, v121
    v_mul_f32 v220, v220, v121
    v_mul_f32 v221, v221, v121
    v_mul_f32 v222, v222, v121
    v_mul_f32 v223, v223, v121
    v_cvt_pk_bf16_f32 v80, v32, v33
    v_cvt_pk_bf16_f32 v81, v34, v35
    v_cvt_pk_bf16_f32 v82, v36, v37
    v_cvt_pk_bf16_f32 v83, v38, v39
    v_lshlrev_b32 v120, 16, v80
    v_and_b32 v121, 0xffff0000, v80
    v_add_f32 v110, v110, v120
    v_add_f32 v110, v110, v121
    v_lshlrev_b32 v120, 16, v81
    v_and_b32 v121, 0xffff0000, v81
    v_add_f32 v110, v110, v120
    v_add_f32 v110, v110, v121
    v_lshlrev_b32 v120, 16, v82
    v_and_b32 v121, 0xffff0000, v82
    v_add_f32 v110, v110, v120
    v_add_f32 v110, v110, v121
    v_lshlrev_b32 v120, 16, v83
    v_and_b32 v121, 0xffff0000, v83
    v_add_f32 v110, v110, v120
    v_add_f32 v110, v110, v121
    v_mfma_f32_16x16x32_bf16 v[192:195], a[128:131], v[80:83], v[192:195]
    v_mfma_f32_16x16x32_bf16 v[196:199], a[136:139], v[80:83], v[196:199]
    v_mfma_f32_16x16x32_bf16 v[200:203], a[144:147], v[80:83], v[200:203]
    v_mfma_f32_16x16x32_bf16 v[204:207], a[152:155], v[80:83], v[204:207]
    v_mfma_f32_16x16x32_bf16 v[208:211], a[160:163], v[80:83], v[208:211]
    v_mfma_f32_16x16x32_bf16 v[212:215], a[168:171], v[80:83], v[212:215]
    v_mfma_f32_16x16x32_bf16 v[216:219], a[176:179], v[80:83], v[216:219]
    v_mfma_f32_16x16x32_bf16 v[220:223], a[184:187], v[80:83], v[220:223]
    v_mfma_f32_16x16x32_bf16 v[48:51], a[64:67], a[48:51], 0
    v_mfma_f32_16x16x32_bf16 v[48:51], a[68:71], a[52:55], v[48:51]
    v_mfma_f32_16x16x32_bf16 v[48:51], a[72:75], a[56:59], v[48:51]
    v_mfma_f32_16x16x32_bf16 v[48:51], a[76:79], a[60:63], v[48:51]
    v_mfma_f32_16x16x32_bf16 v[52:55], a[92:95], a[60:63], 0
    v_mfma_f32_16x16x32_bf16 v[52:55], a[88:91], a[56:59], v[52:55]
    v_mfma_f32_16x16x32_bf16 v[52:55], a[84:87], a[52:55], v[52:55]
    v_mfma_f32_16x16x32_bf16 v[52:55], a[80:83], a[48:51], v[52:55]
    s_nop 7
    v_add_u32 v120, 0, v116
    v_cmp_gt_u32 vcc, s78, v120
    s_nop 1
    v_cndmask_b32 v48, v117, v48, vcc
    v_add_u32 v120, 1, v116
    v_cmp_gt_u32 vcc, s78, v120
    s_nop 1
    v_cndmask_b32 v49, v117, v49, vcc
    v_add_u32 v120, 2, v116
    v_cmp_gt_u32 vcc, s78, v120
    s_nop 1
    v_cndmask_b32 v50, v117, v50, vcc
    v_add_u32 v120, 3, v116
    v_cmp_gt_u32 vcc, s78, v120
    s_nop 1
    v_cndmask_b32 v51, v117, v51, vcc
    v_add_u32 v120, 16, v116
    v_cmp_gt_u32 vcc, s78, v120
    s_nop 1
    v_cndmask_b32 v52, v117, v52, vcc
    v_add_u32 v120, 17, v116
    v_cmp_gt_u32 vcc, s78, v120
    s_nop 1
    v_cndmask_b32 v53, v117, v53, vcc
    v_add_u32 v120, 18, v116
    v_cmp_gt_u32 vcc, s78, v120
    s_nop 1
    v_cndmask_b32 v54, v117, v54, vcc
    v_add_u32 v120, 19, v116
    v_cmp_gt_u32 vcc, s78, v120
    s_nop 1
    v_cndmask_b32 v55, v117, v55, vcc
    v_max3_f32 v120, v48, v49, v50
    v_max3_f32 v120, v120, v51, v52
    v_max3_f32 v120, v120, v53, v54
    v_max3_f32 v120, v120, v55, v99
    v_mov_b32 v121, v120
    s_nop 1
    v_permlane16_swap_b32 v120, v121
    v_max_f32 v120, v120, v121
    v_mov_b32 v121, v120
    s_nop 1
    v_permlane32_swap_b32 v120, v121
    v_max_f32 v120, v120, v121
    v_sub_f32 v121, v99, v120
    v_exp_f32 v121, v121
    v_mov_b32 v99, v120
    v_sub_f32 v48, v48, v120
    v_sub_f32 v49, v49, v120
    v_sub_f32 v50, v50, v120
    v_sub_f32 v51, v51, v120
    v_sub_f32 v52, v52, v120
    v_sub_f32 v53, v53, v120
    v_sub_f32 v54, v54, v120
    v_sub_f32 v55, v55, v120
    v_exp_f32 v48, v48
    v_exp_f32 v49, v49
    v_exp_f32 v50, v50
    v_exp_f32 v51, v51
    v_exp_f32 v52, v52
    v_exp_f32 v53, v53
    v_exp_f32 v54, v54
    v_exp_f32 v55, v55
    v_mul_f32 v111, v111, v121
    v_mul_f32 v224, v224, v121
    v_mul_f32 v225, v225, v121
    v_mul_f32 v226, v226, v121
    v_mul_f32 v227, v227, v121
    v_mul_f32 v228, v228, v121
    v_mul_f32 v229, v229, v121
    v_mul_f32 v230, v230, v121
    v_mul_f32 v231, v231, v121
    v_mul_f32 v232, v232, v121
    v_mul_f32 v233, v233, v121
    v_mul_f32 v234, v234, v121
    v_mul_f32 v235, v235, v121
    v_mul_f32 v236, v236, v121
    v_mul_f32 v237, v237, v121
    v_mul_f32 v238, v238, v121
    v_mul_f32 v239, v239, v121
    v_mul_f32 v240, v240, v121
    v_mul_f32 v241, v241, v121
    v_mul_f32 v242, v242, v121
    v_mul_f32 v243, v243, v121
    v_mul_f32 v244, v244, v121
    v_mul_f32 v245, v245, v121
    v_mul_f32 v246, v246, v121
    v_mul_f32 v247, v247, v121
    v_mul_f32 v248, v248, v121
    v_mul_f32 v249, v249, v121
    v_mul_f32 v250, v250, v121
    v_mul_f32 v251, v251, v121
    v_mul_f32 v252, v252, v121
    v_mul_f32 v253, v253, v121
    v_mul_f32 v254, v254, v121
    v_mul_f32 v255, v255, v121
    v_cvt_pk_bf16_f32 v88, v48, v49
    v_cvt_pk_bf16_f32 v89, v50, v51
    v_cvt_pk_bf16_f32 v90, v52, v53
    v_cvt_pk_bf16_f32 v91, v54, v55
    v_lshlrev_b32 v120, 16, v88
    v_and_b32 v121, 0xffff0000, v88
    v_add_f32 v111, v111, v120
    v_add_f32 v111, v111, v121
    v_lshlrev_b32 v120, 16, v89
    v_and_b32 v121, 0xffff0000, v89
    v_add_f32 v111, v111, v120
    v_add_f32 v111, v111, v121
    v_lshlrev_b32 v120, 16, v90
    v_and_b32 v121, 0xffff0000, v90
    v_add_f32 v111, v111, v120
    v_add_f32 v111, v111, v121
    v_lshlrev_b32 v120, 16, v91
    v_and_b32 v121, 0xffff0000, v91
    v_add_f32 v111, v111, v120
    v_add_f32 v111, v111, v121
    v_mfma_f32_16x16x32_bf16 v[224:227], a[128:131], v[88:91], v[224:227]
    v_mfma_f32_16x16x32_bf16 v[228:231], a[136:139], v[88:91], v[228:231]
    v_mfma_f32_16x16x32_bf16 v[232:235], a[144:147], v[88:91], v[232:235]
    v_mfma_f32_16x16x32_bf16 v[236:239], a[152:155], v[88:91], v[236:239]
    v_mfma_f32_16x16x32_bf16 v[240:243], a[160:163], v[88:91], v[240:243]
    v_mfma_f32_16x16x32_bf16 v[244:247], a[168:171], v[88:91], v[244:247]
    v_mfma_f32_16x16x32_bf16 v[248:251], a[176:179], v[88:91], v[248:251]
    v_mfma_f32_16x16x32_bf16 v[252:255], a[184:187], v[88:91], v[252:255]
    s_add_u32 s38, s38, 32
    s_cmp_lt_u32 s38, s71
    s_cbranch_scc1 L_slow_loop
    s_nop 7
    v_mov_b32 v120, v108
    v_mov_b32 v121, v108
    s_nop 1
    v_permlane16_swap_b32 v120, v121
    v_add_f32 v120, v120, v121
    v_mov_b32 v121, v120
    s_nop 1
    v_permlane32_swap_b32 v120, v121
    v_add_f32 v120, v120, v121
    v_rcp_f32 v120, v120
    s_nop 0
    v_mul_f32 v128, v128, v120
    v_mul_f32 v129, v129, v120
    v_mul_f32 v130, v130, v120
    v_mul_f32 v131, v131, v120
    v_mul_f32 v132, v132, v120
    v_mul_f32 v133, v133, v120
    v_mul_f32 v134, v134, v120
    v_mul_f32 v135, v135, v120
    v_mul_f32 v136, v136, v120
    v_mul_f32 v137, v137, v120
    v_mul_f32 v138, v138, v120
    v_mul_f32 v139, v139, v120
    v_mul_f32 v140, v140, v120
    v_mul_f32 v141, v141, v120
    v_mul_f32 v142, v142, v120
    v_mul_f32 v143, v143, v120
    v_mul_f32 v144, v144, v120
    v_mul_f32 v145, v145, v120
    v_mul_f32 v146, v146, v120
    v_mul_f32 v147, v147, v120
    v_mul_f32 v148, v148, v120
    v_mul_f32 v149, v149, v120
    v_mul_f32 v150, v150, v120
    v_mul_f32 v151, v151, v120
    v_mul_f32 v152, v152, v120
    v_mul_f32 v153, v153, v120
    v_mul_f32 v154, v154, v120
    v_mul_f32 v155, v155, v120
    v_mul_f32 v156, v156, v120
    v_mul_f32 v157, v157, v120
    v_mul_f32 v158, v158, v120
    v_mul_f32 v159, v159, v120
    v_cvt_pk_bf16_f32 v128, v128, v129
    v_cvt_pk_bf16_f32 v129, v130, v131
    v_cvt_pk_bf16_f32 v130, v132, v133
    v_cvt_pk_bf16_f32 v131, v134, v135
    v_cvt_pk_bf16_f32 v136, v136, v137
    v_cvt_pk_bf16_f32 v137, v138, v139
    v_cvt_pk_bf16_f32 v138, v140, v141
    v_cvt_pk_bf16_f32 v139, v142, v143
    v_cvt_pk_bf16_f32 v144, v144, v145
    v_cvt_pk_bf16_f32 v145, v146, v147
    v_cvt_pk_bf16_f32 v146, v148, v149
    v_cvt_pk_bf16_f32 v147, v150, v151
    v_cvt_pk_bf16_f32 v152, v152, v153
    v_cvt_pk_bf16_f32 v153, v154, v155
    v_cvt_pk_bf16_f32 v154, v156, v157
    v_cvt_pk_bf16_f32 v155, v158, v159
    v_permlane16_swap_b32 v128, v130
    v_permlane16_swap_b32 v129, v131
    v_permlane16_swap_b32 v136, v138
    v_permlane16_swap_b32 v137, v139
    v_permlane16_swap_b32 v144, v146
    v_permlane16_swap_b32 v145, v147
    v_permlane16_swap_b32 v152, v154
    v_permlane16_swap_b32 v153, v155
    buffer_store_dwordx4 v[128:131], v115, s[16:19], s77 offen offset:0
    buffer_store_dwordx4 v[136:139], v115, s[16:19], s77 offen offset:64
    buffer_store_dwordx4 v[144:147], v115, s[16:19], s77 offen offset:128
    buffer_store_dwordx4 v[152:155], v115, s[16:19], s77 offen offset:192
    v_mov_b32 v120, v109
    v_mov_b32 v121, v109
    s_nop 1
    v_permlane16_swap_b32 v120, v121
    v_add_f32 v120, v120, v121
    v_mov_b32 v121, v120
    s_nop 1
    v_permlane32_swap_b32 v120, v121
    v_add_f32 v120, v120, v121
    v_rcp_f32 v120, v120
    s_nop 0
    v_mul_f32 v160, v160, v120
    v_mul_f32 v161, v161, v120
    v_mul_f32 v162, v162, v120
    v_mul_f32 v163, v163, v120
    v_mul_f32 v164, v164, v120
    v_mul_f32 v165, v165, v120
    v_mul_f32 v166, v166, v120
    v_mul_f32 v167, v167, v120
    v_mul_f32 v168, v168, v120
    v_mul_f32 v169, v169, v120
    v_mul_f32 v170, v170, v120
    v_mul_f32 v171, v171, v120
    v_mul_f32 v172, v172, v120
    v_mul_f32 v173, v173, v120
    v_mul_f32 v174, v174, v120
    v_mul_f32 v175, v175, v120
    v_mul_f32 v176, v176, v120
    v_mul_f32 v177, v177, v120
    v_mul_f32 v178, v178, v120
    v_mul_f32 v179, v179, v120
    v_mul_f32 v180, v180, v120
    v_mul_f32 v181, v181, v120
    v_mul_f32 v182, v182, v120
    v_mul_f32 v183, v183, v120
    v_mul_f32 v184, v184, v120
    v_mul_f32 v185, v185, v120
    v_mul_f32 v186, v186, v120
    v_mul_f32 v187, v187, v120
    v_mul_f32 v188, v188, v120
    v_mul_f32 v189, v189, v120
    v_mul_f32 v190, v190, v120
    v_mul_f32 v191, v191, v120
    v_cvt_pk_bf16_f32 v160, v160, v161
    v_cvt_pk_bf16_f32 v161, v162, v163
    v_cvt_pk_bf16_f32 v162, v164, v165
    v_cvt_pk_bf16_f32 v163, v166, v167
    v_cvt_pk_bf16_f32 v168, v168, v169
    v_cvt_pk_bf16_f32 v169, v170, v171
    v_cvt_pk_bf16_f32 v170, v172, v173
    v_cvt_pk_bf16_f32 v171, v174, v175
    v_cvt_pk_bf16_f32 v176, v176, v177
    v_cvt_pk_bf16_f32 v177, v178, v179
    v_cvt_pk_bf16_f32 v178, v180, v181
    v_cvt_pk_bf16_f32 v179, v182, v183
    v_cvt_pk_bf16_f32 v184, v184, v185
    v_cvt_pk_bf16_f32 v185, v186, v187
    v_cvt_pk_bf16_f32 v186, v188, v189
    v_cvt_pk_bf16_f32 v187, v190, v191
    v_permlane16_swap_b32 v160, v162
    v_permlane16_swap_b32 v161, v163
    v_permlane16_swap_b32 v168, v170
    v_permlane16_swap_b32 v169, v171
    v_permlane16_swap_b32 v176, v178
    v_permlane16_swap_b32 v177, v179
    v_permlane16_swap_b32 v184, v186
    v_permlane16_swap_b32 v185, v187
    buffer_store_dwordx4 v[160:163], v115, s[16:19], s72 offen offset:0
    buffer_store_dwordx4 v[168:171], v115, s[16:19], s72 offen offset:64
    buffer_store_dwordx4 v[176:179], v115, s[16:19], s72 offen offset:128
    buffer_store_dwordx4 v[184:187], v115, s[16:19], s72 offen offset:192
    v_mov_b32 v120, v110
    v_mov_b32 v121, v110
    s_nop 1
    v_permlane16_swap_b32 v120, v121
    v_add_f32 v120, v120, v121
    v_mov_b32 v121, v120
    s_nop 1
    v_permlane32_swap_b32 v120, v121
    v_add_f32 v120, v120, v121
    v_rcp_f32 v120, v120
    s_nop 0
    v_mul_f32 v192, v192, v120
    v_mul_f32 v193, v193, v120
    v_mul_f32 v194, v194, v120
    v_mul_f32 v195, v195, v120
    v_mul_f32 v196, v196, v120
    v_mul_f32 v197, v197, v120
    v_mul_f32 v198, v198, v120
    v_mul_f32 v199, v199, v120
    v_mul_f32 v200, v200, v120
    v_mul_f32 v201, v201, v120
    v_mul_f32 v202, v202, v120
    v_mul_f32 v203, v203, v120
    v_mul_f32 v204, v204, v120
    v_mul_f32 v205, v205, v120
    v_mul_f32 v206, v206, v120
    v_mul_f32 v207, v207, v120
    v_mul_f32 v208, v208, v120
    v_mul_f32 v209, v209, v120
    v_mul_f32 v210, v210, v120
    v_mul_f32 v211, v211, v120
    v_mul_f32 v212, v212, v120
    v_mul_f32 v213, v213, v120
    v_mul_f32 v214, v214, v120
    v_mul_f32 v215, v215, v120
    v_mul_f32 v216, v216, v120
    v_mul_f32 v217, v217, v120
    v_mul_f32 v218, v218, v120
    v_mul_f32 v219, v219, v120
    v_mul_f32 v220, v220, v120
    v_mul_f32 v221, v221, v120
    v_mul_f32 v222, v222, v120
    v_mul_f32 v223, v223, v120
    v_cvt_pk_bf16_f32 v192, v192, v193
    v_cvt_pk_bf16_f32 v193, v194, v195
    v_cvt_pk_bf16_f32 v194, v196, v197
    v_cvt_pk_bf16_f32 v195, v198, v199
    v_cvt_pk_bf16_f32 v200, v200, v201
    v_cvt_pk_bf16_f32 v201, v202, v203
    v_cvt_pk_bf16_f32 v202, v204, v205
    v_cvt_pk_bf16_f32 v203, v206, v207
    v_cvt_pk_bf16_f32 v208, v208, v209
    v_cvt_pk_bf16_f32 v209, v210, v211
    v_cvt_pk_bf16_f32 v210, v212, v213
    v_cvt_pk_bf16_f32 v211, v214, v215
    v_cvt_pk_bf16_f32 v216, v216, v217
    v_cvt_pk_bf16_f32 v217, v218, v219
    v_cvt_pk_bf16_f32 v218, v220, v221
    v_cvt_pk_bf16_f32 v219, v222, v223
    v_permlane16_swap_b32 v192, v194
    v_permlane16_swap_b32 v193, v195
    v_permlane16_swap_b32 v200, v202
    v_permlane16_swap_b32 v201, v203
    v_permlane16_swap_b32 v208, v210
    v_permlane16_swap_b32 v209, v211
    v_permlane16_swap_b32 v216, v218
    v_permlane16_swap_b32 v217, v219
    buffer_store_dwordx4 v[192:195], v115, s[16:19], s73 offen offset:0
    buffer_store_dwordx4 v[200:203], v115, s[16:19], s73 offen offset:64
    buffer_store_dwordx4 v[208:211], v115, s[16:19], s73 offen offset:128
    buffer_store_dwordx4 v[216:219], v115, s[16:19], s73 offen offset:192
    v_mov_b32 v120, v111
    v_mov_b32 v121, v111
    s_nop 1
    v_permlane16_swap_b32 v120, v121
    v_add_f32 v120, v120, v121
    v_mov_b32 v121, v120
    s_nop 1
    v_permlane32_swap_b32 v120, v121
    v_add_f32 v120, v120, v121
    v_rcp_f32 v120, v120
    s_nop 0
    v_mul_f32 v224, v224, v120
    v_mul_f32 v225, v225, v120
    v_mul_f32 v226, v226, v120
    v_mul_f32 v227, v227, v120
    v_mul_f32 v228, v228, v120
    v_mul_f32 v229, v229, v120
    v_mul_f32 v230, v230, v120
    v_mul_f32 v231, v231, v120
    v_mul_f32 v232, v232, v120
    v_mul_f32 v233, v233, v120
    v_mul_f32 v234, v234, v120
    v_mul_f32 v235, v235, v120
    v_mul_f32 v236, v236, v120
    v_mul_f32 v237, v237, v120
    v_mul_f32 v238, v238, v120
    v_mul_f32 v239, v239, v120
    v_mul_f32 v240, v240, v120
    v_mul_f32 v241, v241, v120
    v_mul_f32 v242, v242, v120
    v_mul_f32 v243, v243, v120
    v_mul_f32 v244, v244, v120
    v_mul_f32 v245, v245, v120
    v_mul_f32 v246, v246, v120
    v_mul_f32 v247, v247, v120
    v_mul_f32 v248, v248, v120
    v_mul_f32 v249, v249, v120
    v_mul_f32 v250, v250, v120
    v_mul_f32 v251, v251, v120
    v_mul_f32 v252, v252, v120
    v_mul_f32 v253, v253, v120
    v_mul_f32 v254, v254, v120
    v_mul_f32 v255, v255, v120
    v_cvt_pk_bf16_f32 v224, v224, v225
    v_cvt_pk_bf16_f32 v225, v226, v227
    v_cvt_pk_bf16_f32 v226, v228, v229
    v_cvt_pk_bf16_f32 v227, v230, v231
    v_cvt_pk_bf16_f32 v232, v232, v233
    v_cvt_pk_bf16_f32 v233, v234, v235
    v_cvt_pk_bf16_f32 v234, v236, v237
    v_cvt_pk_bf16_f32 v235, v238, v239
    v_cvt_pk_bf16_f32 v240, v240, v241
    v_cvt_pk_bf16_f32 v241, v242, v243
    v_cvt_pk_bf16_f32 v242, v244, v245
    v_cvt_pk_bf16_f32 v243, v246, v247
    v_cvt_pk_bf16_f32 v248, v248, v249
    v_cvt_pk_bf16_f32 v249, v250, v251
    v_cvt_pk_bf16_f32 v250, v252, v253
    v_cvt_pk_bf16_f32 v251, v254, v255
    v_permlane16_swap_b32 v224, v226
    v_permlane16_swap_b32 v225, v227
    v_permlane16_swap_b32 v232, v234
    v_permlane16_swap_b32 v233, v235
    v_permlane16_swap_b32 v240, v242
    v_permlane16_swap_b32 v241, v243
    v_permlane16_swap_b32 v248, v250
    v_permlane16_swap_b32 v249, v251
    buffer_store_dwordx4 v[224:227], v115, s[16:19], s74 offen offset:0
    buffer_store_dwordx4 v[232:235], v115, s[16:19], s74 offen offset:64
    buffer_store_dwordx4 v[240:243], v115, s[16:19], s74 offen offset:128
    buffer_store_dwordx4 v[248:251], v115, s[16:19], s74 offen offset:192
    s_endpgm
L_end:
    s_endpgm
.section .rodata,"a"
.p2align 6
.amdhsa_kernel standalone__paged_block_table_kv_pagedattention__prompt_kernel
  .amdhsa_next_free_vgpr 504
  .amdhsa_next_free_sgpr 102
  .amdhsa_accum_offset 256
  .amdhsa_group_segment_fixed_size 0
  .amdhsa_kernarg_size 64
  .amdhsa_user_sgpr_count 2
  .amdhsa_user_sgpr_kernarg_segment_ptr 1
  .amdhsa_system_sgpr_workgroup_id_x 1
.end_amdhsa_kernel
```
